```python
import torch

def _softmax(x, axis=-1):
    return torch.softmax(x, dim=axis)

def _gelu(x):
    return torch.nn.functional.gelu(x, approximate='tanh')

def _silu(x):
    return torch.nn.functional.silu(x)

def _sigmoid(x):
    return torch.sigmoid(x)

def _layernorm(x, axis=-1, eps=1e-05):
    m = x.mean(dim=axis, keepdim=True)
    v = x.var(dim=axis, keepdim=True, unbiased=False)
    return (x - m) / torch.sqrt(v + eps)

def _scatter_add(tgt, idx, src, axis=0):
    return tgt.clone().index_add_(axis, idx, src)

def _segment_sum(src, seg, n):
    out = torch.zeros((n,) + src.shape[1:], dtype=src.dtype)
    return out.index_add_(0, seg, src)

def _pad(x, pw):
    flat = tuple((v for pair in reversed(pw) for v in pair))
    return torch.nn.functional.pad(x, flat)
kernel_name = 'adaLN_cond__gqa_block_cached__dense_activation_silu__prompt'

def setup_inputs():

    _w = lambda a: (lambda t: t.to(torch.bfloat16) if t.is_floating_point() else t)(torch.as_tensor(a))

    def _A_setup():
        B, Sq, D = (1, 2048, 512)
        Hq, Hkv, Sk, Dh = (32, 32, 2048, 128)
        assert Hq % Hkv == 0, (Hq, Hkv)
        return {'x': _w((lambda *s: torch.randn(*s, dtype=torch.bfloat16) * 0.1)(B, Sq, D)), 'k_cache': _w((lambda *s: torch.randn(*s, dtype=torch.bfloat16) * 0.8)(B, Hkv, Sk, Dh)), 'v_cache': _w((lambda *s: torch.randn(*s, dtype=torch.bfloat16) * 3.2)(B, Hkv, Sk, Dh)), 'wq': _w((lambda *s: torch.randn(*s, dtype=torch.bfloat16) * 0.8)(D, Hq * Dh) * D ** (-0.5)), 'wo': _w((lambda *s: torch.randn(*s, dtype=torch.bfloat16) * 3.2)(Hq * Dh, D) * (Hq * Dh) ** (-0.5))}
    _A_in = _A_setup()

    def _B_setup():
        B, S, D, F = (1, 2048, 512, 1376)
        return {'x': _w((lambda *s: torch.randn(*s, dtype=torch.bfloat16) * 0.1)(B, S, D)), 'w1': _w((lambda *s: torch.randn(*s, dtype=torch.bfloat16) * 3.2)(D, F) * D ** (-0.5)), 'w2': _w((lambda *s: torch.randn(*s, dtype=torch.bfloat16) * 3.2)(F, D) * F ** (-0.5))}
    _B_in = _B_setup()
    return {'A_x': _A_in['x'], 'A_k_cache': _A_in['k_cache'], 'A_v_cache': _A_in['v_cache'], 'A_wq': _A_in['wq'], 'A_wo': _A_in['wo'], 'B_x': _B_in['x'], 'B_w1': _B_in['w1'], 'B_w2': _B_in['w2'], 'c': _w((lambda *s: torch.randn(*s, dtype=torch.bfloat16) * 0.2)(1, 512) * 8.0), 'w_mod': _w((lambda *s: torch.randn(*s, dtype=torch.bfloat16) * 0.2)(512, 6 * 512) * 512 ** (-0.5) * 8.0)}

def reference(A_x, A_k_cache, A_v_cache, A_wq, A_wo, B_x, B_w1, B_w2, c, w_mod):

    def _A_ref(x, k_cache, v_cache, wq, wo):
        B, Sq, D = x.shape
        Hq, Dh = (32, 128)
        Hkv = k_cache.shape[1]
        rep = Hq // Hkv
        q = (lambda x, *d: x.permute(*d))((x @ wq).reshape(B, Sq, Hq, Dh), 0, 2, 1, 3)
        k = (lambda x, n, axis: torch.repeat_interleave(x, n, dim=axis))(k_cache, rep, axis=1)
        v = (lambda x, n, axis: torch.repeat_interleave(x, n, dim=axis))(v_cache, rep, axis=1)
        scores = torch.einsum('bhqd,bhkd->bhqk', q, k) * Dh ** (-0.5)
        p = _softmax(scores, axis=-1)
        o = torch.einsum('bhqk,bhkd->bhqd', p, v)
        return (lambda x, *d: x.permute(*d))(o, 0, 2, 1, 3).reshape(B, Sq, Hq * Dh) @ wo

    def _B_ref(x, w1, w2):
        h = torch.einsum('bsd,df->bsf', x, w1)
        h = _silu(h)
        out = torch.einsum('bsf,fd->bsd', h, w2)
        return out
    x = A_x
    mod = (_silu(c) @ w_mod).reshape(c.shape[0], 6, 1, -1)
    sa, ca, ga, sb, cb, gb = (mod[:, 0].clone(), mod[:, 1].clone(), mod[:, 2].clone(), mod[:, 3].clone(), mod[:, 4].clone(), mod[:, 5].clone())
    h = _layernorm(x, axis=-1) * (1 + ca) + sa
    x = x + ga * _A_ref(h, A_k_cache, A_v_cache, A_wq, A_wo)
    h = _layernorm(x, axis=-1) * (1 + cb) + sb
    x = x + gb * _B_ref(h, B_w1, B_w2)
    return x
```

```asm
; @launch grid=(256,1,1) block=(256,1,1) lds=163840
.amdgcn_target "amdgcn-amd-amdhsa--gfx950"
.text
.globl adaLN_cond__gqa_block_cached__dense_activation_silu__prompt_kernel
.p2align 8
.type adaLN_cond__gqa_block_cached__dense_activation_silu__prompt_kernel,@function
adaLN_cond__gqa_block_cached__dense_activation_silu__prompt_kernel:
    s_cmpk_ge_u32 s2, 0x100
    s_cbranch_scc1 L_done
    s_mov_b32 s73, 0
L_top:
    s_load_dwordx2 s[32:33], s[0:1], 0
    s_getpc_b64 s[44:45]
L_pc:
    v_lshlrev_b32 v119, 4, v0
    s_lshr_b32 s74, s2, 3
    s_lshl_b32 s74, s74, 12
    s_mov_b32 s46, L_end-L_pc
    s_mov_b32 s47, 0x20000
    buffer_load_dwordx4 v[120:123], v119, s[44:47], s74 offen
    s_load_dwordx2 s[28:29], s[0:1], 72
    s_load_dwordx2 s[24:25], s[0:1], 64
    s_load_dwordx2 s[40:41], s[0:1], 96
    s_mov_b32 s42, 32899072
    s_mov_b32 s43, s47
    v_mov_b32 v115, 32520192
    v_readfirstlane_b32 s64, v0
    v_and_b32 v219, 7, v0
    v_and_b32 v220, 24, v0
    v_lshrrev_b32 v221, 5, v0
    v_lshl_add_u32 v105, v219, 10, v220
    v_lshl_add_u32 v105, v221, 7, v105
    s_lshl_b32 s67, s2, 13
    s_mov_b32 s34, 0x200000
    s_mov_b32 s35, s47
    s_mov_b32 s27, s47
    s_mov_b32 s31, s47
    s_movk_i32 s26, 1024
    s_mov_b32 s30, 3145728
    v_bfe_u32 v222, v0, 4, 2
    v_lshlrev_b32 v222, 3, v222
    s_and_b32 s70, s2, 3
    s_lshl_b32 s68, s70, 8
    s_add_u32 s68, s68, s64
    v_bfe_u32 v106, v0, 3, 3
    v_and_b32 v104, 6, v106
    v_xor_b32 v104, v104, v219
    v_mul_u32_u24 v106, 6144, v106
    v_lshl_add_u32 v104, v104, 4, v106
    s_lshr_b32 s69, s2, 2
    s_mul_i32 s81, s68, 3072
    s_lshl_b32 s79, s69, 7
    s_add_u32 s81, s81, s79
    s_cmp_lt_u32 s69, 48
    s_cselect_b32 s81, s81, s30
    s_lshl_b32 m0, s64, 6
    s_waitcnt lgkmcnt(0)
    buffer_load_dwordx2 v[12:13], v222, s[24:27], s68 offen offset:0
    buffer_load_dwordx2 v[14:15], v222, s[24:27], s68 offen offset:32
    buffer_load_dword v114, v115, s[40:43], 0 offen sc1
    buffer_load_dwordx4 v104, s[28:31], s81 offen offset:0 lds
    s_add_u32 s81, s81, 48128
    buffer_load_dwordx4 v104, s[28:31], s81 offen offset:1024 lds
    s_add_u32 s81, s81, 48128
    buffer_load_dwordx4 v104, s[28:31], s81 offen offset:2048 lds
    s_add_u32 s81, s81, 48128
    buffer_load_dwordx4 v104, s[28:31], s81 offen offset:3072 lds
    buffer_load_dwordx2 v[4:5], v105, s[32:35], s67 offen offset:0
    buffer_load_dwordx2 v[6:7], v105, s[32:35], s67 offen offset:32
    buffer_load_dwordx2 v[8:9], v105, s[32:35], s67 offen offset:64
    buffer_load_dwordx2 v[10:11], v105, s[32:35], s67 offen offset:96
    s_load_dwordx2 s[54:55], s[0:1], 96
    s_load_dwordx2 s[22:23], s[0:1], 24
    s_load_dwordx4 s[48:51], s[0:1], 8
    s_load_dwordx2 s[52:53], s[0:1], 80
    s_load_dwordx2 s[58:59], s[0:1], 0
    s_load_dwordx2 s[56:57], s[0:1], 32
    s_load_dwordx4 s[60:63], s[0:1], 48
    v_lshlrev_b32 v106, 4, v219
    v_lshl_add_u32 v106, v220, 5, v106
    v_lshl_add_u32 v106, v221, 11, v106
    v_and_b32 v218, 63, v0
    v_lshlrev_b32 v231, 4, v218
    s_lshr_b32 s64, s64, 6
    s_and_b32 s65, s2, 7
    s_lshl_b32 s65, s65, 2
    s_lshr_b32 s67, s2, 6
    s_add_u32 s77, s65, s67
    s_bfe_u32 s78, s2, 0x30003
    s_bfe_u32 s67, s2, 0x20003
    s_add_u32 s65, s65, s67
    s_lshr_b32 s66, s2, 5
    s_lshl_b32 s71, s64, 12
    s_waitcnt lgkmcnt(0)
    s_add_u32 s40, s54, 32505856
    s_addc_u32 s41, s55, 0
    s_mov_b32 s42, 0x60000
    s_mov_b32 s43, 0x20000
    s_lshl_b32 s67, s66, 11
    s_add_u32 s67, s67, 262144
    v_and_b32 v219, 127, v0
    v_lshlrev_b32 v219, 4, v219
    buffer_load_dword v120, v219, s[40:43], s67 offen sc1
    v_lshrrev_b32 v219, 4, v218
    v_and_b32 v220, 15, v218
    s_lshl_b32 s67, s64, 4
    v_add_u32 v221, s67, v219
    v_lshlrev_b32 v222, 1, v219
    v_xor_b32 v222, v222, v220
    v_lshlrev_b32 v222, 4, v222
    v_lshl_add_u32 v216, v221, 8, v222
    v_lshl_add_u32 v190, v221, 13, v222
    v_lshlrev_b32 v222, 1, v219
    v_xor_b32 v222, v222, v220
    v_xor_b32 v222, 8, v222
    v_lshlrev_b32 v222, 4, v222
    v_lshl_add_u32 v217, v221, 8, v222
    v_lshl_add_u32 v191, v221, 13, v222
    s_lshl_b32 s67, s65, 8
    s_add_u32 s12, s22, s67
    s_addc_u32 s13, s23, 0
    s_mov_b32 s14, 0x3fe100
    s_mov_b32 s15, 0x20000
    s_lshl_b32 s67, s65, 19
    s_add_u32 s4, s48, s67
    s_addc_u32 s5, s49, 0
    s_mov_b32 s6, 0x80000
    s_mov_b32 s7, 0x20000
    s_add_u32 s8, s50, s67
    s_addc_u32 s9, s51, 0
    s_mov_b32 s10, 0x80000
    s_mov_b32 s11, 0x20000
    v_xor_b32 v222, v219, v220
    v_lshlrev_b32 v222, 4, v222
    v_lshl_add_u32 v212, v221, 8, v222
    v_xor_b32 v222, v219, v220
    v_xor_b32 v222, 4, v222
    v_lshlrev_b32 v222, 4, v222
    v_lshl_add_u32 v213, v221, 8, v222
    v_xor_b32 v222, v219, v220
    v_xor_b32 v222, 8, v222
    v_lshlrev_b32 v222, 4, v222
    v_lshl_add_u32 v214, v221, 8, v222
    v_xor_b32 v222, v219, v220
    v_xor_b32 v222, 12, v222
    v_lshlrev_b32 v222, 4, v222
    v_lshl_add_u32 v215, v221, 8, v222
    v_xor_b32 v222, v219, v220
    v_lshlrev_b32 v222, 4, v222
    v_lshl_add_u32 v200, v220, 8, v222
    v_xor_b32 v201, 64, v200
    v_xor_b32 v202, 128, v200
    v_xor_b32 v203, 192, v200
    v_lshrrev_b32 v221, 2, v218
    v_and_b32 v222, 7, v221
    v_lshlrev_b32 v222, 1, v222
    v_lshlrev_b32 v221, 8, v221
    v_and_b32 v220, 3, v218
    v_xor_b32 v219, v222, v220
    v_lshl_add_u32 v186, v219, 4, v221
    v_xor_b32 v187, 64, v186
    v_xor_b32 v188, 128, v186
    v_xor_b32 v189, 192, v186
    v_lshrrev_b32 v219, 1, v220
    v_xor_b32 v219, v222, v219
    v_lshl_add_u32 v221, v219, 4, v221
    v_and_b32 v219, 1, v220
    v_lshl_add_u32 v221, v219, 3, v221
    v_add_u32 v204, 65536, v221
    v_xor_b32 v205, 32, v204
    v_xor_b32 v206, 64, v204
    v_xor_b32 v207, 96, v204
    v_xor_b32 v208, 128, v204
    v_xor_b32 v209, 160, v204
    v_xor_b32 v210, 192, v204
    v_xor_b32 v211, 224, v204
    v_and_b32 v219, 1, v218
    v_cmp_eq_u32 vcc, 0, v219
    v_mov_b32 v219, 0x44444444
    v_mov_b32 v221, 0xeeeeeeee
    v_cndmask_b32 v2, v221, v219, vcc
    v_bfe_u32 v219, v218, 1, 1
    v_lshrrev_b32 v221, 5, v218
    v_cmp_eq_u32 vcc, v219, v221
    v_mov_b32 v219, 0x3f803f80
    v_accvgpr_write_b32 a192, 0
    v_accvgpr_write_b32 a193, 0
    v_accvgpr_write_b32 a194, 0
    v_accvgpr_write_b32 a195, 0
    v_accvgpr_write_b32 a196, 0
    v_accvgpr_write_b32 a197, 0
    v_accvgpr_write_b32 a198, 0
    v_accvgpr_write_b32 a199, 0
    v_cndmask_b32 v196, 0, v219, vcc
    v_cndmask_b32 v197, 0, v219, vcc
    v_cndmask_b32 v198, 0, v219, vcc
    v_cndmask_b32 v199, 0, v219, vcc
    s_mul_i32 s67, s66, 2097152
    s_lshl_b32 s68, s65, 10
    s_add_u32 s67, s67, s68
    s_add_u32 s67, s67, 2097152
    s_add_u32 s20, s54, s67
    s_addc_u32 s21, s55, 0
    s_mov_b32 s22, 0x1f8400
    s_mov_b32 s23, 0x20000
    s_lshl_b32 s67, s78, 19
    s_lshl_b32 s68, s64, 17
    s_add_u32 s67, s67, s68
    s_add_u32 s67, s67, 33554432
    s_add_u32 s44, s54, s67
    s_addc_u32 s45, s55, 0
    s_mov_b32 s46, 0x20000
    s_mov_b32 s47, 0x20000
    v_lshrrev_b32 v219, 2, v218
    v_and_b32 v220, 6, v219
    v_bfe_u32 v221, v218, 1, 1
    v_xor_b32 v220, v220, v221
    v_lshlrev_b32 v220, 4, v220
    v_lshl_add_u32 v220, v219, 7, v220
    v_and_b32 v221, 1, v218
    v_lshl_add_u32 v220, v221, 3, v220
    v_add_u32 v108, s71, v220
    v_xor_b32 v109, 32, v108
    v_xor_b32 v110, 64, v108
    v_xor_b32 v111, 96, v108
    v_and_b32 v222, 48, v218
    s_lshl_b32 s67, s64, 8
    s_add_u32 s67, s67, 151552
    v_add_u32 v116, s67, v222
    v_and_b32 v219, 15, v218
    v_lshlrev_b32 v219, 4, v219
    v_add_u32 v117, 151552, v219
    v_and_b32 v221, 7, v218
    v_lshlrev_b32 v221, 5, v221
    v_add_u32 v119, 152576, v221
    s_lshl_b32 s67, s64, 3
    v_add_u32 v118, s67, v119
    s_add_u32 s24, s54, 31457280
    s_addc_u32 s25, s55, 0
    s_mov_b32 s26, 0xc000
    s_mov_b32 s27, 0x20000
    s_mul_i32 s75, s70, 12288
    s_lshl_b32 s68, s69, 8
    s_add_u32 s75, s75, s68
    s_cmp_lt_u32 s69, 48
    s_cselect_b32 s75, s75, 0x100000
    v_lshrrev_b32 v219, 4, v0
    v_lshlrev_b32 v219, 20, v219
    v_lshl_add_u32 v124, v0, 4, v219
    s_lshl_b32 s68, s66, 18
    s_add_u32 s16, s54, s68
    s_addc_u32 s17, s55, 0
    s_mov_b32 s18, 0x40000
    s_mov_b32 s19, 0x20000
    s_bfe_u32 s76, s2, 0x40001
    s_lshl_b32 s76, s76, 14
    s_and_b32 s68, s2, 1
    s_lshl_b32 s68, s68, 7
    s_add_u32 s76, s76, s68
    v_add_u32 v106, s76, v106
    s_lshl_b32 s67, s2, 4
    s_add_u32 s67, s67, 262656
    s_cmp_lt_u32 s2, 64
    s_cselect_b32 s67, s67, 0x100000
    v_lshrrev_b32 v219, 3, v0
    v_lshlrev_b32 v219, 20, v219
    v_lshl_add_u32 v115, v0, 11, v219
    v_add_u32 v115, s67, v115
    s_lshl_b32 s67, s66, 11
    s_add_u32 s67, s67, 262144
    s_and_b32 s68, s2, 31
    s_lshl_b32 s68, s68, 4
    s_add_u32 s68, s67, s68
    v_lshlrev_b32 v125, 20, v0
    v_add_u32 v125, s68, v125
    s_lshl_b32 s68, s64, 5
    s_add_u32 s67, s67, s68
    s_add_u32 s67, s67, 128
    v_and_b32 v219, 7, v218
    v_bfe_u32 v220, v218, 3, 1
    v_lshlrev_b32 v220, 7, v220
    v_lshl_add_u32 v219, v219, 2, v220
    v_add_u32 v126, s67, v219
    v_and_b32 v219, 31, v218
    v_lshrrev_b32 v220, 5, v218
    v_cvt_f32_u32 v128, v220
    v_lshlrev_b32 v220, 11, v220
    v_lshl_add_u32 v219, v219, 4, v220
    s_lshl_b32 s67, s64, 9
    v_add_u32 v127, s67, v219
    s_lshl_b32 s67, s64, 10
    s_add_u32 s67, s67, 147456
    v_add_u32 v129, s67, v231
    v_lshrrev_b32 v219, 5, v218
    v_and_b32 v220, 24, v218
    v_lshlrev_b32 v220, 1, v220
    v_lshl_add_u32 v219, v219, 8, v220
    v_add_u32 v130, s67, v219
    s_waitcnt vmcnt(10)
    v_lshlrev_b32 v32, 16, v12
    v_and_b32 v33, 0xffff0000, v12
    v_lshlrev_b32 v34, 16, v13
    v_and_b32 v35, 0xffff0000, v13
    v_lshlrev_b32 v36, 16, v14
    v_and_b32 v37, 0xffff0000, v14
    v_lshlrev_b32 v38, 16, v15
    v_and_b32 v39, 0xffff0000, v15
    v_mul_f32 v40, 0xbfb8aa3b, v32
    v_mul_f32 v41, 0xbfb8aa3b, v33
    v_mul_f32 v42, 0xbfb8aa3b, v34
    v_mul_f32 v43, 0xbfb8aa3b, v35
    v_mul_f32 v44, 0xbfb8aa3b, v36
    v_mul_f32 v45, 0xbfb8aa3b, v37
    v_mul_f32 v46, 0xbfb8aa3b, v38
    v_mul_f32 v47, 0xbfb8aa3b, v39
    v_exp_f32 v40, v40
    v_exp_f32 v41, v41
    v_exp_f32 v42, v42
    v_exp_f32 v43, v43
    v_exp_f32 v44, v44
    v_exp_f32 v45, v45
    v_exp_f32 v46, v46
    v_exp_f32 v47, v47
    v_add_f32 v40, 1.0, v40
    v_add_f32 v41, 1.0, v41
    v_add_f32 v42, 1.0, v42
    v_add_f32 v43, 1.0, v43
    v_add_f32 v44, 1.0, v44
    v_add_f32 v45, 1.0, v45
    v_add_f32 v46, 1.0, v46
    v_add_f32 v47, 1.0, v47
    v_rcp_f32 v40, v40
    v_rcp_f32 v41, v41
    v_rcp_f32 v42, v42
    v_rcp_f32 v43, v43
    v_rcp_f32 v44, v44
    v_rcp_f32 v45, v45
    v_rcp_f32 v46, v46
    v_rcp_f32 v47, v47
    v_mul_f32 v32, v32, v40
    v_mul_f32 v33, v33, v41
    v_mul_f32 v34, v34, v42
    v_mul_f32 v35, v35, v43
    v_mul_f32 v36, v36, v44
    v_mul_f32 v37, v37, v45
    v_mul_f32 v38, v38, v46
    v_mul_f32 v39, v39, v47
    v_cvt_pk_bf16_f32 v12, v32, v33
    v_cvt_pk_bf16_f32 v13, v34, v35
    v_cvt_pk_bf16_f32 v14, v36, v37
    v_cvt_pk_bf16_f32 v15, v38, v39
    s_waitcnt vmcnt(9)
    s_cmp_lg_u32 s73, 0
    s_cbranch_scc1 L_havetag
    v_readfirstlane_b32 s82, v114
    s_nop 0
    s_mul_i32 s82, s82, 1664525
    s_add_u32 s82, s82, 1013904223
L_havetag:
    v_mov_b32 v254, s82
    s_waitcnt vmcnt(5)
    s_add_u32 s68, s66, 0
    s_and_b32 s68, s68, 7
    s_lshl_b32 s67, s68, 14
    s_add_u32 s67, s67, s71
    s_add_u32 m0, s67, 16384
    s_lshl_b32 s67, s68, 19
    buffer_load_dwordx4 v190, s[12:15], s67 offen offset:0 lds
    s_add_u32 s67, s67, 31744
    buffer_load_dwordx4 v191, s[12:15], s67 offen offset:1024 lds
    s_add_u32 s67, s67, 31744
    buffer_load_dwordx4 v190, s[12:15], s67 offen offset:2048 lds
    s_add_u32 s67, s67, 31744
    buffer_load_dwordx4 v191, s[12:15], s67 offen offset:3072 lds
    ds_read_b64_tr_b16 v[64:65], v108 offset:0
    ds_read_b64_tr_b16 v[66:67], v108 offset:2048
    ds_read_b64_tr_b16 v[68:69], v109 offset:0
    ds_read_b64_tr_b16 v[70:71], v109 offset:2048
    ds_read_b64_tr_b16 v[72:73], v110 offset:0
    ds_read_b64_tr_b16 v[74:75], v110 offset:2048
    ds_read_b64_tr_b16 v[76:77], v111 offset:0
    ds_read_b64_tr_b16 v[78:79], v111 offset:2048
    s_waitcnt lgkmcnt(6)
    v_mfma_f32_16x16x32_bf16 v[48:51], v[64:67], v[12:15], 0
    s_waitcnt lgkmcnt(4)
    v_mfma_f32_16x16x32_bf16 v[52:55], v[68:71], v[12:15], 0
    s_waitcnt lgkmcnt(2)
    v_mfma_f32_16x16x32_bf16 v[56:59], v[72:75], v[12:15], 0
    s_waitcnt lgkmcnt(0)
    v_mfma_f32_16x16x32_bf16 v[60:63], v[76:79], v[12:15], 0
    s_nop 1
    ds_write_b128 v116, v[48:51] offset:0
    s_nop 0
    ds_write_b128 v116, v[52:55] offset:64
    s_nop 0
    ds_write_b128 v116, v[56:59] offset:128
    s_nop 0
    ds_write_b128 v116, v[60:63] offset:192
    s_waitcnt lgkmcnt(0)
    s_barrier
    ds_read_b128 v[88:91], v117 offset:0
    ds_read_b128 v[92:95], v117 offset:256
    ds_read_b128 v[96:99], v117 offset:512
    ds_read_b128 v[100:103], v117 offset:768
    s_waitcnt lgkmcnt(0)
    v_add_f32 v88, v88, v92
    v_add_f32 v96, v96, v100
    v_add_f32 v89, v89, v93
    v_add_f32 v97, v97, v101
    v_add_f32 v90, v90, v94
    v_add_f32 v98, v98, v102
    v_add_f32 v91, v91, v95
    v_add_f32 v99, v99, v103
    v_add_f32 v48, v88, v96
    v_add_f32 v49, v89, v97
    v_add_f32 v50, v90, v98
    v_add_f32 v51, v91, v99
    v_add_u32 v48, 0x80, v48
    s_mov_b32 s67, 0x7060500
    v_perm_b32 v48, v48, v254, s67
    v_add_u32 v49, 0x80, v49
    s_mov_b32 s67, 0x7060501
    v_perm_b32 v49, v49, v254, s67
    v_add_u32 v50, 0x80, v50
    s_mov_b32 s67, 0x7060502
    v_perm_b32 v50, v50, v254, s67
    v_add_u32 v51, 0x80, v51
    s_mov_b32 s67, 0x7060503
    v_perm_b32 v51, v51, v254, s67
    buffer_store_dwordx4 v[48:51], v124, s[24:27], s75 offen sc1
    s_waitcnt vmcnt(6)
    v_lshlrev_b32 v16, 16, v4
    v_and_b32 v17, 0xffff0000, v4
    v_lshlrev_b32 v18, 16, v5
    v_and_b32 v19, 0xffff0000, v5
    v_lshlrev_b32 v20, 16, v6
    v_and_b32 v21, 0xffff0000, v6
    v_lshlrev_b32 v22, 16, v7
    v_and_b32 v23, 0xffff0000, v7
    v_lshlrev_b32 v24, 16, v8
    v_and_b32 v25, 0xffff0000, v8
    v_lshlrev_b32 v26, 16, v9
    v_and_b32 v27, 0xffff0000, v9
    v_lshlrev_b32 v28, 16, v10
    v_and_b32 v29, 0xffff0000, v10
    v_lshlrev_b32 v30, 16, v11
    v_and_b32 v31, 0xffff0000, v11
    v_pk_add_f32 v[40:41], v[16:17], v[24:25]
    v_pk_add_f32 v[42:43], v[18:19], v[26:27]
    v_pk_add_f32 v[44:45], v[20:21], v[28:29]
    v_pk_add_f32 v[46:47], v[22:23], v[30:31]
    v_pk_add_f32 v[40:41], v[40:41], v[44:45]
    v_pk_add_f32 v[42:43], v[42:43], v[46:47]
    v_pk_add_f32 v[40:41], v[40:41], v[42:43]
    v_add_f32 v112, v40, v41
    v_mov_b32 v219, v112
    s_nop 1
    v_permlane32_swap_b32 v219, v112
    v_add_f32 v112, v219, v112
    v_mov_b32 v219, v112
    s_nop 1
    v_permlane16_swap_b32 v219, v112
    v_add_f32 v112, v219, v112
    s_nop 1
    v_add_f32_dpp v112, v112, v112 row_ror:8 row_mask:0xf bank_mask:0xf
    v_mul_f32 v32, 0xbc000000, v112
    v_pk_add_f32 v[88:89], v[16:17], v[32:33] op_sel_hi:[1,0]
    v_pk_add_f32 v[90:91], v[18:19], v[32:33] op_sel_hi:[1,0]
    v_pk_add_f32 v[92:93], v[20:21], v[32:33] op_sel_hi:[1,0]
    v_pk_add_f32 v[94:95], v[22:23], v[32:33] op_sel_hi:[1,0]
    v_pk_add_f32 v[96:97], v[24:25], v[32:33] op_sel_hi:[1,0]
    v_pk_add_f32 v[98:99], v[26:27], v[32:33] op_sel_hi:[1,0]
    v_pk_add_f32 v[100:101], v[28:29], v[32:33] op_sel_hi:[1,0]
    v_pk_add_f32 v[102:103], v[30:31], v[32:33] op_sel_hi:[1,0]
    v_pk_mul_f32 v[96:97], v[96:97], v[96:97]
    v_pk_mul_f32 v[98:99], v[98:99], v[98:99]
    v_pk_mul_f32 v[100:101], v[100:101], v[100:101]
    v_pk_mul_f32 v[102:103], v[102:103], v[102:103]
    v_pk_fma_f32 v[40:41], v[88:89], v[88:89], v[96:97]
    v_pk_fma_f32 v[42:43], v[90:91], v[90:91], v[98:99]
    v_pk_fma_f32 v[44:45], v[92:93], v[92:93], v[100:101]
    v_pk_fma_f32 v[46:47], v[94:95], v[94:95], v[102:103]
    v_pk_add_f32 v[40:41], v[40:41], v[44:45]
    v_pk_add_f32 v[42:43], v[42:43], v[46:47]
    v_pk_add_f32 v[40:41], v[40:41], v[42:43]
    v_add_f32 v113, v40, v41
    v_mov_b32 v219, v113
    s_nop 1
    v_permlane32_swap_b32 v219, v113
    v_add_f32 v113, v219, v113
    v_mov_b32 v219, v113
    s_nop 1
    v_permlane16_swap_b32 v219, v113
    v_add_f32 v113, v219, v113
    s_nop 1
    v_add_f32_dpp v113, v113, v113 row_ror:8 row_mask:0xf bank_mask:0xf
    ds_write_b64 v118, v[112:113]
    s_waitcnt lgkmcnt(0)
    s_barrier
    ds_read_b128 v[80:83], v119
    ds_read_b128 v[84:87], v119 offset:16
    s_add_u32 s68, s66, 1
    s_and_b32 s68, s68, 7
    s_lshl_b32 s67, s68, 14
    s_add_u32 s67, s67, s71
    s_add_u32 m0, s67, 16384
    s_lshl_b32 s67, s68, 19
    buffer_load_dwordx4 v190, s[12:15], s67 offen offset:0 lds
    s_add_u32 s67, s67, 31744
    buffer_load_dwordx4 v191, s[12:15], s67 offen offset:1024 lds
    s_add_u32 s67, s67, 31744
    buffer_load_dwordx4 v190, s[12:15], s67 offen offset:2048 lds
    s_add_u32 s67, s67, 31744
    buffer_load_dwordx4 v191, s[12:15], s67 offen offset:3072 lds
    s_add_u32 s68, s66, 2
    s_and_b32 s68, s68, 7
    s_lshl_b32 s67, s68, 14
    s_add_u32 s67, s67, s71
    s_add_u32 m0, s67, 16384
    s_lshl_b32 s67, s68, 19
    buffer_load_dwordx4 v190, s[12:15], s67 offen offset:0 lds
    s_add_u32 s67, s67, 31744
    buffer_load_dwordx4 v191, s[12:15], s67 offen offset:1024 lds
    s_add_u32 s67, s67, 31744
    buffer_load_dwordx4 v190, s[12:15], s67 offen offset:2048 lds
    s_add_u32 s67, s67, 31744
    buffer_load_dwordx4 v191, s[12:15], s67 offen offset:3072 lds
    s_waitcnt lgkmcnt(0)
    v_pk_add_f32 v[32:33], v[80:81], v[82:83]
    v_pk_add_f32 v[34:35], v[84:85], v[86:87]
    v_pk_add_f32 v[112:113], v[32:33], v[34:35]
    v_mul_f32 v112, 0x3b000000, v112
    v_mov_b32 v220, 0x3c000000
    v_fma_f32 v80, v80, v220, -v112
    v_fma_f32 v82, v82, v220, -v112
    v_fma_f32 v84, v84, v220, -v112
    v_fma_f32 v86, v86, v220, -v112
    v_mul_f32 v219, v80, v80
    v_fmac_f32 v219, v82, v82
    v_fmac_f32 v219, v84, v84
    v_fmac_f32 v219, v86, v86
    v_fmac_f32 v113, 0x43000000, v219
    v_mul_f32 v113, 0x3b000000, v113
    v_cvt_pk_bf16_f32 v112, v112, v112
    v_and_b32 v112, 0xffff0000, v112
    v_max_f32 v113, 0, v113
    v_cvt_pk_bf16_f32 v113, v113, v113
    v_and_b32 v113, 0xffff0000, v113
    v_add_f32 v113, 0x3727c5ac, v113
    v_cvt_pk_bf16_f32 v113, v113, v113
    v_and_b32 v113, 0xffff0000, v113
    v_sqrt_f32 v113, v113
    s_nop 0
    v_cvt_pk_bf16_f32 v113, v113, v113
    v_and_b32 v113, 0xffff0000, v113
    v_rcp_f32 v113, v113
    s_nop 0
    v_pk_add_f32 v[16:17], v[16:17], v[112:113] op_sel_hi:[1,0] neg_lo:[0,1] neg_hi:[0,1]
    v_pk_add_f32 v[18:19], v[18:19], v[112:113] op_sel_hi:[1,0] neg_lo:[0,1] neg_hi:[0,1]
    v_pk_add_f32 v[20:21], v[20:21], v[112:113] op_sel_hi:[1,0] neg_lo:[0,1] neg_hi:[0,1]
    v_pk_add_f32 v[22:23], v[22:23], v[112:113] op_sel_hi:[1,0] neg_lo:[0,1] neg_hi:[0,1]
    v_pk_add_f32 v[24:25], v[24:25], v[112:113] op_sel_hi:[1,0] neg_lo:[0,1] neg_hi:[0,1]
    v_pk_add_f32 v[26:27], v[26:27], v[112:113] op_sel_hi:[1,0] neg_lo:[0,1] neg_hi:[0,1]
    v_pk_add_f32 v[28:29], v[28:29], v[112:113] op_sel_hi:[1,0] neg_lo:[0,1] neg_hi:[0,1]
    v_pk_add_f32 v[30:31], v[30:31], v[112:113] op_sel_hi:[1,0] neg_lo:[0,1] neg_hi:[0,1]
    v_pk_mul_f32 v[16:17], v[16:17], v[112:113] op_sel:[0,1] op_sel_hi:[1,1]
    v_pk_mul_f32 v[18:19], v[18:19], v[112:113] op_sel:[0,1] op_sel_hi:[1,1]
    v_pk_mul_f32 v[20:21], v[20:21], v[112:113] op_sel:[0,1] op_sel_hi:[1,1]
    v_pk_mul_f32 v[22:23], v[22:23], v[112:113] op_sel:[0,1] op_sel_hi:[1,1]
    v_pk_mul_f32 v[24:25], v[24:25], v[112:113] op_sel:[0,1] op_sel_hi:[1,1]
    v_pk_mul_f32 v[26:27], v[26:27], v[112:113] op_sel:[0,1] op_sel_hi:[1,1]
    v_pk_mul_f32 v[28:29], v[28:29], v[112:113] op_sel:[0,1] op_sel_hi:[1,1]
    v_pk_mul_f32 v[30:31], v[30:31], v[112:113] op_sel:[0,1] op_sel_hi:[1,1]
    s_add_u32 s28, s54, 31457280
    s_addc_u32 s29, s55, 0
    s_mov_b32 s30, 0xc000
    s_mov_b32 s31, 0x20000
    s_mov_b32 s72, 0
    s_mov_b32 s75, 0x0c0c0400
    s_mov_b32 s76, 0x04000c0c
L_hm_spin:
    s_mov_b32 s67, 0
    buffer_load_dwordx4 v[88:91], v127, s[28:31], s67 offen sc1
    s_mov_b32 s67, 12288
    buffer_load_dwordx4 v[92:95], v127, s[28:31], s67 offen sc1
    s_mov_b32 s67, 24576
    buffer_load_dwordx4 v[96:99], v127, s[28:31], s67 offen sc1
    s_mov_b32 s67, 36864
    buffer_load_dwordx4 v[100:103], v127, s[28:31], s67 offen sc1
    s_waitcnt vmcnt(3)
    v_perm_b32 v32, v89, v88, s75
    v_perm_b32 v33, v91, v90, s76
    v_or_b32 v32, v32, v33
    v_xor_b32 v32, v32, v254
    s_waitcnt vmcnt(2)
    v_perm_b32 v34, v93, v92, s75
    v_perm_b32 v35, v95, v94, s76
    v_or_b32 v34, v34, v35
    v_xor_b32 v34, v34, v254
    s_waitcnt vmcnt(1)
    v_perm_b32 v36, v97, v96, s75
    v_perm_b32 v37, v99, v98, s76
    v_or_b32 v36, v36, v37
    v_xor_b32 v36, v36, v254
    s_waitcnt vmcnt(0)
    v_perm_b32 v38, v101, v100, s75
    v_perm_b32 v39, v103, v102, s76
    v_or_b32 v38, v38, v39
    v_xor_b32 v38, v38, v254
    v_or3_b32 v32, v32, v34, v36
    v_or_b32 v32, v32, v38
    v_cmp_ne_u32 vcc, 0, v32
    s_add_u32 s72, s72, 1
    s_cmp_eq_u64 vcc, 0
    s_cbranch_scc1 L_hm_ok
    s_sleep 4
    s_cmp_lt_u32 s72, 400000
    s_cbranch_scc1 L_hm_spin
L_hm_ok:
    v_and_b32 v88, 0xffffff00, v88
    v_and_b32 v89, 0xffffff00, v89
    v_and_b32 v90, 0xffffff00, v90
    v_and_b32 v91, 0xffffff00, v91
    v_and_b32 v92, 0xffffff00, v92
    v_and_b32 v93, 0xffffff00, v93
    v_and_b32 v94, 0xffffff00, v94
    v_and_b32 v95, 0xffffff00, v95
    v_and_b32 v96, 0xffffff00, v96
    v_and_b32 v97, 0xffffff00, v97
    v_and_b32 v98, 0xffffff00, v98
    v_and_b32 v99, 0xffffff00, v99
    v_and_b32 v100, 0xffffff00, v100
    v_and_b32 v101, 0xffffff00, v101
    v_and_b32 v102, 0xffffff00, v102
    v_and_b32 v103, 0xffffff00, v103
    v_add_f32 v88, v88, v92
    v_add_f32 v96, v96, v100
    v_add_f32 v89, v89, v93
    v_add_f32 v97, v97, v101
    v_add_f32 v90, v90, v94
    v_add_f32 v98, v98, v102
    v_add_f32 v91, v91, v95
    v_add_f32 v99, v99, v103
    v_add_f32 v88, v88, v96
    v_add_f32 v89, v89, v97
    v_add_f32 v90, v90, v98
    v_add_f32 v91, v91, v99
    v_cvt_pk_bf16_f32 v88, v88, v88
    v_and_b32 v88, 0xffff0000, v88
    v_cvt_pk_bf16_f32 v89, v89, v89
    v_and_b32 v89, 0xffff0000, v89
    v_cvt_pk_bf16_f32 v90, v90, v90
    v_and_b32 v90, 0xffff0000, v90
    v_cvt_pk_bf16_f32 v91, v91, v91
    v_and_b32 v91, 0xffff0000, v91
    v_add_f32 v88, v128, v88
    v_add_f32 v89, v128, v89
    v_add_f32 v90, v128, v90
    v_add_f32 v91, v128, v91
    v_cvt_pk_bf16_f32 v88, v88, v88
    v_and_b32 v88, 0xffff0000, v88
    v_cvt_pk_bf16_f32 v89, v89, v89
    v_and_b32 v89, 0xffff0000, v89
    v_cvt_pk_bf16_f32 v90, v90, v90
    v_and_b32 v90, 0xffff0000, v90
    v_cvt_pk_bf16_f32 v91, v91, v91
    v_and_b32 v91, 0xffff0000, v91
    v_mul_f32 v88, 0x3e0293ee, v88
    v_mul_f32 v89, 0x3e0293ee, v89
    v_mul_f32 v90, 0x3e0293ee, v90
    v_mul_f32 v91, 0x3e0293ee, v91
    ds_write_b128 v129, v[88:91]
    s_waitcnt lgkmcnt(0)
    ds_read_b128 v[48:51], v130 offset:0
    ds_read_b128 v[64:67], v130 offset:512
    ds_read_b128 v[52:55], v130 offset:64
    ds_read_b128 v[68:71], v130 offset:576
    ds_read_b128 v[56:59], v130 offset:128
    ds_read_b128 v[72:75], v130 offset:640
    ds_read_b128 v[60:63], v130 offset:192
    ds_read_b128 v[76:79], v130 offset:704
    s_waitcnt lgkmcnt(4)
    v_pk_fma_f32 v[16:17], v[16:17], v[64:65], v[48:49]
    v_pk_fma_f32 v[18:19], v[18:19], v[66:67], v[50:51]
    v_pk_fma_f32 v[20:21], v[20:21], v[68:69], v[52:53]
    v_pk_fma_f32 v[22:23], v[22:23], v[70:71], v[54:55]
    v_cvt_pk_bf16_f32 v4, v16, v17
    v_cvt_pk_bf16_f32 v5, v18, v19
    v_cvt_pk_bf16_f32 v6, v20, v21
    v_cvt_pk_bf16_f32 v7, v22, v23
    buffer_store_dwordx4 v[4:7], v106, s[16:19], 0 offen offset:0 sc1
    s_waitcnt lgkmcnt(0)
    v_pk_fma_f32 v[24:25], v[24:25], v[72:73], v[56:57]
    v_pk_fma_f32 v[26:27], v[26:27], v[74:75], v[58:59]
    v_pk_fma_f32 v[28:29], v[28:29], v[76:77], v[60:61]
    v_pk_fma_f32 v[30:31], v[30:31], v[78:79], v[62:63]
    v_cvt_pk_bf16_f32 v8, v24, v25
    v_cvt_pk_bf16_f32 v9, v26, v27
    v_cvt_pk_bf16_f32 v10, v28, v29
    v_cvt_pk_bf16_f32 v11, v30, v31
    buffer_store_dwordx4 v[8:11], v106, s[16:19], 0 offen offset:1024 sc1
    s_add_u32 s68, s66, 3
    s_and_b32 s68, s68, 7
    s_lshl_b32 s67, s68, 14
    s_add_u32 s67, s67, s71
    s_add_u32 m0, s67, 16384
    s_lshl_b32 s67, s68, 19
    buffer_load_dwordx4 v190, s[12:15], s67 offen offset:0 lds
    s_add_u32 s67, s67, 31744
    buffer_load_dwordx4 v191, s[12:15], s67 offen offset:1024 lds
    s_add_u32 s67, s67, 31744
    buffer_load_dwordx4 v190, s[12:15], s67 offen offset:2048 lds
    s_add_u32 s67, s67, 31744
    buffer_load_dwordx4 v191, s[12:15], s67 offen offset:3072 lds
    s_add_u32 s68, s66, 4
    s_and_b32 s68, s68, 7
    s_lshl_b32 s67, s68, 14
    s_add_u32 s67, s67, s71
    s_add_u32 m0, s67, 16384
    s_lshl_b32 s67, s68, 19
    buffer_load_dwordx4 v190, s[12:15], s67 offen offset:0 lds
    s_add_u32 s67, s67, 31744
    buffer_load_dwordx4 v191, s[12:15], s67 offen offset:1024 lds
    s_add_u32 s67, s67, 31744
    buffer_load_dwordx4 v190, s[12:15], s67 offen offset:2048 lds
    s_add_u32 s67, s67, 31744
    buffer_load_dwordx4 v191, s[12:15], s67 offen offset:3072 lds
    s_waitcnt vmcnt(8)
    s_barrier
    buffer_store_dword v254, v125, s[40:43], 0 offen sc1
    s_add_u32 s68, s66, 5
    s_and_b32 s68, s68, 7
    s_lshl_b32 s67, s68, 14
    s_add_u32 s67, s67, s71
    s_add_u32 m0, s67, 16384
    s_lshl_b32 s67, s68, 19
    buffer_load_dwordx4 v190, s[12:15], s67 offen offset:0 lds
    s_add_u32 s67, s67, 31744
    buffer_load_dwordx4 v191, s[12:15], s67 offen offset:1024 lds
    s_add_u32 s67, s67, 31744
    buffer_load_dwordx4 v190, s[12:15], s67 offen offset:2048 lds
    s_add_u32 s67, s67, 31744
    buffer_load_dwordx4 v191, s[12:15], s67 offen offset:3072 lds
    s_add_u32 s68, s66, 6
    s_and_b32 s68, s68, 7
    s_lshl_b32 s67, s68, 14
    s_add_u32 s67, s67, s71
    s_add_u32 m0, s67, 16384
    s_lshl_b32 s67, s68, 19
    buffer_load_dwordx4 v190, s[12:15], s67 offen offset:0 lds
    s_add_u32 s67, s67, 31744
    buffer_load_dwordx4 v191, s[12:15], s67 offen offset:1024 lds
    s_add_u32 s67, s67, 31744
    buffer_load_dwordx4 v190, s[12:15], s67 offen offset:2048 lds
    s_add_u32 s67, s67, 31744
    buffer_load_dwordx4 v191, s[12:15], s67 offen offset:3072 lds
    s_add_u32 s68, s66, 7
    s_and_b32 s68, s68, 7
    s_lshl_b32 s67, s68, 14
    s_add_u32 s67, s67, s71
    s_add_u32 m0, s67, 16384
    s_lshl_b32 s67, s68, 19
    buffer_load_dwordx4 v190, s[12:15], s67 offen offset:0 lds
    s_add_u32 s67, s67, 31744
    buffer_load_dwordx4 v191, s[12:15], s67 offen offset:1024 lds
    s_add_u32 s67, s67, 31744
    buffer_load_dwordx4 v190, s[12:15], s67 offen offset:2048 lds
    s_add_u32 s67, s67, 31744
    buffer_load_dwordx4 v191, s[12:15], s67 offen offset:3072 lds
    s_lshl_b32 s68, s66, 11
    s_add_u32 s68, s68, 262144
    s_cmp_eq_u32 s64, 1
    s_cselect_b32 s68, s68, 0x100000
    v_and_b32 v125, 31, v218
    v_lshlrev_b32 v125, 4, v125
    v_add_u32 v125, s68, v125
    s_lshl_b32 s69, s2, 15
    s_and_b32 s70, s2, 3
    s_lshl_b32 s70, s70, 5
    s_lshr_b32 s67, s2, 2
    s_add_u32 s70, s70, s67
    s_lshl_b32 s70, s70, 12
    s_add_u32 s70, s70, 33554432
    s_mov_b32 s75, 1024
    s_mov_b32 s76, 1024
    s_mov_b32 s80, 524288
    s_mov_b32 s26, 32768
    s_cmp_lt_u32 s2, 128
    s_cbranch_scc1 L_j2
    s_sub_u32 s67, s2, 128
    s_lshl_b32 s69, s67, 15
    s_lshl_b32 s70, s67, 12
    s_add_u32 s70, s70, 37748736
    s_mov_b32 s80, 176128
    s_mov_b32 s56, s62
    s_mov_b32 s57, s63
    s_cmp_lt_u32 s2, 171
    s_cbranch_scc1 L_j2
    s_sub_u32 s67, s2, 171
    s_lshr_b32 s68, s67, 4
    s_and_b32 s67, s67, 15
    s_mul_i32 s69, s67, 88064
    s_lshl_b32 s70, s68, 10
    s_add_u32 s69, s69, s70
    s_lshl_b32 s70, s68, 9
    s_add_u32 s70, s70, s67
    s_lshl_b32 s70, s70, 10
    s_add_u32 s70, s70, 39845888
    s_mov_b32 s75, 2752
    s_mov_b32 s76, 16384
    s_mov_b32 s80, 65536
    s_mov_b32 s56, s60
    s_mov_b32 s57, s61
    s_sub_u32 s26, 1409024, s69
    s_cmp_lt_u32 s2, 219
    s_cbranch_scc1 L_j2
    s_mov_b32 s69, 0
    s_mov_b32 s70, 0
    s_mov_b32 s26, 0
    s_mov_b32 s80, 0
L_j2:
    s_add_u32 s24, s56, s69
    s_addc_u32 s25, s57, 0
    s_mov_b32 s27, 0x20000
    s_lshr_b32 s67, s64, 1
    s_mul_i32 s67, s80, s67
    s_add_u32 s70, s70, s67
    s_and_b32 s67, s64, 1
    s_mul_i32 s67, s76, s67
    s_lshl_b32 s67, s67, 1
    s_add_u32 s70, s70, s67
    s_add_u32 s32, s54, s70
    s_addc_u32 s33, s55, 0
    s_mul_i32 s34, s80, 7
    s_mov_b32 s35, 0x20000
    v_lshrrev_b32 v219, 4, v218
    v_and_b32 v220, 15, v218
    v_lshlrev_b32 v221, 1, v219
    v_xor_b32 v220, v220, v221
    s_lshl_b32 s67, s64, 3
    v_add_u32 v219, s67, v219
    v_mul_lo_u32 v219, v219, s75
    v_lshl_add_u32 v227, v220, 4, v219
    v_xor_b32 v220, 8, v220
    v_lshl_add_u32 v219, v220, 4, v219
    s_lshl_b32 s67, s75, 2
    s_sub_u32 s67, s67, 1024
    v_add_u32 v228, s67, v219
    v_lshrrev_b32 v219, 2, v218
    v_and_b32 v220, 7, v219
    v_lshlrev_b32 v220, 1, v220
    v_bfe_u32 v221, v218, 1, 1
    v_xor_b32 v220, v220, v221
    s_lshl_b32 s67, s64, 2
    v_xor_b32 v220, s67, v220
    v_lshlrev_b32 v220, 4, v220
    v_lshl_add_u32 v220, v219, 8, v220
    v_and_b32 v221, 1, v218
    v_lshl_add_u32 v220, v221, 3, v220
    v_add_u32 v252, 131072, v220
    v_xor_b32 v229, 32, v252
    s_lshl_b32 s80, s80, 1
    s_sub_u32 s75, 0, s80
    s_mov_b32 s81, 0
    s_lshl_b32 s74, s2, 2
    v_lshlrev_b32 v255, 20, v0
    s_lshl_b32 s67, s64, 16
    v_add_u32 v192, s67, v231
    v_add_u32 v193, 16384, v192
    v_add_u32 v194, 32768, v192
    v_add_u32 v195, 49152, v192
    v_lshlrev_b32 v181, 4, v0
    s_add_u32 s36, s54, 30408704
    s_addc_u32 s37, s55, 0
    s_mov_b32 s38, 0x2800
    s_mov_b32 s39, 0x20000
    s_lshl_b32 s67, s2, 6
    v_lshrrev_b32 v219, 4, v218
    v_mul_u32_u24 v219, 12288, v219
    v_and_b32 v220, 15, v218
    v_lshl_add_u32 v219, v220, 2, v219
    v_add_u32 v249, s67, v219
    s_sub_u32 s72, s2, 64
    s_lshr_b32 s67, s72, 5
    s_cmp_eq_u32 s67, 2
    s_cselect_b32 s68, 1.0, 0
    v_mov_b32 v1, s68
    v_lshrrev_b32 v219, 4, v0
    v_lshlrev_b32 v219, 20, v219
    v_lshl_add_u32 v250, v220, 2, v219
    s_lshl_b32 s68, s72, 6
    s_cmp_lt_u32 s67, 4
    s_cselect_b32 s68, s68, 0x100000
    v_add_u32 v250, s68, v250
    v_lshrrev_b32 v251, 2, v220
    v_lshl_add_u32 v219, v251, 4, v219
    v_and_b32 v251, 3, v220
    v_lshl_add_u32 v251, v251, 1, v219
    s_bfe_u32 s68, s72, 0x40001
    s_lshl_b32 s68, s68, 6
    s_and_b32 s72, s72, 1
    s_lshl_b32 s72, s72, 3
    s_add_u32 s68, s68, s72
    s_sub_u32 s67, 2, s67
    s_lshl_b32 s72, s67, 10
    s_add_u32 s68, s68, s72
    s_add_u32 s68, s68, 8192
    s_cmp_lt_u32 s67, 2
    s_cselect_b32 s68, s68, 0x100000
    v_add_u32 v251, s68, v251
    v_add_u32 v182, 65536, v186
    v_add_u32 v183, 65536, v187
    v_add_u32 v184, 65536, v188
    v_add_u32 v185, 65536, v189
    s_cmp_lg_u32 s64, 1
    s_cbranch_scc1 L_h0_ok
    s_mov_b32 s72, 0
L_h0_spin:
    buffer_load_dword v222, v125, s[40:43], 0 offen offset:0 sc1
    s_waitcnt vmcnt(0)
    v_xor_b32 v222, s82, v222
    v_cmp_ne_u32 vcc, 0, v222
    s_add_u32 s72, s72, 1
    s_and_b32 s67, vcc_lo, 0xffffffff
    s_cmp_eq_u32 s67, 0
    s_cbranch_scc1 L_h0_ok
    s_sleep 2
    s_cmp_lt_u32 s72, 400000
    s_cbranch_scc1 L_h0_spin
L_h0_ok:
    s_waitcnt vmcnt(0)
    s_barrier
    s_mov_b32 s79, 6144
    buffer_load_dwordx4 a[0:3], v192, s[16:19], s79 offen offset:0 sc1
    buffer_load_dwordx4 a[4:7], v193, s[16:19], s79 offen offset:0 sc1
    buffer_load_dwordx4 a[8:11], v194, s[16:19], s79 offen offset:0 sc1
    buffer_load_dwordx4 a[12:15], v195, s[16:19], s79 offen offset:0 sc1
    buffer_load_dwordx4 a[16:19], v192, s[16:19], s79 offen offset:1024 sc1
    buffer_load_dwordx4 a[20:23], v193, s[16:19], s79 offen offset:1024 sc1
    buffer_load_dwordx4 a[24:27], v194, s[16:19], s79 offen offset:1024 sc1
    buffer_load_dwordx4 a[28:31], v195, s[16:19], s79 offen offset:1024 sc1
    ds_read_b64_tr_b16 a[128:129], v182 offset:0
    ds_read_b64_tr_b16 a[130:131], v182 offset:4096
    ds_read_b64_tr_b16 a[160:161], v182 offset:8192
    ds_read_b64_tr_b16 a[162:163], v182 offset:12288
    ds_read_b64_tr_b16 a[132:133], v182 offset:8
    ds_read_b64_tr_b16 a[134:135], v182 offset:4104
    ds_read_b64_tr_b16 a[164:165], v182 offset:8200
    ds_read_b64_tr_b16 a[166:167], v182 offset:12296
    ds_read_b64_tr_b16 a[136:137], v183 offset:0
    ds_read_b64_tr_b16 a[138:139], v183 offset:4096
    ds_read_b64_tr_b16 a[168:169], v183 offset:8192
    ds_read_b64_tr_b16 a[170:171], v183 offset:12288
    ds_read_b64_tr_b16 a[140:141], v183 offset:8
    ds_read_b64_tr_b16 a[142:143], v183 offset:4104
    ds_read_b64_tr_b16 a[172:173], v183 offset:8200
    ds_read_b64_tr_b16 a[174:175], v183 offset:12296
    ds_read_b64_tr_b16 a[144:145], v184 offset:0
    ds_read_b64_tr_b16 a[146:147], v184 offset:4096
    ds_read_b64_tr_b16 a[176:177], v184 offset:8192
    ds_read_b64_tr_b16 a[178:179], v184 offset:12288
    ds_read_b64_tr_b16 a[148:149], v184 offset:8
    ds_read_b64_tr_b16 a[150:151], v184 offset:4104
    ds_read_b64_tr_b16 a[180:181], v184 offset:8200
    ds_read_b64_tr_b16 a[182:183], v184 offset:12296
    ds_read_b64_tr_b16 a[152:153], v185 offset:0
    ds_read_b64_tr_b16 a[154:155], v185 offset:4096
    ds_read_b64_tr_b16 a[184:185], v185 offset:8192
    ds_read_b64_tr_b16 a[186:187], v185 offset:12288
    ds_read_b64_tr_b16 a[156:157], v185 offset:8
    ds_read_b64_tr_b16 a[158:159], v185 offset:4104
    ds_read_b64_tr_b16 a[188:189], v185 offset:8200
    ds_read_b64_tr_b16 a[190:191], v185 offset:12296
    s_waitcnt vmcnt(0) lgkmcnt(0)
    s_waitcnt vmcnt(0) lgkmcnt(0)
    v_mfma_f32_16x16x32_bf16 v[4:7], a[128:131], a[0:3], 0
    v_mfma_f32_16x16x32_bf16 v[4:7], a[160:163], a[16:19], v[4:7]
    v_mfma_f32_16x16x32_bf16 v[8:11], a[160:163], a[20:23], 0
    s_mov_b32 s79, 0
    buffer_load_dwordx4 a[32:35], v192, s[16:19], s79 offen offset:0 sc1
    v_mfma_f32_16x16x32_bf16 v[8:11], a[128:131], a[4:7], v[8:11]
    v_mfma_f32_16x16x32_bf16 v[12:15], a[128:131], a[8:11], 0
    buffer_load_dwordx4 a[36:39], v193, s[16:19], s79 offen offset:0 sc1
    v_mfma_f32_16x16x32_bf16 v[12:15], a[160:163], a[24:27], v[12:15]
    v_mfma_f32_16x16x32_bf16 v[16:19], a[160:163], a[28:31], 0
    v_add_u32 v182, 16384, v186
    v_mfma_f32_16x16x32_bf16 v[16:19], a[128:131], a[12:15], v[16:19]
    ds_read_b64_tr_b16 a[128:129], v182 offset:0
    v_mfma_f32_16x16x32_bf16 v[32:35], a[132:135], a[12:15], 0
    buffer_load_dwordx4 a[40:43], v194, s[16:19], s79 offen offset:0 sc1
    v_mfma_f32_16x16x32_bf16 v[32:35], a[164:167], a[28:31], v[32:35]
    ds_read_b64_tr_b16 a[130:131], v182 offset:4096
    v_mfma_f32_16x16x32_bf16 v[28:31], a[164:167], a[24:27], 0
    v_mfma_f32_16x16x32_bf16 v[28:31], a[132:135], a[8:11], v[28:31]
    ds_read_b64_tr_b16 a[160:161], v182 offset:8192
    v_mfma_f32_16x16x32_bf16 v[24:27], a[132:135], a[4:7], 0
    buffer_load_dwordx4 a[44:47], v195, s[16:19], s79 offen offset:0 sc1
    v_mfma_f32_16x16x32_bf16 v[24:27], a[164:167], a[20:23], v[24:27]
    ds_read_b64_tr_b16 a[162:163], v182 offset:12288
    v_mfma_f32_16x16x32_bf16 v[20:23], a[164:167], a[16:19], 0
    v_mfma_f32_16x16x32_bf16 v[20:23], a[132:135], a[0:3], v[20:23]
    ds_read_b64_tr_b16 a[132:133], v182 offset:8
    v_mfma_f32_16x16x32_bf16 v[36:39], a[136:139], a[0:3], 0
    buffer_load_dwordx4 a[48:51], v192, s[16:19], s79 offen offset:1024 sc1
    v_mfma_f32_16x16x32_bf16 v[36:39], a[168:171], a[16:19], v[36:39]
    ds_read_b64_tr_b16 a[134:135], v182 offset:4104
    v_mfma_f32_16x16x32_bf16 v[40:43], a[168:171], a[20:23], 0
    v_mfma_f32_16x16x32_bf16 v[40:43], a[136:139], a[4:7], v[40:43]
    ds_read_b64_tr_b16 a[164:165], v182 offset:8200
    v_mfma_f32_16x16x32_bf16 v[44:47], a[136:139], a[8:11], 0
    buffer_load_dwordx4 a[52:55], v193, s[16:19], s79 offen offset:1024 sc1
    v_mfma_f32_16x16x32_bf16 v[44:47], a[168:171], a[24:27], v[44:47]
    ds_read_b64_tr_b16 a[166:167], v182 offset:12296
    v_mfma_f32_16x16x32_bf16 v[48:51], a[168:171], a[28:31], 0
    v_add_u32 v183, 16384, v187
    v_mfma_f32_16x16x32_bf16 v[48:51], a[136:139], a[12:15], v[48:51]
    ds_read_b64_tr_b16 a[136:137], v183 offset:0
    v_mfma_f32_16x16x32_bf16 v[64:67], a[140:143], a[12:15], 0
    buffer_load_dwordx4 a[56:59], v194, s[16:19], s79 offen offset:1024 sc1
    v_mfma_f32_16x16x32_bf16 v[64:67], a[172:175], a[28:31], v[64:67]
    ds_read_b64_tr_b16 a[138:139], v183 offset:4096
    v_mfma_f32_16x16x32_bf16 v[60:63], a[172:175], a[24:27], 0
    v_mfma_f32_16x16x32_bf16 v[60:63], a[140:143], a[8:11], v[60:63]
    ds_read_b64_tr_b16 a[168:169], v183 offset:8192
    v_mfma_f32_16x16x32_bf16 v[56:59], a[140:143], a[4:7], 0
    buffer_load_dwordx4 a[60:63], v195, s[16:19], s79 offen offset:1024 sc1
    v_mfma_f32_16x16x32_bf16 v[56:59], a[172:175], a[20:23], v[56:59]
    ds_read_b64_tr_b16 a[170:171], v183 offset:12288
    v_mfma_f32_16x16x32_bf16 v[52:55], a[172:175], a[16:19], 0
    v_mfma_f32_16x16x32_bf16 v[52:55], a[140:143], a[0:3], v[52:55]
    ds_read_b64_tr_b16 a[140:141], v183 offset:8
    s_waitcnt vmcnt(63) lgkmcnt(13)
    v_mfma_f32_16x16x32_bf16 v[68:71], a[144:147], a[0:3], 0
    v_mfma_f32_16x16x32_bf16 v[68:71], a[176:179], a[16:19], v[68:71]
    ds_read_b64_tr_b16 a[142:143], v183 offset:4104
    v_mfma_f32_16x16x32_bf16 v[72:75], a[176:179], a[20:23], 0
    s_mov_b32 s79, 8192
    buffer_load_dwordx4 a[64:67], v192, s[16:19], s79 offen offset:0 sc1
    v_mfma_f32_16x16x32_bf16 v[72:75], a[144:147], a[4:7], v[72:75]
    ds_read_b64_tr_b16 a[172:173], v183 offset:8200
    v_mfma_f32_16x16x32_bf16 v[76:79], a[144:147], a[8:11], 0
    buffer_load_dwordx4 a[68:71], v193, s[16:19], s79 offen offset:0 sc1
    v_mfma_f32_16x16x32_bf16 v[76:79], a[176:179], a[24:27], v[76:79]
    ds_read_b64_tr_b16 a[174:175], v183 offset:12296
    v_mfma_f32_16x16x32_bf16 v[80:83], a[176:179], a[28:31], 0
    v_add_u32 v184, 16384, v188
    v_mfma_f32_16x16x32_bf16 v[80:83], a[144:147], a[12:15], v[80:83]
    ds_read_b64_tr_b16 a[144:145], v184 offset:0
    v_mfma_f32_16x16x32_bf16 v[96:99], a[148:151], a[12:15], 0
    buffer_load_dwordx4 a[72:75], v194, s[16:19], s79 offen offset:0 sc1
    v_mfma_f32_16x16x32_bf16 v[96:99], a[180:183], a[28:31], v[96:99]
    ds_read_b64_tr_b16 a[146:147], v184 offset:4096
    v_mfma_f32_16x16x32_bf16 v[92:95], a[180:183], a[24:27], 0
    v_mfma_f32_16x16x32_bf16 v[92:95], a[148:151], a[8:11], v[92:95]
    ds_read_b64_tr_b16 a[176:177], v184 offset:8192
    v_mfma_f32_16x16x32_bf16 v[88:91], a[148:151], a[4:7], 0
    buffer_load_dwordx4 a[76:79], v195, s[16:19], s79 offen offset:0 sc1
    v_mfma_f32_16x16x32_bf16 v[88:91], a[180:183], a[20:23], v[88:91]
    ds_read_b64_tr_b16 a[178:179], v184 offset:12288
    v_mfma_f32_16x16x32_bf16 v[84:87], a[180:183], a[16:19], 0
    v_mfma_f32_16x16x32_bf16 v[84:87], a[148:151], a[0:3], v[84:87]
    ds_read_b64_tr_b16 a[148:149], v184 offset:8
    v_mfma_f32_16x16x32_bf16 v[100:103], a[152:155], a[0:3], 0
    buffer_load_dwordx4 a[80:83], v192, s[16:19], s79 offen offset:1024 sc1
    v_mfma_f32_16x16x32_bf16 v[100:103], a[184:187], a[16:19], v[100:103]
    ds_read_b64_tr_b16 a[150:151], v184 offset:4104
    v_mfma_f32_16x16x32_bf16 v[104:107], a[184:187], a[20:23], 0
    v_mfma_f32_16x16x32_bf16 v[104:107], a[152:155], a[4:7], v[104:107]
    ds_read_b64_tr_b16 a[180:181], v184 offset:8200
    v_mfma_f32_16x16x32_bf16 v[108:111], a[152:155], a[8:11], 0
    buffer_load_dwordx4 a[84:87], v193, s[16:19], s79 offen offset:1024 sc1
    v_mfma_f32_16x16x32_bf16 v[108:111], a[184:187], a[24:27], v[108:111]
    ds_read_b64_tr_b16 a[182:183], v184 offset:12296
    v_mfma_f32_16x16x32_bf16 v[112:115], a[184:187], a[28:31], 0
    v_add_u32 v185, 16384, v189
    v_mfma_f32_16x16x32_bf16 v[112:115], a[152:155], a[12:15], v[112:115]
    ds_read_b64_tr_b16 a[152:153], v185 offset:0
    v_mfma_f32_16x16x32_bf16 v[128:131], a[156:159], a[12:15], 0
    buffer_load_dwordx4 a[88:91], v194, s[16:19], s79 offen offset:1024 sc1
    v_mfma_f32_16x16x32_bf16 v[128:131], a[188:191], a[28:31], v[128:131]
    ds_read_b64_tr_b16 a[154:155], v185 offset:4096
    v_mfma_f32_16x16x32_bf16 v[124:127], a[188:191], a[24:27], 0
    v_mfma_f32_16x16x32_bf16 v[124:127], a[156:159], a[8:11], v[124:127]
    ds_read_b64_tr_b16 a[184:185], v185 offset:8192
    v_mfma_f32_16x16x32_bf16 v[120:123], a[156:159], a[4:7], 0
    buffer_load_dwordx4 a[92:95], v195, s[16:19], s79 offen offset:1024 sc1
    v_mfma_f32_16x16x32_bf16 v[120:123], a[188:191], a[20:23], v[120:123]
    ds_read_b64_tr_b16 a[186:187], v185 offset:12288
    v_mfma_f32_16x16x32_bf16 v[116:119], a[188:191], a[16:19], 0
    v_mfma_f32_16x16x32_bf16 v[116:119], a[156:159], a[0:3], v[116:119]
    ds_read_b64_tr_b16 a[156:157], v185 offset:8
    s_waitcnt vmcnt(8) lgkmcnt(13)
    v_mfma_f32_16x16x32_bf16 v[4:7], a[128:131], a[32:35], v[4:7]
    v_mfma_f32_16x16x32_bf16 v[4:7], a[160:163], a[48:51], v[4:7]
    ds_read_b64_tr_b16 a[158:159], v185 offset:4104
    v_mfma_f32_16x16x32_bf16 v[8:11], a[160:163], a[52:55], v[8:11]
    s_mov_b32 s79, 2048
    buffer_load_dwordx4 a[96:99], v192, s[16:19], s79 offen offset:0 sc1
    v_mfma_f32_16x16x32_bf16 v[8:11], a[128:131], a[36:39], v[8:11]
    ds_read_b64_tr_b16 a[188:189], v185 offset:8200
    v_mfma_f32_16x16x32_bf16 v[12:15], a[128:131], a[40:43], v[12:15]
    buffer_load_dwordx4 a[100:103], v193, s[16:19], s79 offen offset:0 sc1
    v_mfma_f32_16x16x32_bf16 v[12:15], a[160:163], a[56:59], v[12:15]
    ds_read_b64_tr_b16 a[190:191], v185 offset:12296
    v_mfma_f32_16x16x32_bf16 v[16:19], a[160:163], a[60:63], v[16:19]
    v_add_u32 v182, 81920, v186
    v_mfma_f32_16x16x32_bf16 v[16:19], a[128:131], a[44:47], v[16:19]
    ds_read_b64_tr_b16 a[128:129], v182 offset:0
    v_mfma_f32_16x16x32_bf16 v[32:35], a[132:135], a[44:47], v[32:35]
    buffer_load_dwordx4 a[104:107], v194, s[16:19], s79 offen offset:0 sc1
    v_mfma_f32_16x16x32_bf16 v[32:35], a[164:167], a[60:63], v[32:35]
    ds_read_b64_tr_b16 a[130:131], v182 offset:4096
    v_mfma_f32_16x16x32_bf16 v[28:31], a[164:167], a[56:59], v[28:31]
    v_mfma_f32_16x16x32_bf16 v[28:31], a[132:135], a[40:43], v[28:31]
    ds_read_b64_tr_b16 a[160:161], v182 offset:8192
    v_mfma_f32_16x16x32_bf16 v[24:27], a[132:135], a[36:39], v[24:27]
    buffer_load_dwordx4 a[108:111], v195, s[16:19], s79 offen offset:0 sc1
    v_mfma_f32_16x16x32_bf16 v[24:27], a[164:167], a[52:55], v[24:27]
    ds_read_b64_tr_b16 a[162:163], v182 offset:12288
    v_mfma_f32_16x16x32_bf16 v[20:23], a[164:167], a[48:51], v[20:23]
    v_mfma_f32_16x16x32_bf16 v[20:23], a[132:135], a[32:35], v[20:23]
    ds_read_b64_tr_b16 a[132:133], v182 offset:8
    v_mfma_f32_16x16x32_bf16 v[36:39], a[136:139], a[32:35], v[36:39]
    buffer_load_dwordx4 a[112:115], v192, s[16:19], s79 offen offset:1024 sc1
    v_mfma_f32_16x16x32_bf16 v[36:39], a[168:171], a[48:51], v[36:39]
    ds_read_b64_tr_b16 a[134:135], v182 offset:4104
    v_mfma_f32_16x16x32_bf16 v[40:43], a[168:171], a[52:55], v[40:43]
    v_mfma_f32_16x16x32_bf16 v[40:43], a[136:139], a[36:39], v[40:43]
    ds_read_b64_tr_b16 a[164:165], v182 offset:8200
    v_mfma_f32_16x16x32_bf16 v[44:47], a[136:139], a[40:43], v[44:47]
    buffer_load_dwordx4 a[116:119], v193, s[16:19], s79 offen offset:1024 sc1
    v_mfma_f32_16x16x32_bf16 v[44:47], a[168:171], a[56:59], v[44:47]
    ds_read_b64_tr_b16 a[166:167], v182 offset:12296
    v_mfma_f32_16x16x32_bf16 v[48:51], a[168:171], a[60:63], v[48:51]
    v_add_u32 v183, 81920, v187
    v_mfma_f32_16x16x32_bf16 v[48:51], a[136:139], a[44:47], v[48:51]
    ds_read_b64_tr_b16 a[136:137], v183 offset:0
    v_mfma_f32_16x16x32_bf16 v[64:67], a[140:143], a[44:47], v[64:67]
    buffer_load_dwordx4 a[120:123], v194, s[16:19], s79 offen offset:1024 sc1
    v_mfma_f32_16x16x32_bf16 v[64:67], a[172:175], a[60:63], v[64:67]
    ds_read_b64_tr_b16 a[138:139], v183 offset:4096
    v_mfma_f32_16x16x32_bf16 v[60:63], a[172:175], a[56:59], v[60:63]
    v_mfma_f32_16x16x32_bf16 v[60:63], a[140:143], a[40:43], v[60:63]
    ds_read_b64_tr_b16 a[168:169], v183 offset:8192
    v_mfma_f32_16x16x32_bf16 v[56:59], a[140:143], a[36:39], v[56:59]
    buffer_load_dwordx4 a[124:127], v195, s[16:19], s79 offen offset:1024 sc1
    v_mfma_f32_16x16x32_bf16 v[56:59], a[172:175], a[52:55], v[56:59]
    ds_read_b64_tr_b16 a[170:171], v183 offset:12288
    v_mfma_f32_16x16x32_bf16 v[52:55], a[172:175], a[48:51], v[52:55]
    v_mfma_f32_16x16x32_bf16 v[52:55], a[140:143], a[32:35], v[52:55]
    ds_read_b64_tr_b16 a[140:141], v183 offset:8
    s_waitcnt vmcnt(63) lgkmcnt(13)
    v_mfma_f32_16x16x32_bf16 v[68:71], a[144:147], a[32:35], v[68:71]
    v_mfma_f32_16x16x32_bf16 v[68:71], a[176:179], a[48:51], v[68:71]
    ds_read_b64_tr_b16 a[142:143], v183 offset:4104
    v_mfma_f32_16x16x32_bf16 v[72:75], a[176:179], a[52:55], v[72:75]
    s_mov_b32 s79, 10240
    buffer_load_dwordx4 a[0:3], v192, s[16:19], s79 offen offset:0 sc1
    v_mfma_f32_16x16x32_bf16 v[72:75], a[144:147], a[36:39], v[72:75]
    ds_read_b64_tr_b16 a[172:173], v183 offset:8200
    v_mfma_f32_16x16x32_bf16 v[76:79], a[144:147], a[40:43], v[76:79]
    buffer_load_dwordx4 a[4:7], v193, s[16:19], s79 offen offset:0 sc1
    v_mfma_f32_16x16x32_bf16 v[76:79], a[176:179], a[56:59], v[76:79]
    ds_read_b64_tr_b16 a[174:175], v183 offset:12296
    v_mfma_f32_16x16x32_bf16 v[80:83], a[176:179], a[60:63], v[80:83]
    v_add_u32 v184, 81920, v188
    v_mfma_f32_16x16x32_bf16 v[80:83], a[144:147], a[44:47], v[80:83]
    ds_read_b64_tr_b16 a[144:145], v184 offset:0
    v_mfma_f32_16x16x32_bf16 v[96:99], a[148:151], a[44:47], v[96:99]
    buffer_load_dwordx4 a[8:11], v194, s[16:19], s79 offen offset:0 sc1
    v_mfma_f32_16x16x32_bf16 v[96:99], a[180:183], a[60:63], v[96:99]
    ds_read_b64_tr_b16 a[146:147], v184 offset:4096
    v_mfma_f32_16x16x32_bf16 v[92:95], a[180:183], a[56:59], v[92:95]
    v_mfma_f32_16x16x32_bf16 v[92:95], a[148:151], a[40:43], v[92:95]
    ds_read_b64_tr_b16 a[176:177], v184 offset:8192
    v_mfma_f32_16x16x32_bf16 v[88:91], a[148:151], a[36:39], v[88:91]
    buffer_load_dwordx4 a[12:15], v195, s[16:19], s79 offen offset:0 sc1
    v_mfma_f32_16x16x32_bf16 v[88:91], a[180:183], a[52:55], v[88:91]
    ds_read_b64_tr_b16 a[178:179], v184 offset:12288
    v_mfma_f32_16x16x32_bf16 v[84:87], a[180:183], a[48:51], v[84:87]
    v_mfma_f32_16x16x32_bf16 v[84:87], a[148:151], a[32:35], v[84:87]
    ds_read_b64_tr_b16 a[148:149], v184 offset:8
    v_mfma_f32_16x16x32_bf16 v[100:103], a[152:155], a[32:35], v[100:103]
    buffer_load_dwordx4 a[16:19], v192, s[16:19], s79 offen offset:1024 sc1
    v_mfma_f32_16x16x32_bf16 v[100:103], a[184:187], a[48:51], v[100:103]
    ds_read_b64_tr_b16 a[150:151], v184 offset:4104
    v_mfma_f32_16x16x32_bf16 v[104:107], a[184:187], a[52:55], v[104:107]
    v_mfma_f32_16x16x32_bf16 v[104:107], a[152:155], a[36:39], v[104:107]
    ds_read_b64_tr_b16 a[180:181], v184 offset:8200
    v_mfma_f32_16x16x32_bf16 v[108:111], a[152:155], a[40:43], v[108:111]
    buffer_load_dwordx4 a[20:23], v193, s[16:19], s79 offen offset:1024 sc1
    v_mfma_f32_16x16x32_bf16 v[108:111], a[184:187], a[56:59], v[108:111]
    ds_read_b64_tr_b16 a[182:183], v184 offset:12296
    v_mfma_f32_16x16x32_bf16 v[112:115], a[184:187], a[60:63], v[112:115]
    v_add_u32 v185, 81920, v189
    v_mfma_f32_16x16x32_bf16 v[112:115], a[152:155], a[44:47], v[112:115]
    ds_read_b64_tr_b16 a[152:153], v185 offset:0
    v_mfma_f32_16x16x32_bf16 v[128:131], a[156:159], a[44:47], v[128:131]
    buffer_load_dwordx4 a[24:27], v194, s[16:19], s79 offen offset:1024 sc1
    v_mfma_f32_16x16x32_bf16 v[128:131], a[188:191], a[60:63], v[128:131]
    ds_read_b64_tr_b16 a[154:155], v185 offset:4096
    v_mfma_f32_16x16x32_bf16 v[124:127], a[188:191], a[56:59], v[124:127]
    v_mfma_f32_16x16x32_bf16 v[124:127], a[156:159], a[40:43], v[124:127]
    ds_read_b64_tr_b16 a[184:185], v185 offset:8192
    v_mfma_f32_16x16x32_bf16 v[120:123], a[156:159], a[36:39], v[120:123]
    buffer_load_dwordx4 a[28:31], v195, s[16:19], s79 offen offset:1024 sc1
    v_mfma_f32_16x16x32_bf16 v[120:123], a[188:191], a[52:55], v[120:123]
    ds_read_b64_tr_b16 a[186:187], v185 offset:12288
    v_mfma_f32_16x16x32_bf16 v[116:119], a[188:191], a[48:51], v[116:119]
    v_mfma_f32_16x16x32_bf16 v[116:119], a[156:159], a[32:35], v[116:119]
    ds_read_b64_tr_b16 a[156:157], v185 offset:8
    s_waitcnt vmcnt(16) lgkmcnt(13)
    v_mfma_f32_16x16x32_bf16 v[4:7], a[128:131], a[64:67], v[4:7]
    v_mfma_f32_16x16x32_bf16 v[4:7], a[160:163], a[80:83], v[4:7]
    ds_read_b64_tr_b16 a[158:159], v185 offset:4104
    v_mfma_f32_16x16x32_bf16 v[8:11], a[160:163], a[84:87], v[8:11]
    s_mov_b32 s79, 4096
    buffer_load_dwordx4 a[32:35], v192, s[16:19], s79 offen offset:0 sc1
    v_mfma_f32_16x16x32_bf16 v[8:11], a[128:131], a[68:71], v[8:11]
    ds_read_b64_tr_b16 a[188:189], v185 offset:8200
    v_mfma_f32_16x16x32_bf16 v[12:15], a[128:131], a[72:75], v[12:15]
    v_mfma_f32_16x16x32_bf16 v[12:15], a[160:163], a[88:91], v[12:15]
    ds_read_b64_tr_b16 a[190:191], v185 offset:12296
    v_mfma_f32_16x16x32_bf16 v[16:19], a[160:163], a[92:95], v[16:19]
    v_add_u32 v182, 32768, v186
    v_mfma_f32_16x16x32_bf16 v[16:19], a[128:131], a[76:79], v[16:19]
    ds_read_b64_tr_b16 a[128:129], v182 offset:0
    v_mfma_f32_16x16x32_bf16 v[32:35], a[132:135], a[76:79], v[32:35]
    buffer_load_dwordx4 a[36:39], v193, s[16:19], s79 offen offset:0 sc1
    v_mfma_f32_16x16x32_bf16 v[32:35], a[164:167], a[92:95], v[32:35]
    ds_read_b64_tr_b16 a[130:131], v182 offset:4096
    v_mfma_f32_16x16x32_bf16 v[28:31], a[164:167], a[88:91], v[28:31]
    v_mfma_f32_16x16x32_bf16 v[28:31], a[132:135], a[72:75], v[28:31]
    ds_read_b64_tr_b16 a[160:161], v182 offset:8192
    v_mfma_f32_16x16x32_bf16 v[24:27], a[132:135], a[68:71], v[24:27]
    v_mfma_f32_16x16x32_bf16 v[24:27], a[164:167], a[84:87], v[24:27]
    ds_read_b64_tr_b16 a[162:163], v182 offset:12288
    v_mfma_f32_16x16x32_bf16 v[20:23], a[164:167], a[80:83], v[20:23]
    v_mfma_f32_16x16x32_bf16 v[20:23], a[132:135], a[64:67], v[20:23]
    ds_read_b64_tr_b16 a[132:133], v182 offset:8
    v_mfma_f32_16x16x32_bf16 v[36:39], a[136:139], a[64:67], v[36:39]
    buffer_load_dwordx4 a[40:43], v194, s[16:19], s79 offen offset:0 sc1
    v_mfma_f32_16x16x32_bf16 v[36:39], a[168:171], a[80:83], v[36:39]
    ds_read_b64_tr_b16 a[134:135], v182 offset:4104
    v_mfma_f32_16x16x32_bf16 v[40:43], a[168:171], a[84:87], v[40:43]
    v_mfma_f32_16x16x32_bf16 v[40:43], a[136:139], a[68:71], v[40:43]
    ds_read_b64_tr_b16 a[164:165], v182 offset:8200
    v_mfma_f32_16x16x32_bf16 v[44:47], a[136:139], a[72:75], v[44:47]
    v_mfma_f32_16x16x32_bf16 v[44:47], a[168:171], a[88:91], v[44:47]
    ds_read_b64_tr_b16 a[166:167], v182 offset:12296
    v_mfma_f32_16x16x32_bf16 v[48:51], a[168:171], a[92:95], v[48:51]
    v_add_u32 v183, 32768, v187
    v_mfma_f32_16x16x32_bf16 v[48:51], a[136:139], a[76:79], v[48:51]
    ds_read_b64_tr_b16 a[136:137], v183 offset:0
    v_mfma_f32_16x16x32_bf16 v[64:67], a[140:143], a[76:79], v[64:67]
    buffer_load_dwordx4 a[44:47], v195, s[16:19], s79 offen offset:0 sc1
    v_mfma_f32_16x16x32_bf16 v[64:67], a[172:175], a[92:95], v[64:67]
    ds_read_b64_tr_b16 a[138:139], v183 offset:4096
    v_mfma_f32_16x16x32_bf16 v[60:63], a[172:175], a[88:91], v[60:63]
    v_mfma_f32_16x16x32_bf16 v[60:63], a[140:143], a[72:75], v[60:63]
    ds_read_b64_tr_b16 a[168:169], v183 offset:8192
    v_mfma_f32_16x16x32_bf16 v[56:59], a[140:143], a[68:71], v[56:59]
    v_mfma_f32_16x16x32_bf16 v[56:59], a[172:175], a[84:87], v[56:59]
    ds_read_b64_tr_b16 a[170:171], v183 offset:12288
    v_mfma_f32_16x16x32_bf16 v[52:55], a[172:175], a[80:83], v[52:55]
    v_mfma_f32_16x16x32_bf16 v[52:55], a[140:143], a[64:67], v[52:55]
    ds_read_b64_tr_b16 a[140:141], v183 offset:8
    s_waitcnt vmcnt(63) lgkmcnt(13)
    v_mfma_f32_16x16x32_bf16 v[68:71], a[144:147], a[64:67], v[68:71]
    v_mfma_f32_16x16x32_bf16 v[68:71], a[176:179], a[80:83], v[68:71]
    ds_read_b64_tr_b16 a[142:143], v183 offset:4104
    v_mfma_f32_16x16x32_bf16 v[72:75], a[176:179], a[84:87], v[72:75]
    buffer_load_dwordx4 a[48:51], v192, s[16:19], s79 offen offset:1024 sc1
    v_mfma_f32_16x16x32_bf16 v[72:75], a[144:147], a[68:71], v[72:75]
    ds_read_b64_tr_b16 a[172:173], v183 offset:8200
    v_mfma_f32_16x16x32_bf16 v[76:79], a[144:147], a[72:75], v[76:79]
    v_mfma_f32_16x16x32_bf16 v[76:79], a[176:179], a[88:91], v[76:79]
    ds_read_b64_tr_b16 a[174:175], v183 offset:12296
    v_mfma_f32_16x16x32_bf16 v[80:83], a[176:179], a[92:95], v[80:83]
    v_add_u32 v184, 32768, v188
    v_mfma_f32_16x16x32_bf16 v[80:83], a[144:147], a[76:79], v[80:83]
    ds_read_b64_tr_b16 a[144:145], v184 offset:0
    v_mfma_f32_16x16x32_bf16 v[96:99], a[148:151], a[76:79], v[96:99]
    buffer_load_dwordx4 a[52:55], v193, s[16:19], s79 offen offset:1024 sc1
    v_mfma_f32_16x16x32_bf16 v[96:99], a[180:183], a[92:95], v[96:99]
    ds_read_b64_tr_b16 a[146:147], v184 offset:4096
    v_mfma_f32_16x16x32_bf16 v[92:95], a[180:183], a[88:91], v[92:95]
    v_mfma_f32_16x16x32_bf16 v[92:95], a[148:151], a[72:75], v[92:95]
    ds_read_b64_tr_b16 a[176:177], v184 offset:8192
    v_mfma_f32_16x16x32_bf16 v[88:91], a[148:151], a[68:71], v[88:91]
    v_mfma_f32_16x16x32_bf16 v[88:91], a[180:183], a[84:87], v[88:91]
    ds_read_b64_tr_b16 a[178:179], v184 offset:12288
    v_mfma_f32_16x16x32_bf16 v[84:87], a[180:183], a[80:83], v[84:87]
    v_mfma_f32_16x16x32_bf16 v[84:87], a[148:151], a[64:67], v[84:87]
    ds_read_b64_tr_b16 a[148:149], v184 offset:8
    v_mfma_f32_16x16x32_bf16 v[100:103], a[152:155], a[64:67], v[100:103]
    buffer_load_dwordx4 a[56:59], v194, s[16:19], s79 offen offset:1024 sc1
    v_mfma_f32_16x16x32_bf16 v[100:103], a[184:187], a[80:83], v[100:103]
    ds_read_b64_tr_b16 a[150:151], v184 offset:4104
    v_mfma_f32_16x16x32_bf16 v[104:107], a[184:187], a[84:87], v[104:107]
    v_mfma_f32_16x16x32_bf16 v[104:107], a[152:155], a[68:71], v[104:107]
    ds_read_b64_tr_b16 a[180:181], v184 offset:8200
    v_mfma_f32_16x16x32_bf16 v[108:111], a[152:155], a[72:75], v[108:111]
    v_mfma_f32_16x16x32_bf16 v[108:111], a[184:187], a[88:91], v[108:111]
    ds_read_b64_tr_b16 a[182:183], v184 offset:12296
    v_mfma_f32_16x16x32_bf16 v[112:115], a[184:187], a[92:95], v[112:115]
    v_add_u32 v185, 32768, v189
    v_mfma_f32_16x16x32_bf16 v[112:115], a[152:155], a[76:79], v[112:115]
    ds_read_b64_tr_b16 a[152:153], v185 offset:0
    v_mfma_f32_16x16x32_bf16 v[128:131], a[156:159], a[76:79], v[128:131]
    buffer_load_dwordx4 a[60:63], v195, s[16:19], s79 offen offset:1024 sc1
    v_mfma_f32_16x16x32_bf16 v[128:131], a[188:191], a[92:95], v[128:131]
    ds_read_b64_tr_b16 a[154:155], v185 offset:4096
    v_mfma_f32_16x16x32_bf16 v[124:127], a[188:191], a[88:91], v[124:127]
    v_mfma_f32_16x16x32_bf16 v[124:127], a[156:159], a[72:75], v[124:127]
    ds_read_b64_tr_b16 a[184:185], v185 offset:8192
    v_mfma_f32_16x16x32_bf16 v[120:123], a[156:159], a[68:71], v[120:123]
    v_mfma_f32_16x16x32_bf16 v[120:123], a[188:191], a[84:87], v[120:123]
    ds_read_b64_tr_b16 a[186:187], v185 offset:12288
    v_mfma_f32_16x16x32_bf16 v[116:119], a[188:191], a[80:83], v[116:119]
    v_mfma_f32_16x16x32_bf16 v[116:119], a[156:159], a[64:67], v[116:119]
    ds_read_b64_tr_b16 a[156:157], v185 offset:8
    s_waitcnt vmcnt(16) lgkmcnt(13)
    v_mfma_f32_16x16x32_bf16 v[4:7], a[128:131], a[96:99], v[4:7]
    v_mfma_f32_16x16x32_bf16 v[4:7], a[160:163], a[112:115], v[4:7]
    ds_read_b64_tr_b16 a[158:159], v185 offset:4104
    v_mfma_f32_16x16x32_bf16 v[8:11], a[160:163], a[116:119], v[8:11]
    s_mov_b32 s79, 12288
    buffer_load_dwordx4 a[64:67], v192, s[16:19], s79 offen offset:0 sc1
    v_mfma_f32_16x16x32_bf16 v[8:11], a[128:131], a[100:103], v[8:11]
    ds_read_b64_tr_b16 a[188:189], v185 offset:8200
    v_mfma_f32_16x16x32_bf16 v[12:15], a[128:131], a[104:107], v[12:15]
    v_mfma_f32_16x16x32_bf16 v[12:15], a[160:163], a[120:123], v[12:15]
    ds_read_b64_tr_b16 a[190:191], v185 offset:12296
    v_mfma_f32_16x16x32_bf16 v[16:19], a[160:163], a[124:127], v[16:19]
    v_add_u32 v182, 98304, v186
    v_mfma_f32_16x16x32_bf16 v[16:19], a[128:131], a[108:111], v[16:19]
    ds_read_b64_tr_b16 a[128:129], v182 offset:0
    v_mfma_f32_16x16x32_bf16 v[32:35], a[132:135], a[108:111], v[32:35]
    buffer_load_dwordx4 a[68:71], v193, s[16:19], s79 offen offset:0 sc1
    v_mfma_f32_16x16x32_bf16 v[32:35], a[164:167], a[124:127], v[32:35]
    ds_read_b64_tr_b16 a[130:131], v182 offset:4096
    v_mfma_f32_16x16x32_bf16 v[28:31], a[164:167], a[120:123], v[28:31]
    v_mfma_f32_16x16x32_bf16 v[28:31], a[132:135], a[104:107], v[28:31]
    ds_read_b64_tr_b16 a[160:161], v182 offset:8192
    v_mfma_f32_16x16x32_bf16 v[24:27], a[132:135], a[100:103], v[24:27]
    v_mfma_f32_16x16x32_bf16 v[24:27], a[164:167], a[116:119], v[24:27]
    ds_read_b64_tr_b16 a[162:163], v182 offset:12288
    v_mfma_f32_16x16x32_bf16 v[20:23], a[164:167], a[112:115], v[20:23]
    v_mfma_f32_16x16x32_bf16 v[20:23], a[132:135], a[96:99], v[20:23]
    ds_read_b64_tr_b16 a[132:133], v182 offset:8
    v_mfma_f32_16x16x32_bf16 v[36:39], a[136:139], a[96:99], v[36:39]
    buffer_load_dwordx4 a[72:75], v194, s[16:19], s79 offen offset:0 sc1
    v_mfma_f32_16x16x32_bf16 v[36:39], a[168:171], a[112:115], v[36:39]
    ds_read_b64_tr_b16 a[134:135], v182 offset:4104
    v_mfma_f32_16x16x32_bf16 v[40:43], a[168:171], a[116:119], v[40:43]
    v_mfma_f32_16x16x32_bf16 v[40:43], a[136:139], a[100:103], v[40:43]
    ds_read_b64_tr_b16 a[164:165], v182 offset:8200
    v_mfma_f32_16x16x32_bf16 v[44:47], a[136:139], a[104:107], v[44:47]
    v_mfma_f32_16x16x32_bf16 v[44:47], a[168:171], a[120:123], v[44:47]
    ds_read_b64_tr_b16 a[166:167], v182 offset:12296
    v_mfma_f32_16x16x32_bf16 v[48:51], a[168:171], a[124:127], v[48:51]
    v_add_u32 v183, 98304, v187
    v_mfma_f32_16x16x32_bf16 v[48:51], a[136:139], a[108:111], v[48:51]
    ds_read_b64_tr_b16 a[136:137], v183 offset:0
    v_mfma_f32_16x16x32_bf16 v[64:67], a[140:143], a[108:111], v[64:67]
    buffer_load_dwordx4 a[76:79], v195, s[16:19], s79 offen offset:0 sc1
    v_mfma_f32_16x16x32_bf16 v[64:67], a[172:175], a[124:127], v[64:67]
    ds_read_b64_tr_b16 a[138:139], v183 offset:4096
    v_mfma_f32_16x16x32_bf16 v[60:63], a[172:175], a[120:123], v[60:63]
    v_mfma_f32_16x16x32_bf16 v[60:63], a[140:143], a[104:107], v[60:63]
    ds_read_b64_tr_b16 a[168:169], v183 offset:8192
    v_mfma_f32_16x16x32_bf16 v[56:59], a[140:143], a[100:103], v[56:59]
    v_mfma_f32_16x16x32_bf16 v[56:59], a[172:175], a[116:119], v[56:59]
    ds_read_b64_tr_b16 a[170:171], v183 offset:12288
    v_mfma_f32_16x16x32_bf16 v[52:55], a[172:175], a[112:115], v[52:55]
    v_mfma_f32_16x16x32_bf16 v[52:55], a[140:143], a[96:99], v[52:55]
    ds_read_b64_tr_b16 a[140:141], v183 offset:8
    s_waitcnt vmcnt(63) lgkmcnt(13)
    v_mfma_f32_16x16x32_bf16 v[68:71], a[144:147], a[96:99], v[68:71]
    s_barrier
    v_mfma_f32_16x16x32_bf16 v[68:71], a[176:179], a[112:115], v[68:71]
    ds_read_b64_tr_b16 a[142:143], v183 offset:4104
    v_mfma_f32_16x16x32_bf16 v[72:75], a[176:179], a[116:119], v[72:75]
    buffer_load_dwordx4 a[80:83], v192, s[16:19], s79 offen offset:1024 sc1
    v_mfma_f32_16x16x32_bf16 v[72:75], a[144:147], a[100:103], v[72:75]
    ds_read_b64_tr_b16 a[172:173], v183 offset:8200
    v_mfma_f32_16x16x32_bf16 v[76:79], a[144:147], a[104:107], v[76:79]
    v_mfma_f32_16x16x32_bf16 v[76:79], a[176:179], a[120:123], v[76:79]
    ds_read_b64_tr_b16 a[174:175], v183 offset:12296
    v_mfma_f32_16x16x32_bf16 v[80:83], a[176:179], a[124:127], v[80:83]
    v_add_u32 v184, 98304, v188
    v_mfma_f32_16x16x32_bf16 v[80:83], a[144:147], a[108:111], v[80:83]
    ds_read_b64_tr_b16 a[144:145], v184 offset:0
    v_mfma_f32_16x16x32_bf16 v[96:99], a[148:151], a[108:111], v[96:99]
    buffer_load_dwordx4 a[84:87], v193, s[16:19], s79 offen offset:1024 sc1
    v_mfma_f32_16x16x32_bf16 v[96:99], a[180:183], a[124:127], v[96:99]
    ds_read_b64_tr_b16 a[146:147], v184 offset:4096
    v_mfma_f32_16x16x32_bf16 v[92:95], a[180:183], a[120:123], v[92:95]
    v_mfma_f32_16x16x32_bf16 v[92:95], a[148:151], a[104:107], v[92:95]
    ds_read_b64_tr_b16 a[176:177], v184 offset:8192
    v_mfma_f32_16x16x32_bf16 v[88:91], a[148:151], a[100:103], v[88:91]
    v_mfma_f32_16x16x32_bf16 v[88:91], a[180:183], a[116:119], v[88:91]
    ds_read_b64_tr_b16 a[178:179], v184 offset:12288
    v_mfma_f32_16x16x32_bf16 v[84:87], a[180:183], a[112:115], v[84:87]
    v_mfma_f32_16x16x32_bf16 v[84:87], a[148:151], a[96:99], v[84:87]
    ds_read_b64_tr_b16 a[148:149], v184 offset:8
    v_mfma_f32_16x16x32_bf16 v[100:103], a[152:155], a[96:99], v[100:103]
    buffer_load_dwordx4 a[88:91], v194, s[16:19], s79 offen offset:1024 sc1
    v_mfma_f32_16x16x32_bf16 v[100:103], a[184:187], a[112:115], v[100:103]
    ds_read_b64_tr_b16 a[150:151], v184 offset:4104
    v_mfma_f32_16x16x32_bf16 v[104:107], a[184:187], a[116:119], v[104:107]
    v_mfma_f32_16x16x32_bf16 v[104:107], a[152:155], a[100:103], v[104:107]
    ds_read_b64_tr_b16 a[180:181], v184 offset:8200
    v_mfma_f32_16x16x32_bf16 v[108:111], a[152:155], a[104:107], v[108:111]
    v_mfma_f32_16x16x32_bf16 v[108:111], a[184:187], a[120:123], v[108:111]
    ds_read_b64_tr_b16 a[182:183], v184 offset:12296
    v_mfma_f32_16x16x32_bf16 v[112:115], a[184:187], a[124:127], v[112:115]
    v_add_u32 v185, 98304, v189
    v_mfma_f32_16x16x32_bf16 v[112:115], a[152:155], a[108:111], v[112:115]
    ds_read_b64_tr_b16 a[152:153], v185 offset:0
    v_mfma_f32_16x16x32_bf16 v[128:131], a[156:159], a[108:111], v[128:131]
    buffer_load_dwordx4 a[92:95], v195, s[16:19], s79 offen offset:1024 sc1
    v_mfma_f32_16x16x32_bf16 v[128:131], a[188:191], a[124:127], v[128:131]
    ds_read_b64_tr_b16 a[154:155], v185 offset:4096
    v_mfma_f32_16x16x32_bf16 v[124:127], a[188:191], a[120:123], v[124:127]
    v_mfma_f32_16x16x32_bf16 v[124:127], a[156:159], a[104:107], v[124:127]
    ds_read_b64_tr_b16 a[184:185], v185 offset:8192
    v_mfma_f32_16x16x32_bf16 v[120:123], a[156:159], a[100:103], v[120:123]
    v_mfma_f32_16x16x32_bf16 v[120:123], a[188:191], a[116:119], v[120:123]
    ds_read_b64_tr_b16 a[186:187], v185 offset:12288
    v_mfma_f32_16x16x32_bf16 v[116:119], a[188:191], a[112:115], v[116:119]
    v_mfma_f32_16x16x32_bf16 v[116:119], a[156:159], a[96:99], v[116:119]
    ds_read_b64_tr_b16 a[156:157], v185 offset:8
    s_waitcnt vmcnt(16) lgkmcnt(13)
    v_mfma_f32_16x16x32_bf16 v[4:7], a[128:131], a[0:3], v[4:7]
    v_mfma_f32_16x16x32_bf16 v[4:7], a[160:163], a[16:19], v[4:7]
    ds_read_b64_tr_b16 a[158:159], v185 offset:4104
    v_mfma_f32_16x16x32_bf16 v[8:11], a[160:163], a[20:23], v[8:11]
    buffer_load_dword v248, v249, s[28:31], 0 offen sc1
    v_mfma_f32_16x16x32_bf16 v[8:11], a[128:131], a[4:7], v[8:11]
    ds_read_b64_tr_b16 a[188:189], v185 offset:8200
    v_mfma_f32_16x16x32_bf16 v[12:15], a[128:131], a[8:11], v[12:15]
    v_mfma_f32_16x16x32_bf16 v[12:15], a[160:163], a[24:27], v[12:15]
    ds_read_b64_tr_b16 a[190:191], v185 offset:12296
    v_mfma_f32_16x16x32_bf16 v[16:19], a[160:163], a[28:31], v[16:19]
    v_add_u32 v182, 49152, v186
    v_mfma_f32_16x16x32_bf16 v[16:19], a[128:131], a[12:15], v[16:19]
    ds_read_b64_tr_b16 a[128:129], v182 offset:0
    v_mfma_f32_16x16x32_bf16 v[32:35], a[132:135], a[12:15], v[32:35]
    s_mov_b32 s79, 14336
    buffer_load_dwordx4 a[96:99], v192, s[16:19], s79 offen offset:0 sc1
    v_mfma_f32_16x16x32_bf16 v[32:35], a[164:167], a[28:31], v[32:35]
    ds_read_b64_tr_b16 a[130:131], v182 offset:4096
    v_mfma_f32_16x16x32_bf16 v[28:31], a[164:167], a[24:27], v[28:31]
    v_mfma_f32_16x16x32_bf16 v[28:31], a[132:135], a[8:11], v[28:31]
    ds_read_b64_tr_b16 a[160:161], v182 offset:8192
    v_mfma_f32_16x16x32_bf16 v[24:27], a[132:135], a[4:7], v[24:27]
    v_mfma_f32_16x16x32_bf16 v[24:27], a[164:167], a[20:23], v[24:27]
    ds_read_b64_tr_b16 a[162:163], v182 offset:12288
    v_mfma_f32_16x16x32_bf16 v[20:23], a[164:167], a[16:19], v[20:23]
    buffer_load_dwordx4 a[100:103], v193, s[16:19], s79 offen offset:0 sc1
    v_mfma_f32_16x16x32_bf16 v[20:23], a[132:135], a[0:3], v[20:23]
    ds_read_b64_tr_b16 a[132:133], v182 offset:8
    v_mfma_f32_16x16x32_bf16 v[36:39], a[136:139], a[0:3], v[36:39]
    v_mfma_f32_16x16x32_bf16 v[36:39], a[168:171], a[16:19], v[36:39]
    ds_read_b64_tr_b16 a[134:135], v182 offset:4104
    v_mfma_f32_16x16x32_bf16 v[40:43], a[168:171], a[20:23], v[40:43]
    v_mfma_f32_16x16x32_bf16 v[40:43], a[136:139], a[4:7], v[40:43]
    ds_read_b64_tr_b16 a[164:165], v182 offset:8200
    v_mfma_f32_16x16x32_bf16 v[44:47], a[136:139], a[8:11], v[44:47]
    buffer_load_dwordx4 a[104:107], v194, s[16:19], s79 offen offset:0 sc1
    v_mfma_f32_16x16x32_bf16 v[44:47], a[168:171], a[24:27], v[44:47]
    ds_read_b64_tr_b16 a[166:167], v182 offset:12296
    v_mfma_f32_16x16x32_bf16 v[48:51], a[168:171], a[28:31], v[48:51]
    v_add_u32 v183, 49152, v187
    v_mfma_f32_16x16x32_bf16 v[48:51], a[136:139], a[12:15], v[48:51]
    ds_read_b64_tr_b16 a[136:137], v183 offset:0
    v_mfma_f32_16x16x32_bf16 v[64:67], a[140:143], a[12:15], v[64:67]
    v_mfma_f32_16x16x32_bf16 v[64:67], a[172:175], a[28:31], v[64:67]
    ds_read_b64_tr_b16 a[138:139], v183 offset:4096
    v_mfma_f32_16x16x32_bf16 v[60:63], a[172:175], a[24:27], v[60:63]
    buffer_load_dwordx4 a[108:111], v195, s[16:19], s79 offen offset:0 sc1
    v_mfma_f32_16x16x32_bf16 v[60:63], a[140:143], a[8:11], v[60:63]
    ds_read_b64_tr_b16 a[168:169], v183 offset:8192
    v_mfma_f32_16x16x32_bf16 v[56:59], a[140:143], a[4:7], v[56:59]
    v_mfma_f32_16x16x32_bf16 v[56:59], a[172:175], a[20:23], v[56:59]
    ds_read_b64_tr_b16 a[170:171], v183 offset:12288
    v_mfma_f32_16x16x32_bf16 v[52:55], a[172:175], a[16:19], v[52:55]
    v_mfma_f32_16x16x32_bf16 v[52:55], a[140:143], a[0:3], v[52:55]
    ds_read_b64_tr_b16 a[140:141], v183 offset:8
    s_waitcnt vmcnt(63) lgkmcnt(13)
    v_mfma_f32_16x16x32_bf16 v[68:71], a[144:147], a[0:3], v[68:71]
    v_mfma_f32_16x16x32_bf16 v[68:71], a[176:179], a[16:19], v[68:71]
    ds_read_b64_tr_b16 a[142:143], v183 offset:4104
    v_mfma_f32_16x16x32_bf16 v[72:75], a[176:179], a[20:23], v[72:75]
    buffer_load_dwordx4 a[112:115], v192, s[16:19], s79 offen offset:1024 sc1
    v_mfma_f32_16x16x32_bf16 v[72:75], a[144:147], a[4:7], v[72:75]
    ds_read_b64_tr_b16 a[172:173], v183 offset:8200
    v_mfma_f32_16x16x32_bf16 v[76:79], a[144:147], a[8:11], v[76:79]
    buffer_load_dwordx4 a[116:119], v193, s[16:19], s79 offen offset:1024 sc1
    v_mfma_f32_16x16x32_bf16 v[76:79], a[176:179], a[24:27], v[76:79]
    ds_read_b64_tr_b16 a[174:175], v183 offset:12296
    v_mfma_f32_16x16x32_bf16 v[80:83], a[176:179], a[28:31], v[80:83]
    v_add_u32 v184, 49152, v188
    v_mfma_f32_16x16x32_bf16 v[80:83], a[144:147], a[12:15], v[80:83]
    ds_read_b64_tr_b16 a[144:145], v184 offset:0
    v_mfma_f32_16x16x32_bf16 v[96:99], a[148:151], a[12:15], v[96:99]
    buffer_load_dwordx4 a[120:123], v194, s[16:19], s79 offen offset:1024 sc1
    v_mfma_f32_16x16x32_bf16 v[96:99], a[180:183], a[28:31], v[96:99]
    ds_read_b64_tr_b16 a[146:147], v184 offset:4096
    v_mfma_f32_16x16x32_bf16 v[92:95], a[180:183], a[24:27], v[92:95]
    v_mfma_f32_16x16x32_bf16 v[92:95], a[148:151], a[8:11], v[92:95]
    ds_read_b64_tr_b16 a[176:177], v184 offset:8192
    v_mfma_f32_16x16x32_bf16 v[88:91], a[148:151], a[4:7], v[88:91]
    buffer_load_dwordx4 a[124:127], v195, s[16:19], s79 offen offset:1024 sc1
    v_mfma_f32_16x16x32_bf16 v[88:91], a[180:183], a[20:23], v[88:91]
    ds_read_b64_tr_b16 a[178:179], v184 offset:12288
    v_mfma_f32_16x16x32_bf16 v[84:87], a[180:183], a[16:19], v[84:87]
    v_mfma_f32_16x16x32_bf16 v[84:87], a[148:151], a[0:3], v[84:87]
    ds_read_b64_tr_b16 a[148:149], v184 offset:8
    v_mfma_f32_16x16x32_bf16 v[100:103], a[152:155], a[0:3], v[100:103]
    s_add_u32 m0, s71, 0
    s_mov_b32 s67, 0
    buffer_load_dwordx4 v212, s[4:7], s67 offen offset:0 lds
    v_mfma_f32_16x16x32_bf16 v[100:103], a[184:187], a[16:19], v[100:103]
    ds_read_b64_tr_b16 a[150:151], v184 offset:4104
    v_mfma_f32_16x16x32_bf16 v[104:107], a[184:187], a[20:23], v[104:107]
    v_mfma_f32_16x16x32_bf16 v[104:107], a[152:155], a[4:7], v[104:107]
    ds_read_b64_tr_b16 a[180:181], v184 offset:8200
    v_mfma_f32_16x16x32_bf16 v[108:111], a[152:155], a[8:11], v[108:111]
    buffer_load_dwordx4 v213, s[4:7], s67 offen offset:1024 lds
    v_mfma_f32_16x16x32_bf16 v[108:111], a[184:187], a[24:27], v[108:111]
    ds_read_b64_tr_b16 a[182:183], v184 offset:12296
    v_mfma_f32_16x16x32_bf16 v[112:115], a[184:187], a[28:31], v[112:115]
    v_add_u32 v185, 49152, v189
    v_mfma_f32_16x16x32_bf16 v[112:115], a[152:155], a[12:15], v[112:115]
    ds_read_b64_tr_b16 a[152:153], v185 offset:0
    v_mfma_f32_16x16x32_bf16 v[128:131], a[156:159], a[12:15], v[128:131]
    buffer_load_dwordx4 v214, s[4:7], s67 offen offset:2048 lds
    v_mfma_f32_16x16x32_bf16 v[128:131], a[188:191], a[28:31], v[128:131]
    ds_read_b64_tr_b16 a[154:155], v185 offset:4096
    v_mfma_f32_16x16x32_bf16 v[124:127], a[188:191], a[24:27], v[124:127]
    v_mfma_f32_16x16x32_bf16 v[124:127], a[156:159], a[8:11], v[124:127]
    ds_read_b64_tr_b16 a[184:185], v185 offset:8192
    v_mfma_f32_16x16x32_bf16 v[120:123], a[156:159], a[4:7], v[120:123]
    buffer_load_dwordx4 v215, s[4:7], s67 offen offset:3072 lds
    v_mfma_f32_16x16x32_bf16 v[120:123], a[188:191], a[20:23], v[120:123]
    ds_read_b64_tr_b16 a[186:187], v185 offset:12288
    v_mfma_f32_16x16x32_bf16 v[116:119], a[188:191], a[16:19], v[116:119]
    v_mfma_f32_16x16x32_bf16 v[116:119], a[156:159], a[0:3], v[116:119]
    ds_read_b64_tr_b16 a[156:157], v185 offset:8
    s_waitcnt vmcnt(21) lgkmcnt(13)
    v_mfma_f32_16x16x32_bf16 v[4:7], a[128:131], a[32:35], v[4:7]
    v_mfma_f32_16x16x32_bf16 v[4:7], a[160:163], a[48:51], v[4:7]
    ds_read_b64_tr_b16 a[158:159], v185 offset:4104
    v_mfma_f32_16x16x32_bf16 v[8:11], a[160:163], a[52:55], v[8:11]
    s_add_u32 m0, s71, 65536
    s_mov_b32 s67, 0
    buffer_load_dwordx4 v216, s[8:11], s67 offen offset:0 lds
    v_mfma_f32_16x16x32_bf16 v[8:11], a[128:131], a[36:39], v[8:11]
    ds_read_b64_tr_b16 a[188:189], v185 offset:8200
    v_mfma_f32_16x16x32_bf16 v[12:15], a[128:131], a[40:43], v[12:15]
    v_mfma_f32_16x16x32_bf16 v[12:15], a[160:163], a[56:59], v[12:15]
    ds_read_b64_tr_b16 a[190:191], v185 offset:12296
    v_mfma_f32_16x16x32_bf16 v[16:19], a[160:163], a[60:63], v[16:19]
    v_add_u32 v182, 114688, v186
    v_mfma_f32_16x16x32_bf16 v[16:19], a[128:131], a[44:47], v[16:19]
    ds_read_b64_tr_b16 a[128:129], v182 offset:0
    v_mfma_f32_16x16x32_bf16 v[32:35], a[132:135], a[44:47], v[32:35]
    buffer_load_dwordx4 v217, s[8:11], s67 offen offset:1024 lds
    v_mfma_f32_16x16x32_bf16 v[32:35], a[164:167], a[60:63], v[32:35]
    ds_read_b64_tr_b16 a[130:131], v182 offset:4096
    v_mfma_f32_16x16x32_bf16 v[28:31], a[164:167], a[56:59], v[28:31]
    v_mfma_f32_16x16x32_bf16 v[28:31], a[132:135], a[40:43], v[28:31]
    ds_read_b64_tr_b16 a[160:161], v182 offset:8192
    v_mfma_f32_16x16x32_bf16 v[24:27], a[132:135], a[36:39], v[24:27]
    v_mfma_f32_16x16x32_bf16 v[24:27], a[164:167], a[52:55], v[24:27]
    ds_read_b64_tr_b16 a[162:163], v182 offset:12288
    v_mfma_f32_16x16x32_bf16 v[20:23], a[164:167], a[48:51], v[20:23]
    v_mfma_f32_16x16x32_bf16 v[20:23], a[132:135], a[32:35], v[20:23]
    ds_read_b64_tr_b16 a[132:133], v182 offset:8
    v_mfma_f32_16x16x32_bf16 v[36:39], a[136:139], a[32:35], v[36:39]
    buffer_load_dwordx4 v216, s[8:11], s67 offen offset:2048 lds
    v_mfma_f32_16x16x32_bf16 v[36:39], a[168:171], a[48:51], v[36:39]
    ds_read_b64_tr_b16 a[134:135], v182 offset:4104
    v_mfma_f32_16x16x32_bf16 v[40:43], a[168:171], a[52:55], v[40:43]
    v_mfma_f32_16x16x32_bf16 v[40:43], a[136:139], a[36:39], v[40:43]
    ds_read_b64_tr_b16 a[164:165], v182 offset:8200
    v_mfma_f32_16x16x32_bf16 v[44:47], a[136:139], a[40:43], v[44:47]
    v_mfma_f32_16x16x32_bf16 v[44:47], a[168:171], a[56:59], v[44:47]
    ds_read_b64_tr_b16 a[166:167], v182 offset:12296
    v_mfma_f32_16x16x32_bf16 v[48:51], a[168:171], a[60:63], v[48:51]
    v_add_u32 v183, 114688, v187
    v_mfma_f32_16x16x32_bf16 v[48:51], a[136:139], a[44:47], v[48:51]
    ds_read_b64_tr_b16 a[136:137], v183 offset:0
    v_mfma_f32_16x16x32_bf16 v[64:67], a[140:143], a[44:47], v[64:67]
    buffer_load_dwordx4 v217, s[8:11], s67 offen offset:3072 lds
    v_mfma_f32_16x16x32_bf16 v[64:67], a[172:175], a[60:63], v[64:67]
    ds_read_b64_tr_b16 a[138:139], v183 offset:4096
    v_mfma_f32_16x16x32_bf16 v[60:63], a[172:175], a[56:59], v[60:63]
    v_mfma_f32_16x16x32_bf16 v[60:63], a[140:143], a[40:43], v[60:63]
    ds_read_b64_tr_b16 a[168:169], v183 offset:8192
    v_mfma_f32_16x16x32_bf16 v[56:59], a[140:143], a[36:39], v[56:59]
    v_mfma_f32_16x16x32_bf16 v[56:59], a[172:175], a[52:55], v[56:59]
    ds_read_b64_tr_b16 a[170:171], v183 offset:12288
    v_mfma_f32_16x16x32_bf16 v[52:55], a[172:175], a[48:51], v[52:55]
    v_mfma_f32_16x16x32_bf16 v[52:55], a[140:143], a[32:35], v[52:55]
    ds_read_b64_tr_b16 a[140:141], v183 offset:8
    s_waitcnt vmcnt(63) lgkmcnt(13)
    v_mfma_f32_16x16x32_bf16 v[68:71], a[144:147], a[32:35], v[68:71]
    s_barrier
    v_mfma_f32_16x16x32_bf16 v[68:71], a[176:179], a[48:51], v[68:71]
    ds_read_b64_tr_b16 a[142:143], v183 offset:4104
    v_mfma_f32_16x16x32_bf16 v[72:75], a[176:179], a[52:55], v[72:75]
    s_add_u32 m0, s71, 16384
    s_mov_b32 s67, 16384
    buffer_load_dwordx4 v212, s[4:7], s67 offen offset:0 lds
    v_mfma_f32_16x16x32_bf16 v[72:75], a[144:147], a[36:39], v[72:75]
    ds_read_b64_tr_b16 a[172:173], v183 offset:8200
    v_mfma_f32_16x16x32_bf16 v[76:79], a[144:147], a[40:43], v[76:79]
    v_mfma_f32_16x16x32_bf16 v[76:79], a[176:179], a[56:59], v[76:79]
    ds_read_b64_tr_b16 a[174:175], v183 offset:12296
    v_mfma_f32_16x16x32_bf16 v[80:83], a[176:179], a[60:63], v[80:83]
    v_add_u32 v184, 114688, v188
    v_mfma_f32_16x16x32_bf16 v[80:83], a[144:147], a[44:47], v[80:83]
    ds_read_b64_tr_b16 a[144:145], v184 offset:0
    v_mfma_f32_16x16x32_bf16 v[96:99], a[148:151], a[44:47], v[96:99]
    buffer_load_dwordx4 v213, s[4:7], s67 offen offset:1024 lds
    v_mfma_f32_16x16x32_bf16 v[96:99], a[180:183], a[60:63], v[96:99]
    ds_read_b64_tr_b16 a[146:147], v184 offset:4096
    v_mfma_f32_16x16x32_bf16 v[92:95], a[180:183], a[56:59], v[92:95]
    v_mfma_f32_16x16x32_bf16 v[92:95], a[148:151], a[40:43], v[92:95]
    ds_read_b64_tr_b16 a[176:177], v184 offset:8192
    v_mfma_f32_16x16x32_bf16 v[88:91], a[148:151], a[36:39], v[88:91]
    v_mfma_f32_16x16x32_bf16 v[88:91], a[180:183], a[52:55], v[88:91]
    ds_read_b64_tr_b16 a[178:179], v184 offset:12288
    v_mfma_f32_16x16x32_bf16 v[84:87], a[180:183], a[48:51], v[84:87]
    v_mfma_f32_16x16x32_bf16 v[84:87], a[148:151], a[32:35], v[84:87]
    ds_read_b64_tr_b16 a[148:149], v184 offset:8
    v_mfma_f32_16x16x32_bf16 v[100:103], a[152:155], a[32:35], v[100:103]
    buffer_load_dwordx4 v214, s[4:7], s67 offen offset:2048 lds
    v_mfma_f32_16x16x32_bf16 v[100:103], a[184:187], a[48:51], v[100:103]
    ds_read_b64_tr_b16 a[150:151], v184 offset:4104
    v_mfma_f32_16x16x32_bf16 v[104:107], a[184:187], a[52:55], v[104:107]
    v_mfma_f32_16x16x32_bf16 v[104:107], a[152:155], a[36:39], v[104:107]
    ds_read_b64_tr_b16 a[180:181], v184 offset:8200
    v_mfma_f32_16x16x32_bf16 v[108:111], a[152:155], a[40:43], v[108:111]
    v_mfma_f32_16x16x32_bf16 v[108:111], a[184:187], a[56:59], v[108:111]
    ds_read_b64_tr_b16 a[182:183], v184 offset:12296
    v_mfma_f32_16x16x32_bf16 v[112:115], a[184:187], a[60:63], v[112:115]
    v_add_u32 v185, 114688, v189
    v_mfma_f32_16x16x32_bf16 v[112:115], a[152:155], a[44:47], v[112:115]
    ds_read_b64_tr_b16 a[152:153], v185 offset:0
    v_mfma_f32_16x16x32_bf16 v[128:131], a[156:159], a[44:47], v[128:131]
    buffer_load_dwordx4 v215, s[4:7], s67 offen offset:3072 lds
    v_mfma_f32_16x16x32_bf16 v[128:131], a[188:191], a[60:63], v[128:131]
    ds_read_b64_tr_b16 a[154:155], v185 offset:4096
    v_mfma_f32_16x16x32_bf16 v[124:127], a[188:191], a[56:59], v[124:127]
    v_mfma_f32_16x16x32_bf16 v[124:127], a[156:159], a[40:43], v[124:127]
    ds_read_b64_tr_b16 a[184:185], v185 offset:8192
    v_mfma_f32_16x16x32_bf16 v[120:123], a[156:159], a[36:39], v[120:123]
    v_mfma_f32_16x16x32_bf16 v[120:123], a[188:191], a[52:55], v[120:123]
    ds_read_b64_tr_b16 a[186:187], v185 offset:12288
    v_mfma_f32_16x16x32_bf16 v[116:119], a[188:191], a[48:51], v[116:119]
    v_mfma_f32_16x16x32_bf16 v[116:119], a[156:159], a[32:35], v[116:119]
    ds_read_b64_tr_b16 a[156:157], v185 offset:8
    s_waitcnt vmcnt(21) lgkmcnt(13)
    v_mfma_f32_16x16x32_bf16 v[4:7], a[128:131], a[64:67], v[4:7]
    v_mfma_f32_16x16x32_bf16 v[4:7], a[160:163], a[80:83], v[4:7]
    ds_read_b64_tr_b16 a[158:159], v185 offset:4104
    v_mfma_f32_16x16x32_bf16 v[8:11], a[160:163], a[84:87], v[8:11]
    s_add_u32 m0, s71, 81920
    s_mov_b32 s67, 16384
    buffer_load_dwordx4 v216, s[8:11], s67 offen offset:0 lds
    v_mfma_f32_16x16x32_bf16 v[8:11], a[128:131], a[68:71], v[8:11]
    ds_read_b64_tr_b16 a[188:189], v185 offset:8200
    v_mfma_f32_16x16x32_bf16 v[12:15], a[128:131], a[72:75], v[12:15]
    v_mfma_f32_16x16x32_bf16 v[12:15], a[160:163], a[88:91], v[12:15]
    ds_read_b64_tr_b16 a[190:191], v185 offset:12296
    v_mfma_f32_16x16x32_bf16 v[16:19], a[160:163], a[92:95], v[16:19]
    v_add_u32 v182, 131072, v186
    v_mfma_f32_16x16x32_bf16 v[16:19], a[128:131], a[76:79], v[16:19]
    ds_read_b64_tr_b16 a[128:129], v182 offset:0
    v_mfma_f32_16x16x32_bf16 v[32:35], a[132:135], a[76:79], v[32:35]
    buffer_load_dwordx4 v217, s[8:11], s67 offen offset:1024 lds
    v_mfma_f32_16x16x32_bf16 v[32:35], a[164:167], a[92:95], v[32:35]
    ds_read_b64_tr_b16 a[130:131], v182 offset:4096
    v_mfma_f32_16x16x32_bf16 v[28:31], a[164:167], a[88:91], v[28:31]
    v_mfma_f32_16x16x32_bf16 v[28:31], a[132:135], a[72:75], v[28:31]
    ds_read_b64_tr_b16 a[160:161], v182 offset:8192
    v_mfma_f32_16x16x32_bf16 v[24:27], a[132:135], a[68:71], v[24:27]
    v_mfma_f32_16x16x32_bf16 v[24:27], a[164:167], a[84:87], v[24:27]
    ds_read_b64_tr_b16 a[162:163], v182 offset:12288
    v_mfma_f32_16x16x32_bf16 v[20:23], a[164:167], a[80:83], v[20:23]
    v_mfma_f32_16x16x32_bf16 v[20:23], a[132:135], a[64:67], v[20:23]
    ds_read_b64_tr_b16 a[132:133], v182 offset:8
    v_mfma_f32_16x16x32_bf16 v[36:39], a[136:139], a[64:67], v[36:39]
    buffer_load_dwordx4 v216, s[8:11], s67 offen offset:2048 lds
    v_mfma_f32_16x16x32_bf16 v[36:39], a[168:171], a[80:83], v[36:39]
    ds_read_b64_tr_b16 a[134:135], v182 offset:4104
    v_mfma_f32_16x16x32_bf16 v[40:43], a[168:171], a[84:87], v[40:43]
    v_mfma_f32_16x16x32_bf16 v[40:43], a[136:139], a[68:71], v[40:43]
    ds_read_b64_tr_b16 a[164:165], v182 offset:8200
    v_mfma_f32_16x16x32_bf16 v[44:47], a[136:139], a[72:75], v[44:47]
    v_mfma_f32_16x16x32_bf16 v[44:47], a[168:171], a[88:91], v[44:47]
    ds_read_b64_tr_b16 a[166:167], v182 offset:12296
    v_mfma_f32_16x16x32_bf16 v[48:51], a[168:171], a[92:95], v[48:51]
    v_add_u32 v183, 131072, v187
    v_mfma_f32_16x16x32_bf16 v[48:51], a[136:139], a[76:79], v[48:51]
    ds_read_b64_tr_b16 a[136:137], v183 offset:0
    v_mfma_f32_16x16x32_bf16 v[64:67], a[140:143], a[76:79], v[64:67]
    buffer_load_dwordx4 v217, s[8:11], s67 offen offset:3072 lds
    v_mfma_f32_16x16x32_bf16 v[64:67], a[172:175], a[92:95], v[64:67]
    ds_read_b64_tr_b16 a[138:139], v183 offset:4096
    v_mfma_f32_16x16x32_bf16 v[60:63], a[172:175], a[88:91], v[60:63]
    v_mfma_f32_16x16x32_bf16 v[60:63], a[140:143], a[72:75], v[60:63]
    ds_read_b64_tr_b16 a[168:169], v183 offset:8192
    v_mfma_f32_16x16x32_bf16 v[56:59], a[140:143], a[68:71], v[56:59]
    v_mfma_f32_16x16x32_bf16 v[56:59], a[172:175], a[84:87], v[56:59]
    ds_read_b64_tr_b16 a[170:171], v183 offset:12288
    v_mfma_f32_16x16x32_bf16 v[52:55], a[172:175], a[80:83], v[52:55]
    v_mfma_f32_16x16x32_bf16 v[52:55], a[140:143], a[64:67], v[52:55]
    ds_read_b64_tr_b16 a[140:141], v183 offset:8
    s_waitcnt vmcnt(63) lgkmcnt(13)
    v_mfma_f32_16x16x32_bf16 v[68:71], a[144:147], a[64:67], v[68:71]
    v_mfma_f32_16x16x32_bf16 v[68:71], a[176:179], a[80:83], v[68:71]
    ds_read_b64_tr_b16 a[142:143], v183 offset:4104
    v_mfma_f32_16x16x32_bf16 v[72:75], a[176:179], a[84:87], v[72:75]
    s_add_u32 m0, s71, 32768
    s_mov_b32 s67, 32768
    buffer_load_dwordx4 v212, s[4:7], s67 offen offset:0 lds
    v_mfma_f32_16x16x32_bf16 v[72:75], a[144:147], a[68:71], v[72:75]
    ds_read_b64_tr_b16 a[172:173], v183 offset:8200
    v_mfma_f32_16x16x32_bf16 v[76:79], a[144:147], a[72:75], v[76:79]
    v_mfma_f32_16x16x32_bf16 v[76:79], a[176:179], a[88:91], v[76:79]
    ds_read_b64_tr_b16 a[174:175], v183 offset:12296
    v_mfma_f32_16x16x32_bf16 v[80:83], a[176:179], a[92:95], v[80:83]
    v_add_u32 v184, 131072, v188
    v_mfma_f32_16x16x32_bf16 v[80:83], a[144:147], a[76:79], v[80:83]
    ds_read_b64_tr_b16 a[144:145], v184 offset:0
    v_mfma_f32_16x16x32_bf16 v[96:99], a[148:151], a[76:79], v[96:99]
    buffer_load_dwordx4 v213, s[4:7], s67 offen offset:1024 lds
    v_mfma_f32_16x16x32_bf16 v[96:99], a[180:183], a[92:95], v[96:99]
    ds_read_b64_tr_b16 a[146:147], v184 offset:4096
    v_mfma_f32_16x16x32_bf16 v[92:95], a[180:183], a[88:91], v[92:95]
    v_mfma_f32_16x16x32_bf16 v[92:95], a[148:151], a[72:75], v[92:95]
    ds_read_b64_tr_b16 a[176:177], v184 offset:8192
    v_mfma_f32_16x16x32_bf16 v[88:91], a[148:151], a[68:71], v[88:91]
    v_mfma_f32_16x16x32_bf16 v[88:91], a[180:183], a[84:87], v[88:91]
    ds_read_b64_tr_b16 a[178:179], v184 offset:12288
    v_mfma_f32_16x16x32_bf16 v[84:87], a[180:183], a[80:83], v[84:87]
    v_mfma_f32_16x16x32_bf16 v[84:87], a[148:151], a[64:67], v[84:87]
    ds_read_b64_tr_b16 a[148:149], v184 offset:8
    v_mfma_f32_16x16x32_bf16 v[100:103], a[152:155], a[64:67], v[100:103]
    buffer_load_dwordx4 v214, s[4:7], s67 offen offset:2048 lds
    v_mfma_f32_16x16x32_bf16 v[100:103], a[184:187], a[80:83], v[100:103]
    ds_read_b64_tr_b16 a[150:151], v184 offset:4104
    v_mfma_f32_16x16x32_bf16 v[104:107], a[184:187], a[84:87], v[104:107]
    v_mfma_f32_16x16x32_bf16 v[104:107], a[152:155], a[68:71], v[104:107]
    ds_read_b64_tr_b16 a[180:181], v184 offset:8200
    v_mfma_f32_16x16x32_bf16 v[108:111], a[152:155], a[72:75], v[108:111]
    v_mfma_f32_16x16x32_bf16 v[108:111], a[184:187], a[88:91], v[108:111]
    ds_read_b64_tr_b16 a[182:183], v184 offset:12296
    v_mfma_f32_16x16x32_bf16 v[112:115], a[184:187], a[92:95], v[112:115]
    v_add_u32 v185, 131072, v189
    v_mfma_f32_16x16x32_bf16 v[112:115], a[152:155], a[76:79], v[112:115]
    ds_read_b64_tr_b16 a[152:153], v185 offset:0
    v_mfma_f32_16x16x32_bf16 v[128:131], a[156:159], a[76:79], v[128:131]
    buffer_load_dwordx4 v215, s[4:7], s67 offen offset:3072 lds
    v_mfma_f32_16x16x32_bf16 v[128:131], a[188:191], a[92:95], v[128:131]
    ds_read_b64_tr_b16 a[154:155], v185 offset:4096
    v_mfma_f32_16x16x32_bf16 v[124:127], a[188:191], a[88:91], v[124:127]
    v_mfma_f32_16x16x32_bf16 v[124:127], a[156:159], a[72:75], v[124:127]
    ds_read_b64_tr_b16 a[184:185], v185 offset:8192
    v_mfma_f32_16x16x32_bf16 v[120:123], a[156:159], a[68:71], v[120:123]
    v_mfma_f32_16x16x32_bf16 v[120:123], a[188:191], a[84:87], v[120:123]
    ds_read_b64_tr_b16 a[186:187], v185 offset:12288
    v_mfma_f32_16x16x32_bf16 v[116:119], a[188:191], a[80:83], v[116:119]
    v_mfma_f32_16x16x32_bf16 v[116:119], a[156:159], a[64:67], v[116:119]
    ds_read_b64_tr_b16 a[156:157], v185 offset:8
    s_waitcnt vmcnt(16) lgkmcnt(13)
    v_mfma_f32_16x16x32_bf16 v[4:7], a[128:131], a[96:99], v[4:7]
    s_barrier
    v_mfma_f32_16x16x32_bf16 v[4:7], a[160:163], a[112:115], v[4:7]
    ds_read_b64_tr_b16 a[158:159], v185 offset:4104
    v_mfma_f32_16x16x32_bf16 v[8:11], a[160:163], a[116:119], v[8:11]
    s_add_u32 m0, s71, 98304
    s_mov_b32 s67, 32768
    buffer_load_dwordx4 v216, s[8:11], s67 offen offset:0 lds
    v_mfma_f32_16x16x32_bf16 v[8:11], a[128:131], a[100:103], v[8:11]
    ds_read_b64_tr_b16 a[188:189], v185 offset:8200
    v_mfma_f32_16x16x32_bf16 v[12:15], a[128:131], a[104:107], v[12:15]
    v_mfma_f32_16x16x32_bf16 v[12:15], a[160:163], a[120:123], v[12:15]
    ds_read_b64_tr_b16 a[190:191], v185 offset:12296
    v_mfma_f32_16x16x32_bf16 v[16:19], a[160:163], a[124:127], v[16:19]
    v_mfma_f32_16x16x32_bf16 v[16:19], a[128:131], a[108:111], v[16:19]
    ds_read_b128 a[128:131], v200 offset:0
    v_mfma_f32_16x16x32_bf16 v[32:35], a[132:135], a[108:111], v[32:35]
    buffer_load_dwordx4 v217, s[8:11], s67 offen offset:1024 lds
    v_mfma_f32_16x16x32_bf16 v[32:35], a[164:167], a[124:127], v[32:35]
    v_mfma_f32_16x16x32_bf16 v[28:31], a[164:167], a[120:123], v[28:31]
    v_mfma_f32_16x16x32_bf16 v[28:31], a[132:135], a[104:107], v[28:31]
    v_mfma_f32_16x16x32_bf16 v[24:27], a[132:135], a[100:103], v[24:27]
    v_mfma_f32_16x16x32_bf16 v[24:27], a[164:167], a[116:119], v[24:27]
    v_mfma_f32_16x16x32_bf16 v[20:23], a[164:167], a[112:115], v[20:23]
    v_mfma_f32_16x16x32_bf16 v[20:23], a[132:135], a[96:99], v[20:23]
    ds_read_b128 a[132:135], v201 offset:0
    v_mfma_f32_16x16x32_bf16 v[36:39], a[136:139], a[96:99], v[36:39]
    buffer_load_dwordx4 v216, s[8:11], s67 offen offset:2048 lds
    v_mfma_f32_16x16x32_bf16 v[36:39], a[168:171], a[112:115], v[36:39]
    v_mfma_f32_16x16x32_bf16 v[40:43], a[168:171], a[116:119], v[40:43]
    v_mfma_f32_16x16x32_bf16 v[40:43], a[136:139], a[100:103], v[40:43]
    v_mfma_f32_16x16x32_bf16 v[44:47], a[136:139], a[104:107], v[44:47]
    v_mfma_f32_16x16x32_bf16 v[44:47], a[168:171], a[120:123], v[44:47]
    v_cvt_pk_bf16_f32 v132, v4, v5
    v_cvt_pk_bf16_f32 v133, v6, v7
    v_mfma_f32_16x16x32_bf16 v[48:51], a[168:171], a[124:127], v[48:51]
    v_cvt_pk_bf16_f32 v134, v20, v21
    v_cvt_pk_bf16_f32 v135, v22, v23
    v_mfma_f32_16x16x32_bf16 v[48:51], a[136:139], a[108:111], v[48:51]
    ds_read_b128 a[136:139], v202 offset:0
    v_cvt_pk_bf16_f32 v148, v8, v9
    v_mfma_f32_16x16x32_bf16 v[64:67], a[140:143], a[108:111], v[64:67]
    buffer_load_dwordx4 v217, s[8:11], s67 offen offset:3072 lds
    v_cvt_pk_bf16_f32 v149, v10, v11
    v_mfma_f32_16x16x32_bf16 v[64:67], a[172:175], a[124:127], v[64:67]
    v_cvt_pk_bf16_f32 v150, v24, v25
    v_cvt_pk_bf16_f32 v151, v26, v27
    v_mfma_f32_16x16x32_bf16 v[60:63], a[172:175], a[120:123], v[60:63]
    v_cvt_pk_bf16_f32 v164, v12, v13
    v_cvt_pk_bf16_f32 v165, v14, v15
    v_mfma_f32_16x16x32_bf16 v[60:63], a[140:143], a[104:107], v[60:63]
    v_cvt_pk_bf16_f32 v166, v28, v29
    v_cvt_pk_bf16_f32 v167, v30, v31
    v_mfma_f32_16x16x32_bf16 v[56:59], a[140:143], a[100:103], v[56:59]
    v_cvt_pk_bf16_f32 v180, v16, v17
    v_cvt_pk_bf16_f32 v181, v18, v19
    v_mfma_f32_16x16x32_bf16 v[56:59], a[172:175], a[116:119], v[56:59]
    v_cvt_pk_bf16_f32 v182, v32, v33
    v_cvt_pk_bf16_f32 v183, v34, v35
    v_mfma_f32_16x16x32_bf16 v[52:55], a[172:175], a[112:115], v[52:55]
    v_mfma_f32_16x16x32_bf16 v[52:55], a[140:143], a[96:99], v[52:55]
    ds_read_b128 a[140:143], v203 offset:0
    s_waitcnt vmcnt(32) lgkmcnt(4)
    v_mfma_f32_16x16x32_bf16 v[68:71], a[144:147], a[96:99], v[68:71]
    v_and_b32 v248, 0xffffff00, v248
    v_mfma_f32_16x16x32_bf16 v[68:71], a[176:179], a[112:115], v[68:71]
    v_mov_b32 v219, v248
    v_mfma_f32_16x16x32_bf16 v[72:75], a[176:179], a[116:119], v[72:75]
    s_add_u32 m0, s71, 49152
    s_mov_b32 s67, 49152
    buffer_load_dwordx4 v212, s[4:7], s67 offen offset:0 lds
    v_permlane32_swap_b32 v219, v248
    v_mfma_f32_16x16x32_bf16 v[72:75], a[144:147], a[100:103], v[72:75]
    v_add_f32 v248, v219, v248
    v_mfma_f32_16x16x32_bf16 v[76:79], a[144:147], a[104:107], v[76:79]
    v_mov_b32 v219, v248
    v_mfma_f32_16x16x32_bf16 v[76:79], a[176:179], a[120:123], v[76:79]
    s_nop 0
    v_permlane16_swap_b32 v219, v248
    v_cvt_pk_bf16_f32 v136, v36, v37
    v_mfma_f32_16x16x32_bf16 v[80:83], a[176:179], a[124:127], v[80:83]
    v_add_f32 v248, v219, v248
    v_cvt_pk_bf16_f32 v137, v38, v39
    v_mfma_f32_16x16x32_bf16 v[80:83], a[144:147], a[108:111], v[80:83]
    ds_read_b128 a[144:147], v200 offset:4096
    v_cvt_pk_bf16_f32 v248, v248, v248
    v_mfma_f32_16x16x32_bf16 v[96:99], a[148:151], a[108:111], v[96:99]
    buffer_load_dwordx4 v213, s[4:7], s67 offen offset:1024 lds
    v_and_b32 v248, 0xffff0000, v248
    v_mfma_f32_16x16x32_bf16 v[96:99], a[180:183], a[124:127], v[96:99]
    v_add_f32 v248, v1, v248
    v_cvt_pk_bf16_f32 v138, v52, v53
    v_mfma_f32_16x16x32_bf16 v[92:95], a[180:183], a[120:123], v[92:95]
    v_cvt_pk_bf16_f32 v248, v248, v248
    v_cvt_pk_bf16_f32 v139, v54, v55
    v_mfma_f32_16x16x32_bf16 v[92:95], a[148:151], a[104:107], v[92:95]
    v_and_b32 v248, 0xffff0000, v248
    v_cvt_pk_bf16_f32 v152, v40, v41
    v_mfma_f32_16x16x32_bf16 v[88:91], a[148:151], a[100:103], v[88:91]
    v_cvt_pk_bf16_f32 v153, v42, v43
    v_cvt_pk_bf16_f32 v154, v56, v57
    v_mfma_f32_16x16x32_bf16 v[88:91], a[180:183], a[116:119], v[88:91]
    v_cvt_pk_bf16_f32 v155, v58, v59
    v_cvt_pk_bf16_f32 v168, v44, v45
    v_mfma_f32_16x16x32_bf16 v[84:87], a[180:183], a[112:115], v[84:87]
    v_cvt_pk_bf16_f32 v169, v46, v47
    v_cvt_pk_bf16_f32 v170, v60, v61
    v_mfma_f32_16x16x32_bf16 v[84:87], a[148:151], a[96:99], v[84:87]
    ds_read_b128 a[148:151], v201 offset:4096
    v_cvt_pk_bf16_f32 v171, v62, v63
    v_mfma_f32_16x16x32_bf16 v[100:103], a[152:155], a[96:99], v[100:103]
    buffer_load_dwordx4 v214, s[4:7], s67 offen offset:2048 lds
    v_cvt_pk_bf16_f32 v184, v48, v49
    v_mfma_f32_16x16x32_bf16 v[100:103], a[184:187], a[112:115], v[100:103]
    v_cvt_pk_bf16_f32 v185, v50, v51
    v_cvt_pk_bf16_f32 v186, v64, v65
    v_mfma_f32_16x16x32_bf16 v[104:107], a[184:187], a[116:119], v[104:107]
    v_cvt_pk_bf16_f32 v187, v66, v67
    v_mfma_f32_16x16x32_bf16 v[104:107], a[152:155], a[100:103], v[104:107]
    v_mfma_f32_16x16x32_bf16 v[108:111], a[152:155], a[104:107], v[108:111]
    v_mfma_f32_16x16x32_bf16 v[108:111], a[184:187], a[120:123], v[108:111]
    v_cvt_pk_bf16_f32 v140, v68, v69
    v_cvt_pk_bf16_f32 v141, v70, v71
    v_mfma_f32_16x16x32_bf16 v[112:115], a[184:187], a[124:127], v[112:115]
    v_cvt_pk_bf16_f32 v142, v84, v85
    v_cvt_pk_bf16_f32 v143, v86, v87
    v_mfma_f32_16x16x32_bf16 v[112:115], a[152:155], a[108:111], v[112:115]
    ds_read_b128 a[152:155], v202 offset:4096
    v_cvt_pk_bf16_f32 v156, v72, v73
    v_mfma_f32_16x16x32_bf16 v[128:131], a[156:159], a[108:111], v[128:131]
    buffer_load_dwordx4 v215, s[4:7], s67 offen offset:3072 lds
    v_cvt_pk_bf16_f32 v157, v74, v75
    v_mfma_f32_16x16x32_bf16 v[128:131], a[188:191], a[124:127], v[128:131]
    v_cvt_pk_bf16_f32 v158, v88, v89
    v_cvt_pk_bf16_f32 v159, v90, v91
    v_mfma_f32_16x16x32_bf16 v[124:127], a[188:191], a[120:123], v[124:127]
    buffer_store_dword v248, v250, s[36:39], 0 offen sc1
    v_cvt_pk_bf16_f32 v172, v76, v77
    v_mfma_f32_16x16x32_bf16 v[124:127], a[156:159], a[104:107], v[124:127]
    v_cvt_pk_bf16_f32 v173, v78, v79
    v_cvt_pk_bf16_f32 v174, v92, v93
    v_mfma_f32_16x16x32_bf16 v[120:123], a[156:159], a[100:103], v[120:123]
    v_cvt_pk_bf16_f32 v175, v94, v95
    v_cvt_pk_bf16_f32 v188, v80, v81
    v_mfma_f32_16x16x32_bf16 v[120:123], a[188:191], a[116:119], v[120:123]
    v_cvt_pk_bf16_f32 v189, v82, v83
    v_cvt_pk_bf16_f32 v190, v96, v97
    v_mfma_f32_16x16x32_bf16 v[116:119], a[188:191], a[112:115], v[116:119]
    buffer_store_short_d16_hi v248, v251, s[36:39], 0 offen sc1
    v_cvt_pk_bf16_f32 v191, v98, v99
    v_mfma_f32_16x16x32_bf16 v[116:119], a[156:159], a[96:99], v[116:119]
    ds_read_b128 a[156:159], v203 offset:4096
    s_waitcnt lgkmcnt(0)
    v_mfma_f32_16x16x32_bf16 v[4:7], a[128:131], v[132:135], 0
    v_mfma_f32_16x16x32_bf16 v[8:11], a[128:131], v[148:151], 0
    v_mfma_f32_16x16x32_bf16 v[12:15], a[128:131], v[164:167], 0
    v_mfma_f32_16x16x32_bf16 v[16:19], a[128:131], v[180:183], 0
    v_mfma_f32_16x16x32_bf16 v[20:23], a[144:147], v[132:135], 0
    v_mfma_f32_16x16x32_bf16 v[24:27], a[144:147], v[148:151], 0
    v_mfma_f32_16x16x32_bf16 v[28:31], a[144:147], v[164:167], 0
    v_mfma_f32_16x16x32_bf16 v[32:35], a[144:147], v[180:183], 0
    v_mfma_f32_16x16x32_bf16 v[4:7], a[132:135], v[136:139], v[4:7]
    v_mfma_f32_16x16x32_bf16 v[8:11], a[132:135], v[152:155], v[8:11]
    v_mfma_f32_16x16x32_bf16 v[12:15], a[132:135], v[168:171], v[12:15]
    v_mfma_f32_16x16x32_bf16 v[16:19], a[132:135], v[184:187], v[16:19]
    v_mfma_f32_16x16x32_bf16 v[20:23], a[148:151], v[136:139], v[20:23]
    v_mfma_f32_16x16x32_bf16 v[24:27], a[148:151], v[152:155], v[24:27]
    v_mfma_f32_16x16x32_bf16 v[28:31], a[148:151], v[168:171], v[28:31]
    v_mfma_f32_16x16x32_bf16 v[32:35], a[148:151], v[184:187], v[32:35]
    v_mfma_f32_16x16x32_bf16 v[4:7], a[136:139], v[140:143], v[4:7]
    v_cvt_pk_bf16_f32 v144, v100, v101
    v_cvt_pk_bf16_f32 v145, v102, v103
    v_mfma_f32_16x16x32_bf16 v[8:11], a[136:139], v[156:159], v[8:11]
    v_cvt_pk_bf16_f32 v146, v116, v117
    v_cvt_pk_bf16_f32 v147, v118, v119
    v_mfma_f32_16x16x32_bf16 v[12:15], a[136:139], v[172:175], v[12:15]
    v_cvt_pk_bf16_f32 v160, v104, v105
    v_cvt_pk_bf16_f32 v161, v106, v107
    v_mfma_f32_16x16x32_bf16 v[16:19], a[136:139], v[188:191], v[16:19]
    v_cvt_pk_bf16_f32 v162, v120, v121
    v_cvt_pk_bf16_f32 v163, v122, v123
    v_mfma_f32_16x16x32_bf16 v[20:23], a[152:155], v[140:143], v[20:23]
    v_cvt_pk_bf16_f32 v176, v108, v109
    v_cvt_pk_bf16_f32 v177, v110, v111
    v_mfma_f32_16x16x32_bf16 v[24:27], a[152:155], v[156:159], v[24:27]
    v_cvt_pk_bf16_f32 v178, v124, v125
    v_cvt_pk_bf16_f32 v179, v126, v127
    v_mfma_f32_16x16x32_bf16 v[28:31], a[152:155], v[172:175], v[28:31]
    v_cvt_pk_bf16_f32 v192, v112, v113
    v_cvt_pk_bf16_f32 v193, v114, v115
    v_mfma_f32_16x16x32_bf16 v[32:35], a[152:155], v[188:191], v[32:35]
    v_cvt_pk_bf16_f32 v194, v128, v129
    v_cvt_pk_bf16_f32 v195, v130, v131
    v_mfma_f32_16x16x32_bf16 v[4:7], a[140:143], v[144:147], v[4:7]
    v_mfma_f32_16x16x32_bf16 v[8:11], a[140:143], v[160:163], v[8:11]
    v_mfma_f32_16x16x32_bf16 v[12:15], a[140:143], v[176:179], v[12:15]
    v_mfma_f32_16x16x32_bf16 v[16:19], a[140:143], v[192:195], v[16:19]
    v_mfma_f32_16x16x32_bf16 v[20:23], a[156:159], v[144:147], v[20:23]
    v_mfma_f32_16x16x32_bf16 v[24:27], a[156:159], v[160:163], v[24:27]
    v_mfma_f32_16x16x32_bf16 v[28:31], a[156:159], v[176:179], v[28:31]
    v_mfma_f32_16x16x32_bf16 v[32:35], a[156:159], v[192:195], v[32:35]
    ds_read_b128 a[128:131], v200 offset:8192
    ds_read_b128 a[132:135], v201 offset:8192
    ds_read_b128 a[136:139], v202 offset:8192
    ds_read_b128 a[140:143], v203 offset:8192
    ds_read_b128 a[144:147], v200 offset:12288
    ds_read_b128 a[148:151], v201 offset:12288
    ds_read_b128 a[152:155], v202 offset:12288
    ds_read_b128 a[156:159], v203 offset:12288
    v_mov_b32 v223, 0xff800000
    v_mov_b32 v224, 0xff800000
    v_mov_b32 v225, 0xff800000
    v_mov_b32 v226, 0xff800000
    s_cmp_lg_u32 s73, 0
    s_cbranch_scc1 L_maxpass
    v_max3_f32 v223, v4, v5, v223
    v_max3_f32 v224, v8, v9, v224
    v_max3_f32 v225, v12, v13, v225
    v_max3_f32 v226, v16, v17, v226
    v_max3_f32 v223, v6, v7, v223
    v_max3_f32 v224, v10, v11, v224
    v_max3_f32 v225, v14, v15, v225
    v_max3_f32 v226, v18, v19, v226
    v_max3_f32 v223, v20, v21, v223
    v_max3_f32 v224, v24, v25, v224
    v_max3_f32 v225, v28, v29, v225
    v_max3_f32 v226, v32, v33, v226
    v_max3_f32 v223, v22, v23, v223
    v_max3_f32 v224, v26, v27, v224
    v_max3_f32 v225, v30, v31, v225
    v_max3_f32 v226, v34, v35, v226
L_havemax:
    v_mov_b32 v36, 0
    v_mov_b32 v37, 0
    v_mov_b32 v38, 0
    v_mov_b32 v39, 0
    v_mov_b32 v219, v223
    s_nop 0
    v_mfma_f32_32x32x16_bf16 a[0:15], v[36:39], v[36:39], 0
    v_mov_b32 v220, v224
    v_mov_b32 v221, v225
    v_mov_b32 v222, v226
    s_nop 1
    v_permlane32_swap_b32 v219, v223
    v_mfma_f32_32x32x16_bf16 a[16:31], v[36:39], v[36:39], 0
    v_permlane32_swap_b32 v220, v224
    v_permlane32_swap_b32 v221, v225
    v_permlane32_swap_b32 v222, v226
    v_max_f32 v223, v219, v223
    v_max_f32 v224, v220, v224
    v_mfma_f32_32x32x16_bf16 a[32:47], v[36:39], v[36:39], 0
    v_max_f32 v225, v221, v225
    v_max_f32 v226, v222, v226
    v_mov_b32 v219, v223
    v_mov_b32 v220, v224
    v_mov_b32 v221, v225
    v_mfma_f32_32x32x16_bf16 a[48:63], v[36:39], v[36:39], 0
    v_mov_b32 v222, v226
    s_nop 1
    v_permlane16_swap_b32 v219, v223
    v_permlane16_swap_b32 v220, v224
    v_permlane16_swap_b32 v221, v225
    v_mfma_f32_32x32x16_bf16 a[64:79], v[36:39], v[36:39], 0
    v_permlane16_swap_b32 v222, v226
    v_max_f32 v223, v219, v223
    v_max_f32 v224, v220, v224
    v_max_f32 v225, v221, v225
    v_max_f32 v226, v222, v226
    v_mfma_f32_32x32x16_bf16 a[80:95], v[36:39], v[36:39], 0
    v_sub_f32 v100, 0, v223
    v_sub_f32 v101, 0, v223
    v_sub_f32 v102, 0, v223
    v_sub_f32 v103, 0, v223
    v_sub_f32 v104, 0, v224
    v_mfma_f32_32x32x16_bf16 a[96:111], v[36:39], v[36:39], 0
    v_sub_f32 v105, 0, v224
    v_sub_f32 v106, 0, v224
    v_sub_f32 v107, 0, v224
    v_sub_f32 v108, 0, v225
    v_sub_f32 v109, 0, v225
    v_mfma_f32_32x32x16_bf16 a[112:127], v[36:39], v[36:39], 0
    v_sub_f32 v110, 0, v225
    v_sub_f32 v111, 0, v225
    v_sub_f32 v112, 0, v226
    v_sub_f32 v113, 0, v226
    v_sub_f32 v114, 0, v226
    v_sub_f32 v115, 0, v226
    s_waitcnt vmcnt(18) lgkmcnt(0)
    s_barrier
    v_pk_add_f32 v[4:5], v[4:5], v[100:101]
    v_pk_add_f32 v[6:7], v[6:7], v[102:103]
    v_pk_add_f32 v[8:9], v[8:9], v[104:105]
    v_pk_add_f32 v[10:11], v[10:11], v[106:107]
    v_pk_add_f32 v[12:13], v[12:13], v[108:109]
    v_pk_add_f32 v[14:15], v[14:15], v[110:111]
    v_pk_add_f32 v[16:17], v[16:17], v[112:113]
    v_pk_add_f32 v[18:19], v[18:19], v[114:115]
    v_pk_add_f32 v[20:21], v[20:21], v[100:101]
    v_pk_add_f32 v[22:23], v[22:23], v[102:103]
    v_pk_add_f32 v[24:25], v[24:25], v[104:105]
    v_pk_add_f32 v[26:27], v[26:27], v[106:107]
    v_pk_add_f32 v[28:29], v[28:29], v[108:109]
    v_pk_add_f32 v[30:31], v[30:31], v[110:111]
    v_pk_add_f32 v[32:33], v[32:33], v[112:113]
    v_pk_add_f32 v[34:35], v[34:35], v[114:115]
    v_exp_f32 v4, v4
    v_exp_f32 v5, v5
    v_exp_f32 v6, v6
    v_cvt_pk_bf16_f32 v116, v4, v5
    v_exp_f32 v7, v7
    v_exp_f32 v8, v8
    v_cvt_pk_bf16_f32 v117, v6, v7
    v_exp_f32 v9, v9
    v_exp_f32 v10, v10
    v_cvt_pk_bf16_f32 v120, v8, v9
    v_exp_f32 v11, v11
    v_exp_f32 v12, v12
    v_cvt_pk_bf16_f32 v121, v10, v11
    v_exp_f32 v13, v13
    v_exp_f32 v14, v14
    v_cvt_pk_bf16_f32 v124, v12, v13
    v_exp_f32 v15, v15
    s_nop 0
    v_cvt_pk_bf16_f32 v125, v14, v15
    v_mfma_f32_16x16x32_bf16 v[36:39], a[128:131], v[132:135], v[100:103]
    v_exp_f32 v16, v16
    v_mfma_f32_16x16x32_bf16 v[36:39], a[132:135], v[136:139], v[36:39]
    v_exp_f32 v17, v17
    v_mfma_f32_16x16x32_bf16 v[36:39], a[136:139], v[140:143], v[36:39]
    v_exp_f32 v18, v18
    v_mfma_f32_16x16x32_bf16 v[36:39], a[140:143], v[144:147], v[36:39]
    v_cvt_pk_bf16_f32 v128, v16, v17
    v_mfma_f32_16x16x32_bf16 v[40:43], a[140:143], v[160:163], v[104:107]
    v_exp_f32 v19, v19
    v_mfma_f32_16x16x32_bf16 v[40:43], a[136:139], v[156:159], v[40:43]
    v_exp_f32 v20, v20
    v_mfma_f32_16x16x32_bf16 v[40:43], a[132:135], v[152:155], v[40:43]
    v_cvt_pk_bf16_f32 v129, v18, v19
    v_mfma_f32_16x16x32_bf16 v[40:43], a[128:131], v[148:151], v[40:43]
    v_exp_f32 v21, v21
    v_mfma_f32_16x16x32_bf16 v[44:47], a[128:131], v[164:167], v[108:111]
    v_exp_f32 v22, v22
    v_mfma_f32_16x16x32_bf16 v[44:47], a[132:135], v[168:171], v[44:47]
    v_cvt_pk_bf16_f32 v118, v20, v21
    v_mfma_f32_16x16x32_bf16 v[44:47], a[136:139], v[172:175], v[44:47]
    v_exp_f32 v23, v23
    v_mfma_f32_16x16x32_bf16 v[44:47], a[140:143], v[176:179], v[44:47]
    v_exp_f32 v24, v24
    v_mfma_f32_16x16x32_bf16 v[48:51], a[140:143], v[192:195], v[112:115]
    v_cvt_pk_bf16_f32 v119, v22, v23
    v_mfma_f32_16x16x32_bf16 v[48:51], a[136:139], v[188:191], v[48:51]
    v_exp_f32 v25, v25
    v_mfma_f32_16x16x32_bf16 v[48:51], a[132:135], v[184:187], v[48:51]
    v_exp_f32 v26, v26
    v_mfma_f32_16x16x32_bf16 v[48:51], a[128:131], v[180:183], v[48:51]
    v_cvt_pk_bf16_f32 v122, v24, v25
    v_mfma_f32_16x16x32_bf16 v[64:67], a[144:147], v[180:183], v[112:115]
    v_exp_f32 v27, v27
    v_mfma_f32_16x16x32_bf16 v[64:67], a[148:151], v[184:187], v[64:67]
    ds_read_b128 a[128:131], v200 offset:16384
    v_mfma_f32_16x16x32_bf16 v[64:67], a[152:155], v[188:191], v[64:67]
    v_exp_f32 v28, v28
    v_mfma_f32_16x16x32_bf16 v[64:67], a[156:159], v[192:195], v[64:67]
    ds_read_b128 a[132:135], v201 offset:16384
    v_cvt_pk_bf16_f32 v123, v26, v27
    v_mfma_f32_16x16x32_bf16 v[60:63], a[156:159], v[176:179], v[108:111]
    v_exp_f32 v29, v29
    v_mfma_f32_16x16x32_bf16 v[60:63], a[152:155], v[172:175], v[60:63]
    ds_read_b128 a[136:139], v202 offset:16384
    v_mfma_f32_16x16x32_bf16 v[60:63], a[148:151], v[168:171], v[60:63]
    v_exp_f32 v30, v30
    v_mfma_f32_16x16x32_bf16 v[60:63], a[144:147], v[164:167], v[60:63]
    ds_read_b128 a[140:143], v203 offset:16384
    v_cvt_pk_bf16_f32 v126, v28, v29
    v_mfma_f32_16x16x32_bf16 v[56:59], a[144:147], v[148:151], v[104:107]
    v_exp_f32 v31, v31
    v_mfma_f32_16x16x32_bf16 v[56:59], a[148:151], v[152:155], v[56:59]
    v_exp_f32 v32, v32
    v_mfma_f32_16x16x32_bf16 v[56:59], a[152:155], v[156:159], v[56:59]
    v_cvt_pk_bf16_f32 v127, v30, v31
    v_mfma_f32_16x16x32_bf16 v[56:59], a[156:159], v[160:163], v[56:59]
    v_exp_f32 v33, v33
    v_mfma_f32_16x16x32_bf16 v[52:55], a[156:159], v[144:147], v[100:103]
    v_exp_f32 v34, v34
    v_mfma_f32_16x16x32_bf16 v[52:55], a[152:155], v[140:143], v[52:55]
    v_cvt_pk_bf16_f32 v130, v32, v33
    v_mfma_f32_16x16x32_bf16 v[52:55], a[148:151], v[136:139], v[52:55]
    v_exp_f32 v35, v35
    v_mfma_f32_16x16x32_bf16 v[52:55], a[144:147], v[132:135], v[52:55]
    v_cvt_pk_bf16_f32 v131, v34, v35
    ds_read_b128 a[144:147], v200 offset:20480
    ds_read_b128 a[148:151], v201 offset:20480
    ds_read_b128 a[152:155], v202 offset:20480
    ds_read_b128 a[156:159], v203 offset:20480
    v_exp_f32 v36, v36
    v_exp_f32 v37, v37
    v_exp_f32 v38, v38
    v_cvt_pk_bf16_f32 v232, v36, v37
    v_exp_f32 v39, v39
    v_exp_f32 v40, v40
    v_cvt_pk_bf16_f32 v233, v38, v39
    v_exp_f32 v41, v41
    v_exp_f32 v42, v42
    v_cvt_pk_bf16_f32 v236, v40, v41
    v_exp_f32 v43, v43
    v_exp_f32 v44, v44
    v_cvt_pk_bf16_f32 v237, v42, v43
    v_exp_f32 v45, v45
    v_exp_f32 v46, v46
    v_cvt_pk_bf16_f32 v240, v44, v45
    v_exp_f32 v47, v47
    v_exp_f32 v48, v48
    v_cvt_pk_bf16_f32 v241, v46, v47
    v_exp_f32 v49, v49
    v_exp_f32 v50, v50
    v_cvt_pk_bf16_f32 v244, v48, v49
    v_exp_f32 v51, v51
    v_exp_f32 v52, v52
    v_cvt_pk_bf16_f32 v245, v50, v51
    v_exp_f32 v53, v53
    v_exp_f32 v54, v54
    v_cvt_pk_bf16_f32 v234, v52, v53
    v_exp_f32 v55, v55
    v_exp_f32 v56, v56
    v_cvt_pk_bf16_f32 v235, v54, v55
    v_exp_f32 v57, v57
    s_nop 0
    v_cvt_pk_bf16_f32 v238, v56, v57
    s_waitcnt lgkmcnt(4)
    s_lshr_b32 s79, s71, 1
    s_add_u32 s79, s79, 131072
    v_lshlrev_b32 v1, 7, v218
    s_getpc_b64 s[28:29]
L_pc2:
    s_add_u32 s28, s28, L_pen-L_pc2
    s_addc_u32 s29, s29, 0
    s_mov_b32 s30, L_end-L_pen
    s_lshr_b32 s68, s2, 3
    s_lshl_b32 s68, s68, 2
    s_add_u32 s68, s68, s64
    s_lshl_b32 s68, s68, 13
    s_mov_b32 s70, 49152
    s_mov_b32 s69, 65536
    s_mov_b32 s72, 0
L_loop:
    v_mfma_f32_16x16x32_bf16 v[4:7], a[128:131], v[132:135], v[100:103]
    v_exp_f32 v58, v58
    v_mfma_f32_16x16x32_bf16 v[4:7], a[132:135], v[136:139], v[4:7]
    ds_read_b64_tr_b16 a[160:161], v204 offset:0
    s_add_u32 m0, s71, 114688
    v_mfma_f32_16x16x32_bf16 v[4:7], a[136:139], v[140:143], v[4:7]
    v_exp_f32 v59, v59
    v_mfma_f32_16x16x32_bf16 v[4:7], a[140:143], v[144:147], v[4:7]
    ds_read_b64_tr_b16 a[162:163], v204 offset:4096
    v_cvt_pk_bf16_f32 v239, v58, v59
    v_mfma_f32_16x16x32_bf16 v[8:11], a[140:143], v[160:163], v[104:107]
    v_exp_f32 v60, v60
    v_mfma_f32_16x16x32_bf16 v[8:11], a[136:139], v[156:159], v[8:11]
    buffer_load_dwordx4 v216, s[8:11], s70 offen offset:0 lds
    v_mfma_f32_16x16x32_bf16 v[8:11], a[132:135], v[152:155], v[8:11]
    v_exp_f32 v61, v61
    v_mfma_f32_16x16x32_bf16 v[8:11], a[128:131], v[148:151], v[8:11]
    ds_read_b64_tr_b16 a[164:165], v204 offset:8192
    v_cvt_pk_bf16_f32 v242, v60, v61
    v_mfma_f32_16x16x32_bf16 v[12:15], a[128:131], v[164:167], v[108:111]
    v_exp_f32 v62, v62
    v_mfma_f32_16x16x32_bf16 v[12:15], a[132:135], v[168:171], v[12:15]
    ds_read_b64_tr_b16 a[166:167], v204 offset:12288
    v_mfma_f32_16x16x32_bf16 v[12:15], a[136:139], v[172:175], v[12:15]
    v_exp_f32 v63, v63
    v_mfma_f32_16x16x32_bf16 v[12:15], a[140:143], v[176:179], v[12:15]
    ds_read_b64_tr_b16 a[168:169], v205 offset:0
    v_cvt_pk_bf16_f32 v243, v62, v63
    v_mfma_f32_16x16x32_bf16 v[16:19], a[140:143], v[192:195], v[112:115]
    v_exp_f32 v64, v64
    v_mfma_f32_16x16x32_bf16 v[16:19], a[136:139], v[188:191], v[16:19]
    ds_read_b64_tr_b16 a[170:171], v205 offset:4096
    s_waitcnt lgkmcnt(6)
    v_mfma_f32_16x16x32_bf16 v[16:19], a[132:135], v[184:187], v[16:19]
    v_exp_f32 v65, v65
    v_mfma_f32_16x16x32_bf16 v[16:19], a[128:131], v[180:183], v[16:19]
    ds_read_b64_tr_b16 a[172:173], v205 offset:8192
    v_cvt_pk_bf16_f32 v246, v64, v65
    v_mfma_f32_16x16x32_bf16 v[32:35], a[144:147], v[180:183], v[112:115]
    v_exp_f32 v66, v66
    v_mfma_f32_16x16x32_bf16 v[32:35], a[148:151], v[184:187], v[32:35]
    ds_read_b128 a[128:131], v200 offset:24576
    v_mfma_f32_16x16x32_bf16 v[32:35], a[152:155], v[188:191], v[32:35]
    v_exp_f32 v67, v67
    v_mfma_f32_16x16x32_bf16 v[32:35], a[156:159], v[192:195], v[32:35]
    ds_read_b128 a[132:135], v201 offset:24576
    v_cvt_pk_bf16_f32 v247, v66, v67
    v_mfma_f32_16x16x32_bf16 v[28:31], a[156:159], v[176:179], v[108:111]
    buffer_load_dwordx4 v217, s[8:11], s70 offen offset:1024 lds
    v_mfma_f32_16x16x32_bf16 v[28:31], a[152:155], v[172:175], v[28:31]
    ds_read_b128 a[136:139], v202 offset:24576
    v_mfma_f32_16x16x32_bf16 v[28:31], a[148:151], v[168:171], v[28:31]
    v_exp_f32 v4, v4
    v_mfma_f32_16x16x32_bf16 v[28:31], a[144:147], v[164:167], v[28:31]
    ds_read_b128 a[140:143], v203 offset:24576
    v_mfma_f32_16x16x32_bf16 v[24:27], a[144:147], v[148:151], v[104:107]
    v_exp_f32 v5, v5
    v_mfma_f32_16x16x32_bf16 v[24:27], a[148:151], v[152:155], v[24:27]
    ds_read_b64_tr_b16 a[174:175], v205 offset:12288
    v_cvt_pk_bf16_f32 v68, v4, v5
    v_mfma_f32_16x16x32_bf16 v[24:27], a[152:155], v[156:159], v[24:27]
    v_exp_f32 v6, v6
    v_mfma_f32_16x16x32_bf16 v[24:27], a[156:159], v[160:163], v[24:27]
    ds_read_b64_tr_b16 a[176:177], v206 offset:0
    v_mfma_f32_16x16x32_bf16 v[20:23], a[156:159], v[144:147], v[100:103]
    v_exp_f32 v7, v7
    v_mfma_f32_16x16x32_bf16 v[20:23], a[152:155], v[140:143], v[20:23]
    ds_read_b64_tr_b16 a[178:179], v206 offset:4096
    v_cvt_pk_bf16_f32 v69, v6, v7
    v_mfma_f32_16x16x32_bf16 v[20:23], a[148:151], v[136:139], v[20:23]
    v_exp_f32 v8, v8
    v_mfma_f32_16x16x32_bf16 v[20:23], a[144:147], v[132:135], v[20:23]
    ds_read_b64_tr_b16 a[180:181], v206 offset:8192
    s_waitcnt lgkmcnt(4)
    v_mfma_f32_16x16x32_bf16 v[36:39], a[128:131], v[132:135], v[100:103]
    v_exp_f32 v9, v9
    v_mfma_f32_16x16x32_bf16 v[36:39], a[132:135], v[136:139], v[36:39]
    ds_read_b128 a[144:147], v200 offset:28672
    v_cvt_pk_bf16_f32 v72, v8, v9
    v_mfma_f32_16x16x32_bf16 v[36:39], a[136:139], v[140:143], v[36:39]
    v_exp_f32 v10, v10
    v_mfma_f32_16x16x32_bf16 v[36:39], a[140:143], v[144:147], v[36:39]
    ds_read_b128 a[148:151], v201 offset:28672
    v_mfma_f32_16x16x32_bf16 v[40:43], a[140:143], v[160:163], v[104:107]
    v_exp_f32 v11, v11
    v_mfma_f32_16x16x32_bf16 v[40:43], a[136:139], v[156:159], v[40:43]
    ds_read_b128 a[152:155], v202 offset:28672
    v_cvt_pk_bf16_f32 v73, v10, v11
    v_mfma_f32_16x16x32_bf16 v[40:43], a[132:135], v[152:155], v[40:43]
    v_exp_f32 v12, v12
    v_mfma_f32_16x16x32_bf16 v[40:43], a[128:131], v[148:151], v[40:43]
    ds_read_b128 a[156:159], v203 offset:28672
    v_mfma_f32_16x16x32_bf16 v[44:47], a[128:131], v[164:167], v[108:111]
    v_exp_f32 v13, v13
    v_mfma_f32_16x16x32_bf16 v[44:47], a[132:135], v[168:171], v[44:47]
    ds_read_b64_tr_b16 a[182:183], v206 offset:12288
    v_cvt_pk_bf16_f32 v76, v12, v13
    v_mfma_f32_16x16x32_bf16 v[44:47], a[136:139], v[172:175], v[44:47]
    v_exp_f32 v14, v14
    v_mfma_f32_16x16x32_bf16 v[44:47], a[140:143], v[176:179], v[44:47]
    buffer_load_dwordx4 v216, s[8:11], s70 offen offset:2048 lds
    v_mfma_f32_16x16x32_bf16 v[48:51], a[140:143], v[192:195], v[112:115]
    v_exp_f32 v15, v15
    v_mfma_f32_16x16x32_bf16 v[48:51], a[136:139], v[188:191], v[48:51]
    ds_read_b64_tr_b16 a[184:185], v207 offset:0
    v_cvt_pk_bf16_f32 v77, v14, v15
    v_mfma_f32_16x16x32_bf16 v[48:51], a[132:135], v[184:187], v[48:51]
    v_exp_f32 v16, v16
    v_mfma_f32_16x16x32_bf16 v[48:51], a[128:131], v[180:183], v[48:51]
    ds_read_b64_tr_b16 a[186:187], v207 offset:4096
    s_waitcnt lgkmcnt(3)
    v_mfma_f32_16x16x32_bf16 v[64:67], a[144:147], v[180:183], v[112:115]
    v_exp_f32 v17, v17
    v_mfma_f32_16x16x32_bf16 v[64:67], a[148:151], v[184:187], v[64:67]
    ds_read_b64_tr_b16 a[188:189], v207 offset:8192
    v_cvt_pk_bf16_f32 v80, v16, v17
    v_mfma_f32_16x16x32_bf16 v[64:67], a[152:155], v[188:191], v[64:67]
    v_exp_f32 v18, v18
    v_mfma_f32_16x16x32_bf16 v[64:67], a[156:159], v[192:195], v[64:67]
    ds_read_b64_tr_b16 a[190:191], v207 offset:12288
    v_mfma_f32_16x16x32_bf16 v[60:63], a[156:159], v[176:179], v[108:111]
    v_exp_f32 v19, v19
    v_mfma_f32_16x16x32_bf16 v[60:63], a[152:155], v[172:175], v[60:63]
    ds_read_b64_tr_b16 a[208:209], v252 offset:0
    v_cvt_pk_bf16_f32 v81, v18, v19
    v_mfma_f32_16x16x32_bf16 v[60:63], a[148:151], v[168:171], v[60:63]
    v_exp_f32 v20, v20
    v_mfma_f32_16x16x32_bf16 v[60:63], a[144:147], v[164:167], v[60:63]
    buffer_load_dwordx4 v217, s[8:11], s70 offen offset:3072 lds
    v_mfma_f32_16x16x32_bf16 v[56:59], a[144:147], v[148:151], v[104:107]
    v_exp_f32 v21, v21
    v_mfma_f32_16x16x32_bf16 v[56:59], a[148:151], v[152:155], v[56:59]
    ds_read_b64_tr_b16 a[210:211], v252 offset:4096
    v_cvt_pk_bf16_f32 v70, v20, v21
    v_mfma_f32_16x16x32_bf16 v[56:59], a[152:155], v[156:159], v[56:59]
    v_exp_f32 v22, v22
    v_mfma_f32_16x16x32_bf16 v[56:59], a[156:159], v[160:163], v[56:59]
    s_add_u32 s70, s70, 16384
    s_add_u32 m0, s71, 0
    v_mfma_f32_16x16x32_bf16 v[52:55], a[156:159], v[144:147], v[100:103]
    v_exp_f32 v23, v23
    v_mfma_f32_16x16x32_bf16 v[52:55], a[152:155], v[140:143], v[52:55]
    ds_read_b64_tr_b16 a[212:213], v229 offset:0
    v_cvt_pk_bf16_f32 v71, v22, v23
    v_mfma_f32_16x16x32_bf16 v[52:55], a[148:151], v[136:139], v[52:55]
    v_exp_f32 v24, v24
    v_mfma_f32_16x16x32_bf16 v[52:55], a[144:147], v[132:135], v[52:55]
    buffer_load_dwordx4 v212, s[4:7], s69 offen offset:0 lds
    v_smfmac_f32_16x16x64_bf16 a[196:199], v[196:199], v[124:131], v2
    v_exp_f32 v25, v25
    v_smfmac_f32_16x16x64_bf16 a[196:199], v[196:199], v[240:247], v2
    s_waitcnt lgkmcnt(3)
    v_cvt_pk_bf16_f32 v74, v24, v25
    v_smfmac_f32_16x16x64_bf16 a[192:195], v[196:199], v[232:239], v2
    v_exp_f32 v26, v26
    v_smfmac_f32_16x16x64_bf16 a[192:195], v[196:199], v[116:123], v2
    ds_read_b64_tr_b16 a[214:215], v229 offset:4096
    v_mfma_f32_16x16x32_bf16 a[0:3], a[160:163], v[116:119], a[0:3]
    v_exp_f32 v27, v27
    v_mfma_f32_16x16x32_bf16 a[0:3], a[164:167], v[232:235], a[0:3]
    v_cvt_pk_bf16_f32 v75, v26, v27
    v_mfma_f32_16x16x32_bf16 a[4:7], a[164:167], v[236:239], a[4:7]
    v_exp_f32 v28, v28
    v_mfma_f32_16x16x32_bf16 a[4:7], a[160:163], v[120:123], a[4:7]
    buffer_load_dwordx4 v213, s[4:7], s69 offen offset:1024 lds
    v_mfma_f32_16x16x32_bf16 a[8:11], a[160:163], v[124:127], a[8:11]
    v_exp_f32 v29, v29
    v_mfma_f32_16x16x32_bf16 a[8:11], a[164:167], v[240:243], a[8:11]
    s_waitcnt lgkmcnt(2)
    v_cvt_pk_bf16_f32 v78, v28, v29
    v_mfma_f32_16x16x32_bf16 a[12:15], a[164:167], v[244:247], a[12:15]
    v_exp_f32 v30, v30
    v_mfma_f32_16x16x32_bf16 a[12:15], a[160:163], v[128:131], a[12:15]
    buffer_store_dwordx4 a[208:211], v231, s[32:35], s75 offen sc1
    v_mfma_f32_16x16x32_bf16 a[28:31], a[168:171], v[128:131], a[28:31]
    v_exp_f32 v31, v31
    v_mfma_f32_16x16x32_bf16 a[28:31], a[172:175], v[244:247], a[28:31]
    ds_read_b64_tr_b16 a[160:161], v208 offset:0
    v_cvt_pk_bf16_f32 v79, v30, v31
    v_mfma_f32_16x16x32_bf16 a[24:27], a[172:175], v[240:243], a[24:27]
    v_exp_f32 v32, v32
    v_mfma_f32_16x16x32_bf16 a[24:27], a[168:171], v[124:127], a[24:27]
    ds_read_b64_tr_b16 a[162:163], v208 offset:4096
    s_add_u32 s67, s75, s76
    v_mfma_f32_16x16x32_bf16 a[20:23], a[168:171], v[120:123], a[20:23]
    v_exp_f32 v33, v33
    v_mfma_f32_16x16x32_bf16 a[20:23], a[172:175], v[236:239], a[20:23]
    ds_read_b64_tr_b16 a[164:165], v208 offset:8192
    v_cvt_pk_bf16_f32 v82, v32, v33
    v_mfma_f32_16x16x32_bf16 a[16:19], a[172:175], v[232:235], a[16:19]
    v_exp_f32 v34, v34
    v_mfma_f32_16x16x32_bf16 a[16:19], a[168:171], v[116:119], a[16:19]
    ds_read_b64_tr_b16 a[166:167], v208 offset:12288
    s_add_u32 s75, s75, s80
    v_mfma_f32_16x16x32_bf16 a[32:35], a[176:179], v[116:119], a[32:35]
    v_exp_f32 v35, v35
    v_mfma_f32_16x16x32_bf16 a[32:35], a[180:183], v[232:235], a[32:35]
    ds_read_b64_tr_b16 a[168:169], v209 offset:0
    v_cvt_pk_bf16_f32 v83, v34, v35
    v_mfma_f32_16x16x32_bf16 a[36:39], a[180:183], v[236:239], a[36:39]
    buffer_load_dwordx4 v214, s[4:7], s69 offen offset:2048 lds
    v_mfma_f32_16x16x32_bf16 a[36:39], a[176:179], v[120:123], a[36:39]
    ds_read_b64_tr_b16 a[170:171], v209 offset:4096
    v_mfma_f32_16x16x32_bf16 a[40:43], a[176:179], v[124:127], a[40:43]
    v_exp_f32 v36, v36
    v_mfma_f32_16x16x32_bf16 a[40:43], a[180:183], v[240:243], a[40:43]
    ds_read_b64_tr_b16 a[172:173], v209 offset:8192
    s_cmp_lt_u32 s72, 4
    v_mfma_f32_16x16x32_bf16 a[44:47], a[180:183], v[244:247], a[44:47]
    v_exp_f32 v37, v37
    v_mfma_f32_16x16x32_bf16 a[44:47], a[176:179], v[128:131], a[44:47]
    ds_read_b64_tr_b16 a[174:175], v209 offset:12288
    v_cvt_pk_bf16_f32 v84, v36, v37
    v_mfma_f32_16x16x32_bf16 a[60:63], a[184:187], v[128:131], a[60:63]
    v_exp_f32 v38, v38
    v_mfma_f32_16x16x32_bf16 a[60:63], a[188:191], v[244:247], a[60:63]
    ds_read_b64_tr_b16 a[176:177], v210 offset:0
    s_cselect_b32 s26, s26, 0
    v_mfma_f32_16x16x32_bf16 a[56:59], a[188:191], v[240:243], a[56:59]
    v_exp_f32 v39, v39
    v_mfma_f32_16x16x32_bf16 a[56:59], a[184:187], v[124:127], a[56:59]
    ds_read_b64_tr_b16 a[178:179], v210 offset:4096
    v_cvt_pk_bf16_f32 v85, v38, v39
    v_mfma_f32_16x16x32_bf16 a[52:55], a[184:187], v[120:123], a[52:55]
    v_exp_f32 v40, v40
    v_mfma_f32_16x16x32_bf16 a[52:55], a[188:191], v[236:239], a[52:55]
    ds_read_b64_tr_b16 a[180:181], v210 offset:8192
    s_waitcnt lgkmcnt(3)
    v_mfma_f32_16x16x32_bf16 a[48:51], a[188:191], v[232:235], a[48:51]
    v_exp_f32 v41, v41
    v_mfma_f32_16x16x32_bf16 a[48:51], a[184:187], v[116:119], a[48:51]
    ds_read_b64_tr_b16 a[182:183], v210 offset:12288
    v_cvt_pk_bf16_f32 v88, v40, v41
    v_mfma_f32_16x16x32_bf16 a[64:67], a[160:163], v[116:119], a[64:67]
    v_exp_f32 v42, v42
    v_mfma_f32_16x16x32_bf16 a[64:67], a[164:167], v[232:235], a[64:67]
    ds_read_b64_tr_b16 a[184:185], v211 offset:0
    v_mfma_f32_16x16x32_bf16 a[68:71], a[164:167], v[236:239], a[68:71]
    v_exp_f32 v43, v43
    v_mfma_f32_16x16x32_bf16 a[68:71], a[160:163], v[120:123], a[68:71]
    ds_read_b64_tr_b16 a[186:187], v211 offset:4096
    v_cvt_pk_bf16_f32 v89, v42, v43
    v_mfma_f32_16x16x32_bf16 a[72:75], a[160:163], v[124:127], a[72:75]
    v_exp_f32 v44, v44
    v_mfma_f32_16x16x32_bf16 a[72:75], a[164:167], v[240:243], a[72:75]
    ds_read_b64_tr_b16 a[188:189], v211 offset:8192
    v_mfma_f32_16x16x32_bf16 a[76:79], a[164:167], v[244:247], a[76:79]
    v_exp_f32 v45, v45
    v_mfma_f32_16x16x32_bf16 a[76:79], a[160:163], v[128:131], a[76:79]
    ds_read_b64_tr_b16 a[190:191], v211 offset:12288
    v_cvt_pk_bf16_f32 v92, v44, v45
    v_mfma_f32_16x16x32_bf16 a[92:95], a[168:171], v[128:131], a[92:95]
    v_exp_f32 v46, v46
    v_mfma_f32_16x16x32_bf16 a[92:95], a[172:175], v[244:247], a[92:95]
    buffer_load_dwordx4 v215, s[4:7], s69 offen offset:3072 lds
    v_mfma_f32_16x16x32_bf16 a[88:91], a[172:175], v[240:243], a[88:91]
    v_exp_f32 v47, v47
    v_mfma_f32_16x16x32_bf16 a[88:91], a[168:171], v[124:127], a[88:91]
    s_add_u32 s69, s69, 16384
    v_cvt_pk_bf16_f32 v93, v46, v47
    v_mfma_f32_16x16x32_bf16 a[84:87], a[168:171], v[120:123], a[84:87]
    v_exp_f32 v48, v48
    v_mfma_f32_16x16x32_bf16 a[84:87], a[172:175], v[236:239], a[84:87]
    s_waitcnt vmcnt(18) lgkmcnt(0)
    s_barrier
    v_mfma_f32_16x16x32_bf16 a[80:83], a[172:175], v[232:235], a[80:83]
    v_exp_f32 v49, v49
    v_mfma_f32_16x16x32_bf16 a[80:83], a[168:171], v[116:119], a[80:83]
    ds_read_b128 a[128:131], v200 offset:32768
    v_cvt_pk_bf16_f32 v96, v48, v49
    v_mfma_f32_16x16x32_bf16 a[96:99], a[176:179], v[116:119], a[96:99]
    v_exp_f32 v50, v50
    v_mfma_f32_16x16x32_bf16 a[96:99], a[180:183], v[232:235], a[96:99]
    ds_read_b128 a[132:135], v201 offset:32768
    v_mfma_f32_16x16x32_bf16 a[100:103], a[180:183], v[236:239], a[100:103]
    v_exp_f32 v51, v51
    v_mfma_f32_16x16x32_bf16 a[100:103], a[176:179], v[120:123], a[100:103]
    ds_read_b128 a[136:139], v202 offset:32768
    v_cvt_pk_bf16_f32 v97, v50, v51
    v_mfma_f32_16x16x32_bf16 a[104:107], a[176:179], v[124:127], a[104:107]
    v_exp_f32 v52, v52
    v_mfma_f32_16x16x32_bf16 a[104:107], a[180:183], v[240:243], a[104:107]
    ds_read_b128 a[140:143], v203 offset:32768
    v_mfma_f32_16x16x32_bf16 a[108:111], a[180:183], v[244:247], a[108:111]
    v_exp_f32 v53, v53
    v_mfma_f32_16x16x32_bf16 a[108:111], a[176:179], v[128:131], a[108:111]
    ds_read_b128 a[144:147], v200 offset:36864
    v_cvt_pk_bf16_f32 v86, v52, v53
    v_mfma_f32_16x16x32_bf16 a[124:127], a[184:187], v[128:131], a[124:127]
    v_exp_f32 v54, v54
    v_mfma_f32_16x16x32_bf16 a[124:127], a[188:191], v[244:247], a[124:127]
    ds_read_b128 a[148:151], v201 offset:36864
    v_mfma_f32_16x16x32_bf16 a[120:123], a[188:191], v[240:243], a[120:123]
    v_exp_f32 v55, v55
    v_mfma_f32_16x16x32_bf16 a[120:123], a[184:187], v[124:127], a[120:123]
    ds_read_b128 a[152:155], v202 offset:36864
    v_cvt_pk_bf16_f32 v87, v54, v55
    v_mfma_f32_16x16x32_bf16 a[116:119], a[184:187], v[120:123], a[116:119]
    v_exp_f32 v56, v56
    v_mfma_f32_16x16x32_bf16 a[116:119], a[188:191], v[236:239], a[116:119]
    ds_read_b128 a[156:159], v203 offset:36864
    v_mfma_f32_16x16x32_bf16 a[112:115], a[188:191], v[232:235], a[112:115]
    v_exp_f32 v57, v57
    v_mfma_f32_16x16x32_bf16 a[112:115], a[184:187], v[116:119], a[112:115]
    s_waitcnt lgkmcnt(4)
    v_cvt_pk_bf16_f32 v90, v56, v57
    v_mfma_f32_16x16x32_bf16 v[4:7], a[128:131], v[132:135], v[100:103]
    v_exp_f32 v58, v58
    v_mfma_f32_16x16x32_bf16 v[4:7], a[132:135], v[136:139], v[4:7]
    ds_read_b64_tr_b16 a[160:161], v204 offset:16384
    s_add_u32 m0, s71, 65536
    v_mfma_f32_16x16x32_bf16 v[4:7], a[136:139], v[140:143], v[4:7]
    v_exp_f32 v59, v59
    v_mfma_f32_16x16x32_bf16 v[4:7], a[140:143], v[144:147], v[4:7]
    ds_read_b64_tr_b16 a[162:163], v204 offset:20480
    v_cvt_pk_bf16_f32 v91, v58, v59
    v_mfma_f32_16x16x32_bf16 v[8:11], a[140:143], v[160:163], v[104:107]
    v_exp_f32 v60, v60
    v_mfma_f32_16x16x32_bf16 v[8:11], a[136:139], v[156:159], v[8:11]
    buffer_load_dwordx4 v216, s[8:11], s70 offen offset:0 lds
    v_mfma_f32_16x16x32_bf16 v[8:11], a[132:135], v[152:155], v[8:11]
    v_exp_f32 v61, v61
    v_mfma_f32_16x16x32_bf16 v[8:11], a[128:131], v[148:151], v[8:11]
    ds_read_b64_tr_b16 a[164:165], v204 offset:24576
    v_cvt_pk_bf16_f32 v94, v60, v61
    v_mfma_f32_16x16x32_bf16 v[12:15], a[128:131], v[164:167], v[108:111]
    v_exp_f32 v62, v62
    v_mfma_f32_16x16x32_bf16 v[12:15], a[132:135], v[168:171], v[12:15]
    ds_read_b64_tr_b16 a[166:167], v204 offset:28672
    v_mfma_f32_16x16x32_bf16 v[12:15], a[136:139], v[172:175], v[12:15]
    v_exp_f32 v63, v63
    v_mfma_f32_16x16x32_bf16 v[12:15], a[140:143], v[176:179], v[12:15]
    ds_read_b64_tr_b16 a[168:169], v205 offset:16384
    v_cvt_pk_bf16_f32 v95, v62, v63
    v_mfma_f32_16x16x32_bf16 v[16:19], a[140:143], v[192:195], v[112:115]
    v_exp_f32 v64, v64
    v_mfma_f32_16x16x32_bf16 v[16:19], a[136:139], v[188:191], v[16:19]
    ds_read_b64_tr_b16 a[170:171], v205 offset:20480
    s_waitcnt lgkmcnt(6)
    v_mfma_f32_16x16x32_bf16 v[16:19], a[132:135], v[184:187], v[16:19]
    v_exp_f32 v65, v65
    v_mfma_f32_16x16x32_bf16 v[16:19], a[128:131], v[180:183], v[16:19]
    ds_read_b64_tr_b16 a[172:173], v205 offset:24576
    v_cvt_pk_bf16_f32 v98, v64, v65
    v_mfma_f32_16x16x32_bf16 v[32:35], a[144:147], v[180:183], v[112:115]
    v_exp_f32 v66, v66
    v_mfma_f32_16x16x32_bf16 v[32:35], a[148:151], v[184:187], v[32:35]
    ds_read_b128 a[128:131], v200 offset:40960
    v_mfma_f32_16x16x32_bf16 v[32:35], a[152:155], v[188:191], v[32:35]
    v_exp_f32 v67, v67
    v_mfma_f32_16x16x32_bf16 v[32:35], a[156:159], v[192:195], v[32:35]
    ds_read_b128 a[132:135], v201 offset:40960
    v_cvt_pk_bf16_f32 v99, v66, v67
    v_mfma_f32_16x16x32_bf16 v[28:31], a[156:159], v[176:179], v[108:111]
    buffer_load_dwordx4 v217, s[8:11], s70 offen offset:1024 lds
    v_mfma_f32_16x16x32_bf16 v[28:31], a[152:155], v[172:175], v[28:31]
    ds_read_b128 a[136:139], v202 offset:40960
    v_mfma_f32_16x16x32_bf16 v[28:31], a[148:151], v[168:171], v[28:31]
    v_exp_f32 v4, v4
    v_mfma_f32_16x16x32_bf16 v[28:31], a[144:147], v[164:167], v[28:31]
    ds_read_b128 a[140:143], v203 offset:40960
    v_mfma_f32_16x16x32_bf16 v[24:27], a[144:147], v[148:151], v[104:107]
    v_exp_f32 v5, v5
    v_mfma_f32_16x16x32_bf16 v[24:27], a[148:151], v[152:155], v[24:27]
    ds_read_b64_tr_b16 a[174:175], v205 offset:28672
    v_cvt_pk_bf16_f32 v116, v4, v5
    v_mfma_f32_16x16x32_bf16 v[24:27], a[152:155], v[156:159], v[24:27]
    v_exp_f32 v6, v6
    v_mfma_f32_16x16x32_bf16 v[24:27], a[156:159], v[160:163], v[24:27]
    ds_read_b64_tr_b16 a[176:177], v206 offset:16384
    v_mfma_f32_16x16x32_bf16 v[20:23], a[156:159], v[144:147], v[100:103]
    v_exp_f32 v7, v7
    v_mfma_f32_16x16x32_bf16 v[20:23], a[152:155], v[140:143], v[20:23]
    ds_read_b64_tr_b16 a[178:179], v206 offset:20480
    v_cvt_pk_bf16_f32 v117, v6, v7
    v_mfma_f32_16x16x32_bf16 v[20:23], a[148:151], v[136:139], v[20:23]
    v_exp_f32 v8, v8
    v_mfma_f32_16x16x32_bf16 v[20:23], a[144:147], v[132:135], v[20:23]
    ds_read_b64_tr_b16 a[180:181], v206 offset:24576
    s_waitcnt lgkmcnt(4)
    v_mfma_f32_16x16x32_bf16 v[36:39], a[128:131], v[132:135], v[100:103]
    v_exp_f32 v9, v9
    v_mfma_f32_16x16x32_bf16 v[36:39], a[132:135], v[136:139], v[36:39]
    ds_read_b128 a[144:147], v200 offset:45056
    v_cvt_pk_bf16_f32 v120, v8, v9
    v_mfma_f32_16x16x32_bf16 v[36:39], a[136:139], v[140:143], v[36:39]
    v_exp_f32 v10, v10
    v_mfma_f32_16x16x32_bf16 v[36:39], a[140:143], v[144:147], v[36:39]
    ds_read_b128 a[148:151], v201 offset:45056
    v_mfma_f32_16x16x32_bf16 v[40:43], a[140:143], v[160:163], v[104:107]
    v_exp_f32 v11, v11
    v_mfma_f32_16x16x32_bf16 v[40:43], a[136:139], v[156:159], v[40:43]
    ds_read_b128 a[152:155], v202 offset:45056
    v_cvt_pk_bf16_f32 v121, v10, v11
    v_mfma_f32_16x16x32_bf16 v[40:43], a[132:135], v[152:155], v[40:43]
    v_exp_f32 v12, v12
    v_mfma_f32_16x16x32_bf16 v[40:43], a[128:131], v[148:151], v[40:43]
    ds_read_b128 a[156:159], v203 offset:45056
    v_mfma_f32_16x16x32_bf16 v[44:47], a[128:131], v[164:167], v[108:111]
    v_exp_f32 v13, v13
    v_mfma_f32_16x16x32_bf16 v[44:47], a[132:135], v[168:171], v[44:47]
    ds_read_b64_tr_b16 a[182:183], v206 offset:28672
    v_cvt_pk_bf16_f32 v124, v12, v13
    v_mfma_f32_16x16x32_bf16 v[44:47], a[136:139], v[172:175], v[44:47]
    v_exp_f32 v14, v14
    v_mfma_f32_16x16x32_bf16 v[44:47], a[140:143], v[176:179], v[44:47]
    buffer_load_dwordx4 v216, s[8:11], s70 offen offset:2048 lds
    v_mfma_f32_16x16x32_bf16 v[48:51], a[140:143], v[192:195], v[112:115]
    v_exp_f32 v15, v15
    v_mfma_f32_16x16x32_bf16 v[48:51], a[136:139], v[188:191], v[48:51]
    ds_read_b64_tr_b16 a[184:185], v207 offset:16384
    v_cvt_pk_bf16_f32 v125, v14, v15
    v_mfma_f32_16x16x32_bf16 v[48:51], a[132:135], v[184:187], v[48:51]
    v_exp_f32 v16, v16
    v_mfma_f32_16x16x32_bf16 v[48:51], a[128:131], v[180:183], v[48:51]
    ds_read_b64_tr_b16 a[186:187], v207 offset:20480
    s_waitcnt lgkmcnt(3)
    v_mfma_f32_16x16x32_bf16 v[64:67], a[144:147], v[180:183], v[112:115]
    v_exp_f32 v17, v17
    v_mfma_f32_16x16x32_bf16 v[64:67], a[148:151], v[184:187], v[64:67]
    ds_read_b64_tr_b16 a[188:189], v207 offset:24576
    v_cvt_pk_bf16_f32 v128, v16, v17
    v_mfma_f32_16x16x32_bf16 v[64:67], a[152:155], v[188:191], v[64:67]
    v_exp_f32 v18, v18
    v_mfma_f32_16x16x32_bf16 v[64:67], a[156:159], v[192:195], v[64:67]
    ds_read_b64_tr_b16 a[190:191], v207 offset:28672
    v_mfma_f32_16x16x32_bf16 v[60:63], a[156:159], v[176:179], v[108:111]
    v_exp_f32 v19, v19
    v_mfma_f32_16x16x32_bf16 v[60:63], a[152:155], v[172:175], v[60:63]
    v_cvt_pk_bf16_f32 v129, v18, v19
    v_mfma_f32_16x16x32_bf16 v[60:63], a[148:151], v[168:171], v[60:63]
    v_exp_f32 v20, v20
    v_mfma_f32_16x16x32_bf16 v[60:63], a[144:147], v[164:167], v[60:63]
    buffer_load_dwordx4 v217, s[8:11], s70 offen offset:3072 lds
    v_mfma_f32_16x16x32_bf16 v[56:59], a[144:147], v[148:151], v[104:107]
    v_exp_f32 v21, v21
    v_mfma_f32_16x16x32_bf16 v[56:59], a[148:151], v[152:155], v[56:59]
    buffer_store_dwordx4 a[212:215], v231, s[32:35], s67 offen sc1
    v_cvt_pk_bf16_f32 v118, v20, v21
    v_mfma_f32_16x16x32_bf16 v[56:59], a[152:155], v[156:159], v[56:59]
    v_exp_f32 v22, v22
    v_mfma_f32_16x16x32_bf16 v[56:59], a[156:159], v[160:163], v[56:59]
    s_add_u32 s70, s70, 16384
    s_add_u32 m0, s71, 16384
    v_mfma_f32_16x16x32_bf16 v[52:55], a[156:159], v[144:147], v[100:103]
    v_exp_f32 v23, v23
    v_mfma_f32_16x16x32_bf16 v[52:55], a[152:155], v[140:143], v[52:55]
    v_cvt_pk_bf16_f32 v119, v22, v23
    v_mfma_f32_16x16x32_bf16 v[52:55], a[148:151], v[136:139], v[52:55]
    v_exp_f32 v24, v24
    v_mfma_f32_16x16x32_bf16 v[52:55], a[144:147], v[132:135], v[52:55]
    buffer_load_dwordx4 v212, s[4:7], s69 offen offset:0 lds
    v_smfmac_f32_16x16x64_bf16 a[196:199], v[196:199], v[76:83], v2
    v_exp_f32 v25, v25
    v_smfmac_f32_16x16x64_bf16 a[196:199], v[196:199], v[92:99], v2
    s_waitcnt lgkmcnt(0)
    v_cvt_pk_bf16_f32 v122, v24, v25
    v_smfmac_f32_16x16x64_bf16 a[192:195], v[196:199], v[84:91], v2
    v_exp_f32 v26, v26
    v_smfmac_f32_16x16x64_bf16 a[192:195], v[196:199], v[68:75], v2
    buffer_load_dwordx4 v213, s[4:7], s69 offen offset:1024 lds
    v_mfma_f32_16x16x32_bf16 a[0:3], a[160:163], v[68:71], a[0:3]
    v_exp_f32 v27, v27
    v_mfma_f32_16x16x32_bf16 a[0:3], a[164:167], v[84:87], a[0:3]
    v_cvt_pk_bf16_f32 v123, v26, v27
    v_mfma_f32_16x16x32_bf16 a[4:7], a[164:167], v[88:91], a[4:7]
    v_exp_f32 v28, v28
    v_mfma_f32_16x16x32_bf16 a[4:7], a[160:163], v[72:75], a[4:7]
    buffer_load_dwordx4 v214, s[4:7], s69 offen offset:2048 lds
    v_mfma_f32_16x16x32_bf16 a[8:11], a[160:163], v[76:79], a[8:11]
    v_exp_f32 v29, v29
    v_mfma_f32_16x16x32_bf16 a[8:11], a[164:167], v[92:95], a[8:11]
    v_cvt_pk_bf16_f32 v126, v28, v29
    v_mfma_f32_16x16x32_bf16 a[12:15], a[164:167], v[96:99], a[12:15]
    v_exp_f32 v30, v30
    v_mfma_f32_16x16x32_bf16 a[12:15], a[160:163], v[80:83], a[12:15]
    buffer_load_dwordx4 v215, s[4:7], s69 offen offset:3072 lds
    v_mfma_f32_16x16x32_bf16 a[28:31], a[168:171], v[80:83], a[28:31]
    v_exp_f32 v31, v31
    v_mfma_f32_16x16x32_bf16 a[28:31], a[172:175], v[96:99], a[28:31]
    ds_read_b64_tr_b16 a[160:161], v208 offset:16384
    v_cvt_pk_bf16_f32 v127, v30, v31
    v_mfma_f32_16x16x32_bf16 a[24:27], a[172:175], v[92:95], a[24:27]
    v_exp_f32 v32, v32
    v_mfma_f32_16x16x32_bf16 a[24:27], a[168:171], v[76:79], a[24:27]
    ds_read_b64_tr_b16 a[162:163], v208 offset:20480
    s_add_u32 s69, s69, 16384
    v_mfma_f32_16x16x32_bf16 a[20:23], a[168:171], v[72:75], a[20:23]
    v_exp_f32 v33, v33
    v_mfma_f32_16x16x32_bf16 a[20:23], a[172:175], v[88:91], a[20:23]
    ds_read_b64_tr_b16 a[164:165], v208 offset:24576
    v_cvt_pk_bf16_f32 v130, v32, v33
    v_mfma_f32_16x16x32_bf16 a[16:19], a[172:175], v[84:87], a[16:19]
    v_exp_f32 v34, v34
    v_mfma_f32_16x16x32_bf16 a[16:19], a[168:171], v[68:71], a[16:19]
    ds_read_b64_tr_b16 a[166:167], v208 offset:28672
    s_mov_b32 m0, s79
    v_mfma_f32_16x16x32_bf16 a[32:35], a[176:179], v[68:71], a[32:35]
    v_exp_f32 v35, v35
    v_mfma_f32_16x16x32_bf16 a[32:35], a[180:183], v[84:87], a[32:35]
    ds_read_b64_tr_b16 a[168:169], v209 offset:16384
    v_cvt_pk_bf16_f32 v131, v34, v35
    v_mfma_f32_16x16x32_bf16 a[36:39], a[180:183], v[88:91], a[36:39]
    buffer_load_dwordx4 v227, s[24:27], s81 offen lds
    v_mfma_f32_16x16x32_bf16 a[36:39], a[176:179], v[72:75], a[36:39]
    ds_read_b64_tr_b16 a[170:171], v209 offset:20480
    v_mfma_f32_16x16x32_bf16 a[40:43], a[176:179], v[76:79], a[40:43]
    v_exp_f32 v36, v36
    v_mfma_f32_16x16x32_bf16 a[40:43], a[180:183], v[92:95], a[40:43]
    ds_read_b64_tr_b16 a[172:173], v209 offset:24576
    v_mfma_f32_16x16x32_bf16 a[44:47], a[180:183], v[96:99], a[44:47]
    v_exp_f32 v37, v37
    v_mfma_f32_16x16x32_bf16 a[44:47], a[176:179], v[80:83], a[44:47]
    ds_read_b64_tr_b16 a[174:175], v209 offset:28672
    v_cvt_pk_bf16_f32 v232, v36, v37
    v_mfma_f32_16x16x32_bf16 a[60:63], a[184:187], v[80:83], a[60:63]
    v_exp_f32 v38, v38
    v_mfma_f32_16x16x32_bf16 a[60:63], a[188:191], v[96:99], a[60:63]
    ds_read_b64_tr_b16 a[176:177], v210 offset:16384
    v_mfma_f32_16x16x32_bf16 a[56:59], a[188:191], v[92:95], a[56:59]
    v_exp_f32 v39, v39
    v_mfma_f32_16x16x32_bf16 a[56:59], a[184:187], v[76:79], a[56:59]
    ds_read_b64_tr_b16 a[178:179], v210 offset:20480
    v_cvt_pk_bf16_f32 v233, v38, v39
    v_mfma_f32_16x16x32_bf16 a[52:55], a[184:187], v[72:75], a[52:55]
    v_exp_f32 v40, v40
    v_mfma_f32_16x16x32_bf16 a[52:55], a[188:191], v[88:91], a[52:55]
    ds_read_b64_tr_b16 a[180:181], v210 offset:24576
    s_waitcnt lgkmcnt(3)
    v_mfma_f32_16x16x32_bf16 a[48:51], a[188:191], v[84:87], a[48:51]
    v_exp_f32 v41, v41
    v_mfma_f32_16x16x32_bf16 a[48:51], a[184:187], v[68:71], a[48:51]
    ds_read_b64_tr_b16 a[182:183], v210 offset:28672
    v_cvt_pk_bf16_f32 v236, v40, v41
    v_mfma_f32_16x16x32_bf16 a[64:67], a[160:163], v[68:71], a[64:67]
    v_exp_f32 v42, v42
    v_mfma_f32_16x16x32_bf16 a[64:67], a[164:167], v[84:87], a[64:67]
    ds_read_b64_tr_b16 a[184:185], v211 offset:16384
    v_mfma_f32_16x16x32_bf16 a[68:71], a[164:167], v[88:91], a[68:71]
    v_exp_f32 v43, v43
    v_mfma_f32_16x16x32_bf16 a[68:71], a[160:163], v[72:75], a[68:71]
    ds_read_b64_tr_b16 a[186:187], v211 offset:20480
    v_cvt_pk_bf16_f32 v237, v42, v43
    v_mfma_f32_16x16x32_bf16 a[72:75], a[160:163], v[76:79], a[72:75]
    v_exp_f32 v44, v44
    v_mfma_f32_16x16x32_bf16 a[72:75], a[164:167], v[92:95], a[72:75]
    ds_read_b64_tr_b16 a[188:189], v211 offset:24576
    v_mfma_f32_16x16x32_bf16 a[76:79], a[164:167], v[96:99], a[76:79]
    v_exp_f32 v45, v45
    v_mfma_f32_16x16x32_bf16 a[76:79], a[160:163], v[80:83], a[76:79]
    ds_read_b64_tr_b16 a[190:191], v211 offset:28672
    v_cvt_pk_bf16_f32 v240, v44, v45
    v_mfma_f32_16x16x32_bf16 a[92:95], a[168:171], v[80:83], a[92:95]
    v_exp_f32 v46, v46
    v_mfma_f32_16x16x32_bf16 a[92:95], a[172:175], v[96:99], a[92:95]
    buffer_load_dwordx4 v228, s[24:27], s81 offen offset:1024 lds
    s_add_u32 s81, s81, 256
    v_mfma_f32_16x16x32_bf16 a[88:91], a[172:175], v[92:95], a[88:91]
    v_exp_f32 v47, v47
    v_mfma_f32_16x16x32_bf16 a[88:91], a[168:171], v[76:79], a[88:91]
    v_cvt_pk_bf16_f32 v241, v46, v47
    v_mfma_f32_16x16x32_bf16 a[84:87], a[168:171], v[72:75], a[84:87]
    v_exp_f32 v48, v48
    v_mfma_f32_16x16x32_bf16 a[84:87], a[172:175], v[88:91], a[84:87]
    s_waitcnt vmcnt(21) lgkmcnt(0)
    s_barrier
    v_mfma_f32_16x16x32_bf16 a[80:83], a[172:175], v[84:87], a[80:83]
    v_exp_f32 v49, v49
    v_mfma_f32_16x16x32_bf16 a[80:83], a[168:171], v[68:71], a[80:83]
    ds_read_b128 a[128:131], v200 offset:49152
    v_cvt_pk_bf16_f32 v244, v48, v49
    v_mfma_f32_16x16x32_bf16 a[96:99], a[176:179], v[68:71], a[96:99]
    v_exp_f32 v50, v50
    v_mfma_f32_16x16x32_bf16 a[96:99], a[180:183], v[84:87], a[96:99]
    ds_read_b128 a[132:135], v201 offset:49152
    s_cmp_eq_u32 s72, 6
    v_mfma_f32_16x16x32_bf16 a[100:103], a[180:183], v[88:91], a[100:103]
    v_exp_f32 v51, v51
    v_mfma_f32_16x16x32_bf16 a[100:103], a[176:179], v[72:75], a[100:103]
    ds_read_b128 a[136:139], v202 offset:49152
    v_cvt_pk_bf16_f32 v245, v50, v51
    v_mfma_f32_16x16x32_bf16 a[104:107], a[176:179], v[76:79], a[104:107]
    v_exp_f32 v52, v52
    v_mfma_f32_16x16x32_bf16 a[104:107], a[180:183], v[92:95], a[104:107]
    ds_read_b128 a[140:143], v203 offset:49152
    s_cselect_b32 s67, 0, 0x100000
    v_mfma_f32_16x16x32_bf16 a[108:111], a[180:183], v[96:99], a[108:111]
    v_exp_f32 v53, v53
    v_mfma_f32_16x16x32_bf16 a[108:111], a[176:179], v[80:83], a[108:111]
    ds_read_b128 a[144:147], v200 offset:53248
    v_cvt_pk_bf16_f32 v234, v52, v53
    v_mfma_f32_16x16x32_bf16 a[124:127], a[184:187], v[80:83], a[124:127]
    v_exp_f32 v54, v54
    v_mfma_f32_16x16x32_bf16 a[124:127], a[188:191], v[96:99], a[124:127]
    ds_read_b128 a[148:151], v201 offset:53248
    v_mfma_f32_16x16x32_bf16 a[120:123], a[188:191], v[92:95], a[120:123]
    v_exp_f32 v55, v55
    v_mfma_f32_16x16x32_bf16 a[120:123], a[184:187], v[76:79], a[120:123]
    ds_read_b128 a[152:155], v202 offset:53248
    v_cvt_pk_bf16_f32 v235, v54, v55
    v_mfma_f32_16x16x32_bf16 a[116:119], a[184:187], v[72:75], a[116:119]
    v_exp_f32 v56, v56
    v_mfma_f32_16x16x32_bf16 a[116:119], a[188:191], v[88:91], a[116:119]
    ds_read_b128 a[156:159], v203 offset:53248
    v_mfma_f32_16x16x32_bf16 a[112:115], a[188:191], v[84:87], a[112:115]
    v_exp_f32 v57, v57
    v_mfma_f32_16x16x32_bf16 a[112:115], a[184:187], v[68:71], a[112:115]
    buffer_load_dwordx4 v[220:223], v231, s[40:43], s67 offen offset:0 sc1
    s_waitcnt lgkmcnt(4)
    v_cvt_pk_bf16_f32 v238, v56, v57
    v_mfma_f32_16x16x32_bf16 v[4:7], a[128:131], v[132:135], v[100:103]
    v_exp_f32 v58, v58
    v_mfma_f32_16x16x32_bf16 v[4:7], a[132:135], v[136:139], v[4:7]
    ds_read_b64_tr_b16 a[160:161], v204 offset:32768
    s_add_u32 m0, s71, 81920
    v_mfma_f32_16x16x32_bf16 v[4:7], a[136:139], v[140:143], v[4:7]
    v_exp_f32 v59, v59
    v_mfma_f32_16x16x32_bf16 v[4:7], a[140:143], v[144:147], v[4:7]
    ds_read_b64_tr_b16 a[162:163], v204 offset:36864
    v_cvt_pk_bf16_f32 v239, v58, v59
    v_mfma_f32_16x16x32_bf16 v[8:11], a[140:143], v[160:163], v[104:107]
    v_exp_f32 v60, v60
    v_mfma_f32_16x16x32_bf16 v[8:11], a[136:139], v[156:159], v[8:11]
    buffer_load_dwordx4 v216, s[8:11], s70 offen offset:0 lds
    v_mfma_f32_16x16x32_bf16 v[8:11], a[132:135], v[152:155], v[8:11]
    v_exp_f32 v61, v61
    v_mfma_f32_16x16x32_bf16 v[8:11], a[128:131], v[148:151], v[8:11]
    ds_read_b64_tr_b16 a[164:165], v204 offset:40960
    v_cvt_pk_bf16_f32 v242, v60, v61
    v_mfma_f32_16x16x32_bf16 v[12:15], a[128:131], v[164:167], v[108:111]
    v_exp_f32 v62, v62
    v_mfma_f32_16x16x32_bf16 v[12:15], a[132:135], v[168:171], v[12:15]
    ds_read_b64_tr_b16 a[166:167], v204 offset:45056
    v_mfma_f32_16x16x32_bf16 v[12:15], a[136:139], v[172:175], v[12:15]
    v_exp_f32 v63, v63
    v_mfma_f32_16x16x32_bf16 v[12:15], a[140:143], v[176:179], v[12:15]
    ds_read_b64_tr_b16 a[168:169], v205 offset:32768
    v_cvt_pk_bf16_f32 v243, v62, v63
    v_mfma_f32_16x16x32_bf16 v[16:19], a[140:143], v[192:195], v[112:115]
    v_exp_f32 v64, v64
    v_mfma_f32_16x16x32_bf16 v[16:19], a[136:139], v[188:191], v[16:19]
    ds_read_b64_tr_b16 a[170:171], v205 offset:36864
    s_waitcnt lgkmcnt(6)
    v_mfma_f32_16x16x32_bf16 v[16:19], a[132:135], v[184:187], v[16:19]
    v_exp_f32 v65, v65
    v_mfma_f32_16x16x32_bf16 v[16:19], a[128:131], v[180:183], v[16:19]
    ds_read_b64_tr_b16 a[172:173], v205 offset:40960
    v_cvt_pk_bf16_f32 v246, v64, v65
    v_mfma_f32_16x16x32_bf16 v[32:35], a[144:147], v[180:183], v[112:115]
    v_exp_f32 v66, v66
    v_mfma_f32_16x16x32_bf16 v[32:35], a[148:151], v[184:187], v[32:35]
    ds_read_b128 a[128:131], v200 offset:57344
    v_mfma_f32_16x16x32_bf16 v[32:35], a[152:155], v[188:191], v[32:35]
    v_exp_f32 v67, v67
    v_mfma_f32_16x16x32_bf16 v[32:35], a[156:159], v[192:195], v[32:35]
    ds_read_b128 a[132:135], v201 offset:57344
    v_cvt_pk_bf16_f32 v247, v66, v67
    v_mfma_f32_16x16x32_bf16 v[28:31], a[156:159], v[176:179], v[108:111]
    buffer_load_dwordx4 v217, s[8:11], s70 offen offset:1024 lds
    v_mfma_f32_16x16x32_bf16 v[28:31], a[152:155], v[172:175], v[28:31]
    ds_read_b128 a[136:139], v202 offset:57344
    v_mfma_f32_16x16x32_bf16 v[28:31], a[148:151], v[168:171], v[28:31]
    v_exp_f32 v4, v4
    v_mfma_f32_16x16x32_bf16 v[28:31], a[144:147], v[164:167], v[28:31]
    ds_read_b128 a[140:143], v203 offset:57344
    v_mfma_f32_16x16x32_bf16 v[24:27], a[144:147], v[148:151], v[104:107]
    v_exp_f32 v5, v5
    v_mfma_f32_16x16x32_bf16 v[24:27], a[148:151], v[152:155], v[24:27]
    ds_read_b64_tr_b16 a[174:175], v205 offset:45056
    v_cvt_pk_bf16_f32 v68, v4, v5
    v_mfma_f32_16x16x32_bf16 v[24:27], a[152:155], v[156:159], v[24:27]
    v_exp_f32 v6, v6
    v_mfma_f32_16x16x32_bf16 v[24:27], a[156:159], v[160:163], v[24:27]
    ds_read_b64_tr_b16 a[176:177], v206 offset:32768
    v_mfma_f32_16x16x32_bf16 v[20:23], a[156:159], v[144:147], v[100:103]
    v_exp_f32 v7, v7
    v_mfma_f32_16x16x32_bf16 v[20:23], a[152:155], v[140:143], v[20:23]
    ds_read_b64_tr_b16 a[178:179], v206 offset:36864
    v_cvt_pk_bf16_f32 v69, v6, v7
    v_mfma_f32_16x16x32_bf16 v[20:23], a[148:151], v[136:139], v[20:23]
    v_exp_f32 v8, v8
    v_mfma_f32_16x16x32_bf16 v[20:23], a[144:147], v[132:135], v[20:23]
    ds_read_b64_tr_b16 a[180:181], v206 offset:40960
    s_waitcnt lgkmcnt(4)
    v_mfma_f32_16x16x32_bf16 v[36:39], a[128:131], v[132:135], v[100:103]
    v_exp_f32 v9, v9
    v_mfma_f32_16x16x32_bf16 v[36:39], a[132:135], v[136:139], v[36:39]
    ds_read_b128 a[144:147], v200 offset:61440
    v_cvt_pk_bf16_f32 v72, v8, v9
    v_mfma_f32_16x16x32_bf16 v[36:39], a[136:139], v[140:143], v[36:39]
    v_exp_f32 v10, v10
    v_mfma_f32_16x16x32_bf16 v[36:39], a[140:143], v[144:147], v[36:39]
    ds_read_b128 a[148:151], v201 offset:61440
    v_mfma_f32_16x16x32_bf16 v[40:43], a[140:143], v[160:163], v[104:107]
    v_exp_f32 v11, v11
    v_mfma_f32_16x16x32_bf16 v[40:43], a[136:139], v[156:159], v[40:43]
    ds_read_b128 a[152:155], v202 offset:61440
    v_cvt_pk_bf16_f32 v73, v10, v11
    v_mfma_f32_16x16x32_bf16 v[40:43], a[132:135], v[152:155], v[40:43]
    v_exp_f32 v12, v12
    v_mfma_f32_16x16x32_bf16 v[40:43], a[128:131], v[148:151], v[40:43]
    ds_read_b128 a[156:159], v203 offset:61440
    v_mfma_f32_16x16x32_bf16 v[44:47], a[128:131], v[164:167], v[108:111]
    v_exp_f32 v13, v13
    v_mfma_f32_16x16x32_bf16 v[44:47], a[132:135], v[168:171], v[44:47]
    ds_read_b64_tr_b16 a[182:183], v206 offset:45056
    v_cvt_pk_bf16_f32 v76, v12, v13
    v_mfma_f32_16x16x32_bf16 v[44:47], a[136:139], v[172:175], v[44:47]
    v_exp_f32 v14, v14
    v_mfma_f32_16x16x32_bf16 v[44:47], a[140:143], v[176:179], v[44:47]
    buffer_load_dwordx4 v216, s[8:11], s70 offen offset:2048 lds
    v_mfma_f32_16x16x32_bf16 v[48:51], a[140:143], v[192:195], v[112:115]
    v_exp_f32 v15, v15
    v_mfma_f32_16x16x32_bf16 v[48:51], a[136:139], v[188:191], v[48:51]
    ds_read_b64_tr_b16 a[184:185], v207 offset:32768
    v_cvt_pk_bf16_f32 v77, v14, v15
    v_mfma_f32_16x16x32_bf16 v[48:51], a[132:135], v[184:187], v[48:51]
    v_exp_f32 v16, v16
    v_mfma_f32_16x16x32_bf16 v[48:51], a[128:131], v[180:183], v[48:51]
    ds_read_b64_tr_b16 a[186:187], v207 offset:36864
    s_waitcnt lgkmcnt(3)
    v_mfma_f32_16x16x32_bf16 v[64:67], a[144:147], v[180:183], v[112:115]
    v_exp_f32 v17, v17
    v_mfma_f32_16x16x32_bf16 v[64:67], a[148:151], v[184:187], v[64:67]
    ds_read_b64_tr_b16 a[188:189], v207 offset:40960
    v_cvt_pk_bf16_f32 v80, v16, v17
    v_mfma_f32_16x16x32_bf16 v[64:67], a[152:155], v[188:191], v[64:67]
    v_exp_f32 v18, v18
    v_mfma_f32_16x16x32_bf16 v[64:67], a[156:159], v[192:195], v[64:67]
    ds_read_b64_tr_b16 a[190:191], v207 offset:45056
    v_mfma_f32_16x16x32_bf16 v[60:63], a[156:159], v[176:179], v[108:111]
    v_exp_f32 v19, v19
    v_mfma_f32_16x16x32_bf16 v[60:63], a[152:155], v[172:175], v[60:63]
    v_cvt_pk_bf16_f32 v81, v18, v19
    v_mfma_f32_16x16x32_bf16 v[60:63], a[148:151], v[168:171], v[60:63]
    v_exp_f32 v20, v20
    v_mfma_f32_16x16x32_bf16 v[60:63], a[144:147], v[164:167], v[60:63]
    buffer_load_dwordx4 v217, s[8:11], s70 offen offset:3072 lds
    v_mfma_f32_16x16x32_bf16 v[56:59], a[144:147], v[148:151], v[104:107]
    v_exp_f32 v21, v21
    v_mfma_f32_16x16x32_bf16 v[56:59], a[148:151], v[152:155], v[56:59]
    v_cvt_pk_bf16_f32 v70, v20, v21
    v_mfma_f32_16x16x32_bf16 v[56:59], a[152:155], v[156:159], v[56:59]
    v_exp_f32 v22, v22
    v_mfma_f32_16x16x32_bf16 v[56:59], a[156:159], v[160:163], v[56:59]
    s_add_u32 s70, s70, 16384
    s_add_u32 m0, s71, 32768
    v_mfma_f32_16x16x32_bf16 v[52:55], a[156:159], v[144:147], v[100:103]
    v_exp_f32 v23, v23
    v_mfma_f32_16x16x32_bf16 v[52:55], a[152:155], v[140:143], v[52:55]
    s_add_u32 s67, s67, s68
    v_cvt_pk_bf16_f32 v71, v22, v23
    v_mfma_f32_16x16x32_bf16 v[52:55], a[148:151], v[136:139], v[52:55]
    v_exp_f32 v24, v24
    v_mfma_f32_16x16x32_bf16 v[52:55], a[144:147], v[132:135], v[52:55]
    buffer_load_dwordx4 v212, s[4:7], s69 offen offset:0 lds
    v_smfmac_f32_16x16x64_bf16 a[196:199], v[196:199], v[124:131], v2
    v_exp_f32 v25, v25
    v_smfmac_f32_16x16x64_bf16 a[196:199], v[196:199], v[240:247], v2
    s_waitcnt lgkmcnt(0)
    v_cvt_pk_bf16_f32 v74, v24, v25
    v_smfmac_f32_16x16x64_bf16 a[192:195], v[196:199], v[232:239], v2
    v_exp_f32 v26, v26
    v_smfmac_f32_16x16x64_bf16 a[192:195], v[196:199], v[116:123], v2
    buffer_load_dword v253, v1, s[28:31], s67 offen
    v_mfma_f32_16x16x32_bf16 a[0:3], a[160:163], v[116:119], a[0:3]
    v_exp_f32 v27, v27
    v_mfma_f32_16x16x32_bf16 a[0:3], a[164:167], v[232:235], a[0:3]
    v_cvt_pk_bf16_f32 v75, v26, v27
    v_mfma_f32_16x16x32_bf16 a[4:7], a[164:167], v[236:239], a[4:7]
    v_exp_f32 v28, v28
    v_mfma_f32_16x16x32_bf16 a[4:7], a[160:163], v[120:123], a[4:7]
    buffer_load_dwordx4 v213, s[4:7], s69 offen offset:1024 lds
    v_mfma_f32_16x16x32_bf16 a[8:11], a[160:163], v[124:127], a[8:11]
    v_exp_f32 v29, v29
    v_mfma_f32_16x16x32_bf16 a[8:11], a[164:167], v[240:243], a[8:11]
    v_cvt_pk_bf16_f32 v78, v28, v29
    v_mfma_f32_16x16x32_bf16 a[12:15], a[164:167], v[244:247], a[12:15]
    v_exp_f32 v30, v30
    v_mfma_f32_16x16x32_bf16 a[12:15], a[160:163], v[128:131], a[12:15]
    v_mfma_f32_16x16x32_bf16 a[28:31], a[168:171], v[128:131], a[28:31]
    v_exp_f32 v31, v31
    v_mfma_f32_16x16x32_bf16 a[28:31], a[172:175], v[244:247], a[28:31]
    ds_read_b64_tr_b16 a[160:161], v208 offset:32768
    v_cvt_pk_bf16_f32 v79, v30, v31
    v_mfma_f32_16x16x32_bf16 a[24:27], a[172:175], v[240:243], a[24:27]
    v_exp_f32 v32, v32
    v_mfma_f32_16x16x32_bf16 a[24:27], a[168:171], v[124:127], a[24:27]
    ds_read_b64_tr_b16 a[162:163], v208 offset:36864
    v_mfma_f32_16x16x32_bf16 a[20:23], a[168:171], v[120:123], a[20:23]
    v_exp_f32 v33, v33
    v_mfma_f32_16x16x32_bf16 a[20:23], a[172:175], v[236:239], a[20:23]
    ds_read_b64_tr_b16 a[164:165], v208 offset:40960
    v_cvt_pk_bf16_f32 v82, v32, v33
    v_mfma_f32_16x16x32_bf16 a[16:19], a[172:175], v[232:235], a[16:19]
    v_exp_f32 v34, v34
    v_mfma_f32_16x16x32_bf16 a[16:19], a[168:171], v[116:119], a[16:19]
    ds_read_b64_tr_b16 a[166:167], v208 offset:45056
    v_mfma_f32_16x16x32_bf16 a[32:35], a[176:179], v[116:119], a[32:35]
    v_exp_f32 v35, v35
    v_mfma_f32_16x16x32_bf16 a[32:35], a[180:183], v[232:235], a[32:35]
    ds_read_b64_tr_b16 a[168:169], v209 offset:32768
    v_cvt_pk_bf16_f32 v83, v34, v35
    v_mfma_f32_16x16x32_bf16 a[36:39], a[180:183], v[236:239], a[36:39]
    buffer_load_dwordx4 v214, s[4:7], s69 offen offset:2048 lds
    v_mfma_f32_16x16x32_bf16 a[36:39], a[176:179], v[120:123], a[36:39]
    ds_read_b64_tr_b16 a[170:171], v209 offset:36864
    v_mfma_f32_16x16x32_bf16 a[40:43], a[176:179], v[124:127], a[40:43]
    v_exp_f32 v36, v36
    v_mfma_f32_16x16x32_bf16 a[40:43], a[180:183], v[240:243], a[40:43]
    ds_read_b64_tr_b16 a[172:173], v209 offset:40960
    v_mfma_f32_16x16x32_bf16 a[44:47], a[180:183], v[244:247], a[44:47]
    v_exp_f32 v37, v37
    v_mfma_f32_16x16x32_bf16 a[44:47], a[176:179], v[128:131], a[44:47]
    ds_read_b64_tr_b16 a[174:175], v209 offset:45056
    v_cvt_pk_bf16_f32 v84, v36, v37
    v_mfma_f32_16x16x32_bf16 a[60:63], a[184:187], v[128:131], a[60:63]
    v_exp_f32 v38, v38
    v_mfma_f32_16x16x32_bf16 a[60:63], a[188:191], v[244:247], a[60:63]
    ds_read_b64_tr_b16 a[176:177], v210 offset:32768
    v_mfma_f32_16x16x32_bf16 a[56:59], a[188:191], v[240:243], a[56:59]
    v_exp_f32 v39, v39
    v_mfma_f32_16x16x32_bf16 a[56:59], a[184:187], v[124:127], a[56:59]
    ds_read_b64_tr_b16 a[178:179], v210 offset:36864
    v_cvt_pk_bf16_f32 v85, v38, v39
    v_mfma_f32_16x16x32_bf16 a[52:55], a[184:187], v[120:123], a[52:55]
    v_exp_f32 v40, v40
    v_mfma_f32_16x16x32_bf16 a[52:55], a[188:191], v[236:239], a[52:55]
    ds_read_b64_tr_b16 a[180:181], v210 offset:40960
    s_waitcnt lgkmcnt(3)
    v_mfma_f32_16x16x32_bf16 a[48:51], a[188:191], v[232:235], a[48:51]
    v_exp_f32 v41, v41
    v_mfma_f32_16x16x32_bf16 a[48:51], a[184:187], v[116:119], a[48:51]
    ds_read_b64_tr_b16 a[182:183], v210 offset:45056
    v_cvt_pk_bf16_f32 v88, v40, v41
    v_mfma_f32_16x16x32_bf16 a[64:67], a[160:163], v[116:119], a[64:67]
    v_exp_f32 v42, v42
    v_mfma_f32_16x16x32_bf16 a[64:67], a[164:167], v[232:235], a[64:67]
    ds_read_b64_tr_b16 a[184:185], v211 offset:32768
    v_mfma_f32_16x16x32_bf16 a[68:71], a[164:167], v[236:239], a[68:71]
    v_exp_f32 v43, v43
    v_mfma_f32_16x16x32_bf16 a[68:71], a[160:163], v[120:123], a[68:71]
    ds_read_b64_tr_b16 a[186:187], v211 offset:36864
    v_cvt_pk_bf16_f32 v89, v42, v43
    v_mfma_f32_16x16x32_bf16 a[72:75], a[160:163], v[124:127], a[72:75]
    v_exp_f32 v44, v44
    v_mfma_f32_16x16x32_bf16 a[72:75], a[164:167], v[240:243], a[72:75]
    ds_read_b64_tr_b16 a[188:189], v211 offset:40960
    v_mfma_f32_16x16x32_bf16 a[76:79], a[164:167], v[244:247], a[76:79]
    v_exp_f32 v45, v45
    v_mfma_f32_16x16x32_bf16 a[76:79], a[160:163], v[128:131], a[76:79]
    ds_read_b64_tr_b16 a[190:191], v211 offset:45056
    v_cvt_pk_bf16_f32 v92, v44, v45
    v_mfma_f32_16x16x32_bf16 a[92:95], a[168:171], v[128:131], a[92:95]
    v_exp_f32 v46, v46
    v_mfma_f32_16x16x32_bf16 a[92:95], a[172:175], v[244:247], a[92:95]
    buffer_load_dwordx4 v215, s[4:7], s69 offen offset:3072 lds
    v_mfma_f32_16x16x32_bf16 a[88:91], a[172:175], v[240:243], a[88:91]
    v_exp_f32 v47, v47
    v_mfma_f32_16x16x32_bf16 a[88:91], a[168:171], v[124:127], a[88:91]
    s_add_u32 s69, s69, 16384
    v_cvt_pk_bf16_f32 v93, v46, v47
    v_mfma_f32_16x16x32_bf16 a[84:87], a[168:171], v[120:123], a[84:87]
    v_exp_f32 v48, v48
    v_mfma_f32_16x16x32_bf16 a[84:87], a[172:175], v[236:239], a[84:87]
    s_waitcnt vmcnt(21) lgkmcnt(0)
    s_barrier
    v_mfma_f32_16x16x32_bf16 a[80:83], a[172:175], v[232:235], a[80:83]
    v_exp_f32 v49, v49
    v_mfma_f32_16x16x32_bf16 a[80:83], a[168:171], v[116:119], a[80:83]
    ds_read_b128 a[128:131], v200 offset:0
    v_cvt_pk_bf16_f32 v96, v48, v49
    v_mfma_f32_16x16x32_bf16 a[96:99], a[176:179], v[116:119], a[96:99]
    v_exp_f32 v50, v50
    v_mfma_f32_16x16x32_bf16 a[96:99], a[180:183], v[232:235], a[96:99]
    ds_read_b128 a[132:135], v201 offset:0
    v_mfma_f32_16x16x32_bf16 a[100:103], a[180:183], v[236:239], a[100:103]
    v_exp_f32 v51, v51
    v_mfma_f32_16x16x32_bf16 a[100:103], a[176:179], v[120:123], a[100:103]
    ds_read_b128 a[136:139], v202 offset:0
    v_cvt_pk_bf16_f32 v97, v50, v51
    v_mfma_f32_16x16x32_bf16 a[104:107], a[176:179], v[124:127], a[104:107]
    v_exp_f32 v52, v52
    v_mfma_f32_16x16x32_bf16 a[104:107], a[180:183], v[240:243], a[104:107]
    ds_read_b128 a[140:143], v203 offset:0
    v_mfma_f32_16x16x32_bf16 a[108:111], a[180:183], v[244:247], a[108:111]
    v_exp_f32 v53, v53
    v_mfma_f32_16x16x32_bf16 a[108:111], a[176:179], v[128:131], a[108:111]
    ds_read_b128 a[144:147], v200 offset:4096
    v_cvt_pk_bf16_f32 v86, v52, v53
    v_mfma_f32_16x16x32_bf16 a[124:127], a[184:187], v[128:131], a[124:127]
    v_exp_f32 v54, v54
    v_mfma_f32_16x16x32_bf16 a[124:127], a[188:191], v[244:247], a[124:127]
    ds_read_b128 a[148:151], v201 offset:4096
    v_mfma_f32_16x16x32_bf16 a[120:123], a[188:191], v[240:243], a[120:123]
    v_exp_f32 v55, v55
    v_mfma_f32_16x16x32_bf16 a[120:123], a[184:187], v[124:127], a[120:123]
    ds_read_b128 a[152:155], v202 offset:4096
    v_cvt_pk_bf16_f32 v87, v54, v55
    v_mfma_f32_16x16x32_bf16 a[116:119], a[184:187], v[120:123], a[116:119]
    v_exp_f32 v56, v56
    v_mfma_f32_16x16x32_bf16 a[116:119], a[188:191], v[236:239], a[116:119]
    ds_read_b128 a[156:159], v203 offset:4096
    v_mfma_f32_16x16x32_bf16 a[112:115], a[188:191], v[232:235], a[112:115]
    v_exp_f32 v57, v57
    v_mfma_f32_16x16x32_bf16 a[112:115], a[184:187], v[116:119], a[112:115]
    s_waitcnt lgkmcnt(4)
    v_cvt_pk_bf16_f32 v90, v56, v57
    v_mfma_f32_16x16x32_bf16 v[4:7], a[128:131], v[132:135], v[100:103]
    v_exp_f32 v58, v58
    v_mfma_f32_16x16x32_bf16 v[4:7], a[132:135], v[136:139], v[4:7]
    ds_read_b64_tr_b16 a[160:161], v204 offset:49152
    s_add_u32 m0, s71, 98304
    v_mfma_f32_16x16x32_bf16 v[4:7], a[136:139], v[140:143], v[4:7]
    v_exp_f32 v59, v59
    v_mfma_f32_16x16x32_bf16 v[4:7], a[140:143], v[144:147], v[4:7]
    ds_read_b64_tr_b16 a[162:163], v204 offset:53248
    v_cvt_pk_bf16_f32 v91, v58, v59
    v_mfma_f32_16x16x32_bf16 v[8:11], a[140:143], v[160:163], v[104:107]
    v_exp_f32 v60, v60
    v_mfma_f32_16x16x32_bf16 v[8:11], a[136:139], v[156:159], v[8:11]
    buffer_load_dwordx4 v216, s[8:11], s70 offen offset:0 lds
    v_mfma_f32_16x16x32_bf16 v[8:11], a[132:135], v[152:155], v[8:11]
    v_exp_f32 v61, v61
    v_mfma_f32_16x16x32_bf16 v[8:11], a[128:131], v[148:151], v[8:11]
    ds_read_b64_tr_b16 a[164:165], v204 offset:57344
    v_cvt_pk_bf16_f32 v94, v60, v61
    v_mfma_f32_16x16x32_bf16 v[12:15], a[128:131], v[164:167], v[108:111]
    v_exp_f32 v62, v62
    v_mfma_f32_16x16x32_bf16 v[12:15], a[132:135], v[168:171], v[12:15]
    ds_read_b64_tr_b16 a[166:167], v204 offset:61440
    v_mfma_f32_16x16x32_bf16 v[12:15], a[136:139], v[172:175], v[12:15]
    v_exp_f32 v63, v63
    v_mfma_f32_16x16x32_bf16 v[12:15], a[140:143], v[176:179], v[12:15]
    ds_read_b64_tr_b16 a[168:169], v205 offset:49152
    v_cvt_pk_bf16_f32 v95, v62, v63
    v_mfma_f32_16x16x32_bf16 v[16:19], a[140:143], v[192:195], v[112:115]
    v_exp_f32 v64, v64
    v_mfma_f32_16x16x32_bf16 v[16:19], a[136:139], v[188:191], v[16:19]
    ds_read_b64_tr_b16 a[170:171], v205 offset:53248
    s_waitcnt lgkmcnt(6)
    v_mfma_f32_16x16x32_bf16 v[16:19], a[132:135], v[184:187], v[16:19]
    v_exp_f32 v65, v65
    v_mfma_f32_16x16x32_bf16 v[16:19], a[128:131], v[180:183], v[16:19]
    ds_read_b64_tr_b16 a[172:173], v205 offset:57344
    v_cvt_pk_bf16_f32 v98, v64, v65
    v_mfma_f32_16x16x32_bf16 v[32:35], a[144:147], v[180:183], v[112:115]
    v_exp_f32 v66, v66
    v_mfma_f32_16x16x32_bf16 v[32:35], a[148:151], v[184:187], v[32:35]
    ds_read_b128 a[128:131], v200 offset:8192
    v_mfma_f32_16x16x32_bf16 v[32:35], a[152:155], v[188:191], v[32:35]
    v_exp_f32 v67, v67
    v_mfma_f32_16x16x32_bf16 v[32:35], a[156:159], v[192:195], v[32:35]
    ds_read_b128 a[132:135], v201 offset:8192
    v_cvt_pk_bf16_f32 v99, v66, v67
    v_mfma_f32_16x16x32_bf16 v[28:31], a[156:159], v[176:179], v[108:111]
    buffer_load_dwordx4 v217, s[8:11], s70 offen offset:1024 lds
    v_mfma_f32_16x16x32_bf16 v[28:31], a[152:155], v[172:175], v[28:31]
    ds_read_b128 a[136:139], v202 offset:8192
    v_mfma_f32_16x16x32_bf16 v[28:31], a[148:151], v[168:171], v[28:31]
    v_exp_f32 v4, v4
    v_mfma_f32_16x16x32_bf16 v[28:31], a[144:147], v[164:167], v[28:31]
    ds_read_b128 a[140:143], v203 offset:8192
    v_mfma_f32_16x16x32_bf16 v[24:27], a[144:147], v[148:151], v[104:107]
    v_exp_f32 v5, v5
    v_mfma_f32_16x16x32_bf16 v[24:27], a[148:151], v[152:155], v[24:27]
    ds_read_b64_tr_b16 a[174:175], v205 offset:61440
    v_cvt_pk_bf16_f32 v116, v4, v5
    v_mfma_f32_16x16x32_bf16 v[24:27], a[152:155], v[156:159], v[24:27]
    v_exp_f32 v6, v6
    v_mfma_f32_16x16x32_bf16 v[24:27], a[156:159], v[160:163], v[24:27]
    ds_read_b64_tr_b16 a[176:177], v206 offset:49152
    v_mfma_f32_16x16x32_bf16 v[20:23], a[156:159], v[144:147], v[100:103]
    v_exp_f32 v7, v7
    v_mfma_f32_16x16x32_bf16 v[20:23], a[152:155], v[140:143], v[20:23]
    ds_read_b64_tr_b16 a[178:179], v206 offset:53248
    v_cvt_pk_bf16_f32 v117, v6, v7
    v_mfma_f32_16x16x32_bf16 v[20:23], a[148:151], v[136:139], v[20:23]
    v_exp_f32 v8, v8
    v_mfma_f32_16x16x32_bf16 v[20:23], a[144:147], v[132:135], v[20:23]
    ds_read_b64_tr_b16 a[180:181], v206 offset:57344
    s_waitcnt lgkmcnt(4)
    v_mfma_f32_16x16x32_bf16 v[36:39], a[128:131], v[132:135], v[100:103]
    v_exp_f32 v9, v9
    v_mfma_f32_16x16x32_bf16 v[36:39], a[132:135], v[136:139], v[36:39]
    ds_read_b128 a[144:147], v200 offset:12288
    v_cvt_pk_bf16_f32 v120, v8, v9
    v_mfma_f32_16x16x32_bf16 v[36:39], a[136:139], v[140:143], v[36:39]
    v_exp_f32 v10, v10
    v_mfma_f32_16x16x32_bf16 v[36:39], a[140:143], v[144:147], v[36:39]
    ds_read_b128 a[148:151], v201 offset:12288
    v_mfma_f32_16x16x32_bf16 v[40:43], a[140:143], v[160:163], v[104:107]
    v_exp_f32 v11, v11
    v_mfma_f32_16x16x32_bf16 v[40:43], a[136:139], v[156:159], v[40:43]
    ds_read_b128 a[152:155], v202 offset:12288
    v_cvt_pk_bf16_f32 v121, v10, v11
    v_mfma_f32_16x16x32_bf16 v[40:43], a[132:135], v[152:155], v[40:43]
    v_exp_f32 v12, v12
    v_mfma_f32_16x16x32_bf16 v[40:43], a[128:131], v[148:151], v[40:43]
    ds_read_b128 a[156:159], v203 offset:12288
    v_mfma_f32_16x16x32_bf16 v[44:47], a[128:131], v[164:167], v[108:111]
    v_exp_f32 v13, v13
    v_mfma_f32_16x16x32_bf16 v[44:47], a[132:135], v[168:171], v[44:47]
    ds_read_b64_tr_b16 a[182:183], v206 offset:61440
    v_cvt_pk_bf16_f32 v124, v12, v13
    v_mfma_f32_16x16x32_bf16 v[44:47], a[136:139], v[172:175], v[44:47]
    v_exp_f32 v14, v14
    v_mfma_f32_16x16x32_bf16 v[44:47], a[140:143], v[176:179], v[44:47]
    buffer_load_dwordx4 v216, s[8:11], s70 offen offset:2048 lds
    v_mfma_f32_16x16x32_bf16 v[48:51], a[140:143], v[192:195], v[112:115]
    v_exp_f32 v15, v15
    v_mfma_f32_16x16x32_bf16 v[48:51], a[136:139], v[188:191], v[48:51]
    ds_read_b64_tr_b16 a[184:185], v207 offset:49152
    v_cvt_pk_bf16_f32 v125, v14, v15
    v_mfma_f32_16x16x32_bf16 v[48:51], a[132:135], v[184:187], v[48:51]
    v_exp_f32 v16, v16
    v_mfma_f32_16x16x32_bf16 v[48:51], a[128:131], v[180:183], v[48:51]
    ds_read_b64_tr_b16 a[186:187], v207 offset:53248
    s_waitcnt lgkmcnt(3)
    v_mfma_f32_16x16x32_bf16 v[64:67], a[144:147], v[180:183], v[112:115]
    v_exp_f32 v17, v17
    v_mfma_f32_16x16x32_bf16 v[64:67], a[148:151], v[184:187], v[64:67]
    ds_read_b64_tr_b16 a[188:189], v207 offset:57344
    v_cvt_pk_bf16_f32 v128, v16, v17
    v_mfma_f32_16x16x32_bf16 v[64:67], a[152:155], v[188:191], v[64:67]
    v_exp_f32 v18, v18
    v_mfma_f32_16x16x32_bf16 v[64:67], a[156:159], v[192:195], v[64:67]
    ds_read_b64_tr_b16 a[190:191], v207 offset:61440
    v_mfma_f32_16x16x32_bf16 v[60:63], a[156:159], v[176:179], v[108:111]
    v_exp_f32 v19, v19
    v_mfma_f32_16x16x32_bf16 v[60:63], a[152:155], v[172:175], v[60:63]
    v_cvt_pk_bf16_f32 v129, v18, v19
    v_mfma_f32_16x16x32_bf16 v[60:63], a[148:151], v[168:171], v[60:63]
    v_exp_f32 v20, v20
    v_mfma_f32_16x16x32_bf16 v[60:63], a[144:147], v[164:167], v[60:63]
    buffer_load_dwordx4 v217, s[8:11], s70 offen offset:3072 lds
    v_mfma_f32_16x16x32_bf16 v[56:59], a[144:147], v[148:151], v[104:107]
    v_exp_f32 v21, v21
    v_mfma_f32_16x16x32_bf16 v[56:59], a[148:151], v[152:155], v[56:59]
    v_cvt_pk_bf16_f32 v118, v20, v21
    v_mfma_f32_16x16x32_bf16 v[56:59], a[152:155], v[156:159], v[56:59]
    v_exp_f32 v22, v22
    v_mfma_f32_16x16x32_bf16 v[56:59], a[156:159], v[160:163], v[56:59]
    s_add_u32 s70, s70, 16384
    s_add_u32 m0, s71, 49152
    v_mfma_f32_16x16x32_bf16 v[52:55], a[156:159], v[144:147], v[100:103]
    v_exp_f32 v23, v23
    v_mfma_f32_16x16x32_bf16 v[52:55], a[152:155], v[140:143], v[52:55]
    v_cvt_pk_bf16_f32 v119, v22, v23
    v_mfma_f32_16x16x32_bf16 v[52:55], a[148:151], v[136:139], v[52:55]
    v_exp_f32 v24, v24
    v_mfma_f32_16x16x32_bf16 v[52:55], a[144:147], v[132:135], v[52:55]
    buffer_load_dwordx4 v212, s[4:7], s69 offen offset:0 lds
    v_smfmac_f32_16x16x64_bf16 a[196:199], v[196:199], v[76:83], v2
    v_exp_f32 v25, v25
    v_smfmac_f32_16x16x64_bf16 a[196:199], v[196:199], v[92:99], v2
    s_waitcnt lgkmcnt(0)
    v_cvt_pk_bf16_f32 v122, v24, v25
    v_smfmac_f32_16x16x64_bf16 a[192:195], v[196:199], v[84:91], v2
    v_exp_f32 v26, v26
    v_smfmac_f32_16x16x64_bf16 a[192:195], v[196:199], v[68:75], v2
    s_cmp_eq_u32 s72, 4
    s_cselect_b32 s67, s74, 0x100000
    v_mfma_f32_16x16x32_bf16 a[0:3], a[160:163], v[68:71], a[0:3]
    v_exp_f32 v27, v27
    v_mfma_f32_16x16x32_bf16 a[0:3], a[164:167], v[84:87], a[0:3]
    v_cvt_pk_bf16_f32 v123, v26, v27
    v_mfma_f32_16x16x32_bf16 a[4:7], a[164:167], v[88:91], a[4:7]
    v_exp_f32 v28, v28
    v_mfma_f32_16x16x32_bf16 a[4:7], a[160:163], v[72:75], a[4:7]
    buffer_load_dwordx4 v213, s[4:7], s69 offen offset:1024 lds
    v_mfma_f32_16x16x32_bf16 a[8:11], a[160:163], v[76:79], a[8:11]
    v_exp_f32 v29, v29
    v_mfma_f32_16x16x32_bf16 a[8:11], a[164:167], v[92:95], a[8:11]
    v_cvt_pk_bf16_f32 v126, v28, v29
    v_mfma_f32_16x16x32_bf16 a[12:15], a[164:167], v[96:99], a[12:15]
    v_exp_f32 v30, v30
    v_mfma_f32_16x16x32_bf16 a[12:15], a[160:163], v[80:83], a[12:15]
    v_mfma_f32_16x16x32_bf16 a[28:31], a[168:171], v[80:83], a[28:31]
    v_exp_f32 v31, v31
    v_mfma_f32_16x16x32_bf16 a[28:31], a[172:175], v[96:99], a[28:31]
    ds_read_b64_tr_b16 a[160:161], v208 offset:49152
    v_cvt_pk_bf16_f32 v127, v30, v31
    v_mfma_f32_16x16x32_bf16 a[24:27], a[172:175], v[92:95], a[24:27]
    v_exp_f32 v32, v32
    v_mfma_f32_16x16x32_bf16 a[24:27], a[168:171], v[76:79], a[24:27]
    ds_read_b64_tr_b16 a[162:163], v208 offset:53248
    v_mfma_f32_16x16x32_bf16 a[20:23], a[168:171], v[72:75], a[20:23]
    v_exp_f32 v33, v33
    v_mfma_f32_16x16x32_bf16 a[20:23], a[172:175], v[88:91], a[20:23]
    ds_read_b64_tr_b16 a[164:165], v208 offset:57344
    v_cvt_pk_bf16_f32 v130, v32, v33
    v_mfma_f32_16x16x32_bf16 a[16:19], a[172:175], v[84:87], a[16:19]
    v_exp_f32 v34, v34
    v_mfma_f32_16x16x32_bf16 a[16:19], a[168:171], v[68:71], a[16:19]
    ds_read_b64_tr_b16 a[166:167], v208 offset:61440
    v_mfma_f32_16x16x32_bf16 a[32:35], a[176:179], v[68:71], a[32:35]
    v_exp_f32 v35, v35
    v_mfma_f32_16x16x32_bf16 a[32:35], a[180:183], v[84:87], a[32:35]
    ds_read_b64_tr_b16 a[168:169], v209 offset:49152
    v_cvt_pk_bf16_f32 v131, v34, v35
    v_mfma_f32_16x16x32_bf16 a[36:39], a[180:183], v[88:91], a[36:39]
    buffer_load_dwordx4 v214, s[4:7], s69 offen offset:2048 lds
    v_mfma_f32_16x16x32_bf16 a[36:39], a[176:179], v[72:75], a[36:39]
    ds_read_b64_tr_b16 a[170:171], v209 offset:53248
    v_mfma_f32_16x16x32_bf16 a[40:43], a[176:179], v[76:79], a[40:43]
    v_exp_f32 v36, v36
    v_mfma_f32_16x16x32_bf16 a[40:43], a[180:183], v[92:95], a[40:43]
    ds_read_b64_tr_b16 a[172:173], v209 offset:57344
    v_mfma_f32_16x16x32_bf16 a[44:47], a[180:183], v[96:99], a[44:47]
    v_exp_f32 v37, v37
    v_mfma_f32_16x16x32_bf16 a[44:47], a[176:179], v[80:83], a[44:47]
    ds_read_b64_tr_b16 a[174:175], v209 offset:61440
    v_cvt_pk_bf16_f32 v232, v36, v37
    v_mfma_f32_16x16x32_bf16 a[60:63], a[184:187], v[80:83], a[60:63]
    v_exp_f32 v38, v38
    v_mfma_f32_16x16x32_bf16 a[60:63], a[188:191], v[96:99], a[60:63]
    ds_read_b64_tr_b16 a[176:177], v210 offset:49152
    v_mfma_f32_16x16x32_bf16 a[56:59], a[188:191], v[92:95], a[56:59]
    v_exp_f32 v39, v39
    v_mfma_f32_16x16x32_bf16 a[56:59], a[184:187], v[76:79], a[56:59]
    ds_read_b64_tr_b16 a[178:179], v210 offset:53248
    v_cvt_pk_bf16_f32 v233, v38, v39
    v_mfma_f32_16x16x32_bf16 a[52:55], a[184:187], v[72:75], a[52:55]
    v_exp_f32 v40, v40
    v_mfma_f32_16x16x32_bf16 a[52:55], a[188:191], v[88:91], a[52:55]
    ds_read_b64_tr_b16 a[180:181], v210 offset:57344
    s_waitcnt lgkmcnt(3)
    v_mfma_f32_16x16x32_bf16 a[48:51], a[188:191], v[84:87], a[48:51]
    v_exp_f32 v41, v41
    v_mfma_f32_16x16x32_bf16 a[48:51], a[184:187], v[68:71], a[48:51]
    ds_read_b64_tr_b16 a[182:183], v210 offset:61440
    v_cvt_pk_bf16_f32 v236, v40, v41
    v_mfma_f32_16x16x32_bf16 a[64:67], a[160:163], v[68:71], a[64:67]
    v_exp_f32 v42, v42
    v_mfma_f32_16x16x32_bf16 a[64:67], a[164:167], v[84:87], a[64:67]
    ds_read_b64_tr_b16 a[184:185], v211 offset:49152
    v_mfma_f32_16x16x32_bf16 a[68:71], a[164:167], v[88:91], a[68:71]
    v_exp_f32 v43, v43
    v_mfma_f32_16x16x32_bf16 a[68:71], a[160:163], v[72:75], a[68:71]
    ds_read_b64_tr_b16 a[186:187], v211 offset:53248
    v_cvt_pk_bf16_f32 v237, v42, v43
    v_mfma_f32_16x16x32_bf16 a[72:75], a[160:163], v[76:79], a[72:75]
    v_exp_f32 v44, v44
    v_mfma_f32_16x16x32_bf16 a[72:75], a[164:167], v[92:95], a[72:75]
    ds_read_b64_tr_b16 a[188:189], v211 offset:57344
    v_mfma_f32_16x16x32_bf16 a[76:79], a[164:167], v[96:99], a[76:79]
    v_exp_f32 v45, v45
    v_mfma_f32_16x16x32_bf16 a[76:79], a[160:163], v[80:83], a[76:79]
    ds_read_b64_tr_b16 a[190:191], v211 offset:61440
    v_cvt_pk_bf16_f32 v240, v44, v45
    v_mfma_f32_16x16x32_bf16 a[92:95], a[168:171], v[80:83], a[92:95]
    v_exp_f32 v46, v46
    v_mfma_f32_16x16x32_bf16 a[92:95], a[172:175], v[96:99], a[92:95]
    buffer_load_dwordx4 v215, s[4:7], s69 offen offset:3072 lds
    v_mfma_f32_16x16x32_bf16 a[88:91], a[172:175], v[92:95], a[88:91]
    v_exp_f32 v47, v47
    v_mfma_f32_16x16x32_bf16 a[88:91], a[168:171], v[76:79], a[88:91]
    s_add_u32 s69, s69, 16384
    v_cvt_pk_bf16_f32 v241, v46, v47
    v_mfma_f32_16x16x32_bf16 a[84:87], a[168:171], v[72:75], a[84:87]
    v_exp_f32 v48, v48
    v_mfma_f32_16x16x32_bf16 a[84:87], a[172:175], v[88:91], a[84:87]
    s_waitcnt vmcnt(17) lgkmcnt(0)
    s_barrier
    v_mfma_f32_16x16x32_bf16 a[80:83], a[172:175], v[84:87], a[80:83]
    v_exp_f32 v49, v49
    v_mfma_f32_16x16x32_bf16 a[80:83], a[168:171], v[68:71], a[80:83]
    ds_read_b128 a[128:131], v200 offset:16384
    v_cvt_pk_bf16_f32 v244, v48, v49
    v_mfma_f32_16x16x32_bf16 a[96:99], a[176:179], v[68:71], a[96:99]
    v_exp_f32 v50, v50
    v_mfma_f32_16x16x32_bf16 a[96:99], a[180:183], v[84:87], a[96:99]
    ds_read_b128 a[132:135], v201 offset:16384
    s_add_u32 s72, s72, 1
    v_mfma_f32_16x16x32_bf16 a[100:103], a[180:183], v[88:91], a[100:103]
    v_exp_f32 v51, v51
    v_mfma_f32_16x16x32_bf16 a[100:103], a[176:179], v[72:75], a[100:103]
    ds_read_b128 a[136:139], v202 offset:16384
    v_cvt_pk_bf16_f32 v245, v50, v51
    v_mfma_f32_16x16x32_bf16 a[104:107], a[176:179], v[76:79], a[104:107]
    v_exp_f32 v52, v52
    v_mfma_f32_16x16x32_bf16 a[104:107], a[180:183], v[92:95], a[104:107]
    ds_read_b128 a[140:143], v203 offset:16384
    s_cmp_lt_u32 s72, 7
    v_mfma_f32_16x16x32_bf16 a[108:111], a[180:183], v[96:99], a[108:111]
    v_exp_f32 v53, v53
    v_mfma_f32_16x16x32_bf16 a[108:111], a[176:179], v[80:83], a[108:111]
    ds_read_b128 a[144:147], v200 offset:20480
    v_cvt_pk_bf16_f32 v234, v52, v53
    v_mfma_f32_16x16x32_bf16 a[124:127], a[184:187], v[80:83], a[124:127]
    v_exp_f32 v54, v54
    v_mfma_f32_16x16x32_bf16 a[124:127], a[188:191], v[96:99], a[124:127]
    ds_read_b128 a[148:151], v201 offset:20480
    v_mfma_f32_16x16x32_bf16 a[120:123], a[188:191], v[92:95], a[120:123]
    v_exp_f32 v55, v55
    v_mfma_f32_16x16x32_bf16 a[120:123], a[184:187], v[76:79], a[120:123]
    ds_read_b128 a[152:155], v202 offset:20480
    v_cvt_pk_bf16_f32 v235, v54, v55
    v_mfma_f32_16x16x32_bf16 a[116:119], a[184:187], v[72:75], a[116:119]
    v_exp_f32 v56, v56
    v_mfma_f32_16x16x32_bf16 a[116:119], a[188:191], v[88:91], a[116:119]
    ds_read_b128 a[156:159], v203 offset:20480
    v_mfma_f32_16x16x32_bf16 a[112:115], a[188:191], v[84:87], a[112:115]
    v_exp_f32 v57, v57
    v_mfma_f32_16x16x32_bf16 a[112:115], a[184:187], v[68:71], a[112:115]
    buffer_store_dword v254, v255, s[40:43], s67 offen offset:0 sc1
    s_waitcnt lgkmcnt(4)
    v_cvt_pk_bf16_f32 v238, v56, v57
    s_cbranch_scc1 L_loop
L_pen:
    s_mov_b32 s72, 0
    s_branch L_fw_chk
L_fw_spin:
    buffer_load_dwordx4 v[220:223], v231, s[40:43], 0 offen offset:0 sc1
    s_waitcnt vmcnt(0)
L_fw_chk:
    v_xor_b32 v220, s82, v220
    v_xor_b32 v221, s82, v221
    v_xor_b32 v222, s82, v222
    v_xor_b32 v223, s82, v223
    v_or3_b32 v220, v220, v222, v223
    v_or_b32 v220, v220, v221
    v_cmp_ne_u32 vcc, 0, v220
    s_add_u32 s72, s72, 1
    s_cmp_eq_u64 vcc, 0
    s_cbranch_scc1 L_fw_ok
    s_sleep 2
    s_cmp_lt_u32 s72, 400000
    s_cbranch_scc1 L_fw_spin
L_fw_ok:
    v_mfma_f32_16x16x32_bf16 v[4:7], a[128:131], v[132:135], v[100:103]
    v_exp_f32 v58, v58
    v_mfma_f32_16x16x32_bf16 v[4:7], a[132:135], v[136:139], v[4:7]
    ds_read_b64_tr_b16 a[160:161], v204 offset:0
    s_lshl_b32 s67, s64, 16
    v_mfma_f32_16x16x32_bf16 v[4:7], a[136:139], v[140:143], v[4:7]
    v_exp_f32 v59, v59
    v_mfma_f32_16x16x32_bf16 v[4:7], a[140:143], v[144:147], v[4:7]
    ds_read_b64_tr_b16 a[162:163], v204 offset:4096
    v_cvt_pk_bf16_f32 v239, v58, v59
    v_mfma_f32_16x16x32_bf16 v[8:11], a[140:143], v[160:163], v[104:107]
    v_exp_f32 v60, v60
    v_mfma_f32_16x16x32_bf16 v[8:11], a[136:139], v[156:159], v[8:11]
    ds_read_b64_tr_b16 a[164:165], v204 offset:8192
    s_lshl_b32 s81, s77, 10
    v_mfma_f32_16x16x32_bf16 v[8:11], a[132:135], v[152:155], v[8:11]
    v_exp_f32 v61, v61
    v_mfma_f32_16x16x32_bf16 v[8:11], a[128:131], v[148:151], v[8:11]
    ds_read_b64_tr_b16 a[166:167], v204 offset:12288
    v_cvt_pk_bf16_f32 v242, v60, v61
    v_mfma_f32_16x16x32_bf16 v[12:15], a[128:131], v[164:167], v[108:111]
    v_exp_f32 v62, v62
    v_mfma_f32_16x16x32_bf16 v[12:15], a[132:135], v[168:171], v[12:15]
    ds_read_b64_tr_b16 a[168:169], v205 offset:0
    s_add_u32 s67, s67, s81
    v_mfma_f32_16x16x32_bf16 v[12:15], a[136:139], v[172:175], v[12:15]
    v_exp_f32 v63, v63
    v_mfma_f32_16x16x32_bf16 v[12:15], a[140:143], v[176:179], v[12:15]
    ds_read_b64_tr_b16 a[170:171], v205 offset:4096
    v_cvt_pk_bf16_f32 v243, v62, v63
    v_mfma_f32_16x16x32_bf16 v[16:19], a[140:143], v[192:195], v[112:115]
    v_exp_f32 v64, v64
    v_mfma_f32_16x16x32_bf16 v[16:19], a[136:139], v[188:191], v[16:19]
    ds_read_b64_tr_b16 a[172:173], v205 offset:8192
    s_waitcnt lgkmcnt(7)
    s_mov_b32 s79, 0
    v_mfma_f32_16x16x32_bf16 v[16:19], a[132:135], v[184:187], v[16:19]
    v_exp_f32 v65, v65
    v_mfma_f32_16x16x32_bf16 v[16:19], a[128:131], v[180:183], v[16:19]
    ds_read_b64_tr_b16 a[174:175], v205 offset:12288
    v_cvt_pk_bf16_f32 v246, v64, v65
    v_mfma_f32_16x16x32_bf16 v[32:35], a[144:147], v[180:183], v[112:115]
    v_exp_f32 v66, v66
    v_mfma_f32_16x16x32_bf16 v[32:35], a[148:151], v[184:187], v[32:35]
    ds_read_b128 a[128:131], v200 offset:24576
    buffer_load_dwordx4 a[208:211], v231, s[44:47], s79 offen offset:0 sc1
    v_mfma_f32_16x16x32_bf16 v[32:35], a[152:155], v[188:191], v[32:35]
    v_exp_f32 v67, v67
    v_mfma_f32_16x16x32_bf16 v[32:35], a[156:159], v[192:195], v[32:35]
    ds_read_b128 a[132:135], v201 offset:24576
    v_cvt_pk_bf16_f32 v247, v66, v67
    v_mfma_f32_16x16x32_bf16 v[28:31], a[156:159], v[176:179], v[108:111]
    buffer_load_dwordx4 v[220:223], v231, s[40:43], s67 offen
    v_mfma_f32_16x16x32_bf16 v[28:31], a[152:155], v[172:175], v[28:31]
    ds_read_b128 a[136:139], v202 offset:24576
    buffer_load_dwordx4 a[212:215], v231, s[44:47], s79 offen offset:1024 sc1
    v_mfma_f32_16x16x32_bf16 v[28:31], a[148:151], v[168:171], v[28:31]
    v_exp_f32 v4, v4
    v_mfma_f32_16x16x32_bf16 v[28:31], a[144:147], v[164:167], v[28:31]
    ds_read_b128 a[140:143], v203 offset:24576
    v_mfma_f32_16x16x32_bf16 v[24:27], a[144:147], v[148:151], v[104:107]
    v_exp_f32 v5, v5
    v_mfma_f32_16x16x32_bf16 v[24:27], a[148:151], v[152:155], v[24:27]
    ds_read_b64_tr_b16 a[176:177], v206 offset:0
    v_cvt_pk_bf16_f32 v68, v4, v5
    v_mfma_f32_16x16x32_bf16 v[24:27], a[152:155], v[156:159], v[24:27]
    v_exp_f32 v6, v6
    v_mfma_f32_16x16x32_bf16 v[24:27], a[156:159], v[160:163], v[24:27]
    ds_read_b64_tr_b16 a[178:179], v206 offset:4096
    buffer_load_dwordx4 a[216:219], v231, s[44:47], s79 offen offset:2048 sc1
    v_mfma_f32_16x16x32_bf16 v[20:23], a[156:159], v[144:147], v[100:103]
    v_exp_f32 v7, v7
    v_mfma_f32_16x16x32_bf16 v[20:23], a[152:155], v[140:143], v[20:23]
    ds_read_b64_tr_b16 a[180:181], v206 offset:8192
    v_cvt_pk_bf16_f32 v69, v6, v7
    v_mfma_f32_16x16x32_bf16 v[20:23], a[148:151], v[136:139], v[20:23]
    v_exp_f32 v8, v8
    v_mfma_f32_16x16x32_bf16 v[20:23], a[144:147], v[132:135], v[20:23]
    ds_read_b64_tr_b16 a[182:183], v206 offset:12288
    s_waitcnt lgkmcnt(4)
    v_mfma_f32_16x16x32_bf16 v[36:39], a[128:131], v[132:135], v[100:103]
    v_exp_f32 v9, v9
    v_mfma_f32_16x16x32_bf16 v[36:39], a[132:135], v[136:139], v[36:39]
    ds_read_b128 a[144:147], v200 offset:28672
    v_cvt_pk_bf16_f32 v72, v8, v9
    v_mfma_f32_16x16x32_bf16 v[36:39], a[136:139], v[140:143], v[36:39]
    v_exp_f32 v10, v10
    v_mfma_f32_16x16x32_bf16 v[36:39], a[140:143], v[144:147], v[36:39]
    ds_read_b128 a[148:151], v201 offset:28672
    buffer_load_dwordx4 a[220:223], v231, s[44:47], s79 offen offset:3072 sc1
    v_mfma_f32_16x16x32_bf16 v[40:43], a[140:143], v[160:163], v[104:107]
    v_exp_f32 v11, v11
    v_mfma_f32_16x16x32_bf16 v[40:43], a[136:139], v[156:159], v[40:43]
    ds_read_b128 a[152:155], v202 offset:28672
    v_cvt_pk_bf16_f32 v73, v10, v11
    v_mfma_f32_16x16x32_bf16 v[40:43], a[132:135], v[152:155], v[40:43]
    v_exp_f32 v12, v12
    v_mfma_f32_16x16x32_bf16 v[40:43], a[128:131], v[148:151], v[40:43]
    ds_read_b128 a[156:159], v203 offset:28672
    v_mfma_f32_16x16x32_bf16 v[44:47], a[128:131], v[164:167], v[108:111]
    v_exp_f32 v13, v13
    v_mfma_f32_16x16x32_bf16 v[44:47], a[132:135], v[168:171], v[44:47]
    ds_read_b64_tr_b16 a[184:185], v207 offset:0
    v_cvt_pk_bf16_f32 v76, v12, v13
    v_mfma_f32_16x16x32_bf16 v[44:47], a[136:139], v[172:175], v[44:47]
    v_exp_f32 v14, v14
    v_mfma_f32_16x16x32_bf16 v[44:47], a[140:143], v[176:179], v[44:47]
    ds_read_b64_tr_b16 a[186:187], v207 offset:4096
    s_add_u32 m0, s71, 114688
    v_mfma_f32_16x16x32_bf16 v[48:51], a[140:143], v[192:195], v[112:115]
    v_exp_f32 v15, v15
    v_mfma_f32_16x16x32_bf16 v[48:51], a[136:139], v[188:191], v[48:51]
    ds_read_b64_tr_b16 a[188:189], v207 offset:8192
    v_cvt_pk_bf16_f32 v77, v14, v15
    v_mfma_f32_16x16x32_bf16 v[48:51], a[132:135], v[184:187], v[48:51]
    v_exp_f32 v16, v16
    v_mfma_f32_16x16x32_bf16 v[48:51], a[128:131], v[180:183], v[48:51]
    ds_read_b64_tr_b16 a[190:191], v207 offset:12288
    s_waitcnt lgkmcnt(4)
    v_mfma_f32_16x16x32_bf16 v[64:67], a[144:147], v[180:183], v[112:115]
    v_exp_f32 v17, v17
    v_mfma_f32_16x16x32_bf16 v[64:67], a[148:151], v[184:187], v[64:67]
    buffer_load_dwordx4 v216, s[8:11], s70 offen offset:0 lds
    v_cvt_pk_bf16_f32 v80, v16, v17
    v_mfma_f32_16x16x32_bf16 v[64:67], a[152:155], v[188:191], v[64:67]
    v_exp_f32 v18, v18
    v_mfma_f32_16x16x32_bf16 v[64:67], a[156:159], v[192:195], v[64:67]
    buffer_load_dwordx4 v217, s[8:11], s70 offen offset:1024 lds
    v_mfma_f32_16x16x32_bf16 v[60:63], a[156:159], v[176:179], v[108:111]
    v_exp_f32 v19, v19
    v_mfma_f32_16x16x32_bf16 v[60:63], a[152:155], v[172:175], v[60:63]
    v_cvt_pk_bf16_f32 v81, v18, v19
    v_mfma_f32_16x16x32_bf16 v[60:63], a[148:151], v[168:171], v[60:63]
    v_exp_f32 v20, v20
    v_mfma_f32_16x16x32_bf16 v[60:63], a[144:147], v[164:167], v[60:63]
    buffer_load_dwordx4 v216, s[8:11], s70 offen offset:2048 lds
    v_mfma_f32_16x16x32_bf16 v[56:59], a[144:147], v[148:151], v[104:107]
    v_exp_f32 v21, v21
    v_mfma_f32_16x16x32_bf16 v[56:59], a[148:151], v[152:155], v[56:59]
    v_cvt_pk_bf16_f32 v70, v20, v21
    v_mfma_f32_16x16x32_bf16 v[56:59], a[152:155], v[156:159], v[56:59]
    v_exp_f32 v22, v22
    v_mfma_f32_16x16x32_bf16 v[56:59], a[156:159], v[160:163], v[56:59]
    buffer_load_dwordx4 v217, s[8:11], s70 offen offset:3072 lds
    v_mfma_f32_16x16x32_bf16 v[52:55], a[156:159], v[144:147], v[100:103]
    v_exp_f32 v23, v23
    v_mfma_f32_16x16x32_bf16 v[52:55], a[152:155], v[140:143], v[52:55]
    s_add_u32 s70, s70, 16384
    s_add_u32 m0, s71, 0
    v_cvt_pk_bf16_f32 v71, v22, v23
    v_mfma_f32_16x16x32_bf16 v[52:55], a[148:151], v[136:139], v[52:55]
    v_exp_f32 v24, v24
    v_mfma_f32_16x16x32_bf16 v[52:55], a[144:147], v[132:135], v[52:55]
    s_waitcnt lgkmcnt(0)
    s_mov_b32 s79, 53248
    v_smfmac_f32_16x16x64_bf16 a[196:199], v[196:199], v[124:131], v2
    v_exp_f32 v25, v25
    v_smfmac_f32_16x16x64_bf16 a[196:199], v[196:199], v[240:247], v2
    buffer_load_dwordx4 v231, s[44:47], s79 offen offset:0 sc1 lds
    v_cvt_pk_bf16_f32 v74, v24, v25
    v_smfmac_f32_16x16x64_bf16 a[192:195], v[196:199], v[232:239], v2
    v_exp_f32 v26, v26
    v_smfmac_f32_16x16x64_bf16 a[192:195], v[196:199], v[116:123], v2
    buffer_load_dwordx4 v231, s[44:47], s79 offen offset:1024 sc1 lds
    v_mfma_f32_16x16x32_bf16 a[0:3], a[160:163], v[116:119], a[0:3]
    v_exp_f32 v27, v27
    v_mfma_f32_16x16x32_bf16 a[0:3], a[164:167], v[232:235], a[0:3]
    v_cvt_pk_bf16_f32 v75, v26, v27
    v_mfma_f32_16x16x32_bf16 a[4:7], a[164:167], v[236:239], a[4:7]
    v_exp_f32 v28, v28
    v_mfma_f32_16x16x32_bf16 a[4:7], a[160:163], v[120:123], a[4:7]
    buffer_load_dwordx4 v231, s[44:47], s79 offen offset:2048 sc1 lds
    v_mfma_f32_16x16x32_bf16 a[8:11], a[160:163], v[124:127], a[8:11]
    v_exp_f32 v29, v29
    v_mfma_f32_16x16x32_bf16 a[8:11], a[164:167], v[240:243], a[8:11]
    v_cvt_pk_bf16_f32 v78, v28, v29
    v_mfma_f32_16x16x32_bf16 a[12:15], a[164:167], v[244:247], a[12:15]
    v_exp_f32 v30, v30
    v_mfma_f32_16x16x32_bf16 a[12:15], a[160:163], v[128:131], a[12:15]
    buffer_load_dwordx4 v231, s[44:47], s79 offen offset:3072 sc1 lds
    v_mfma_f32_16x16x32_bf16 a[28:31], a[168:171], v[128:131], a[28:31]
    v_exp_f32 v31, v31
    v_mfma_f32_16x16x32_bf16 a[28:31], a[172:175], v[244:247], a[28:31]
    ds_read_b64_tr_b16 a[160:161], v208 offset:0
    v_cvt_pk_bf16_f32 v79, v30, v31
    v_mfma_f32_16x16x32_bf16 a[24:27], a[172:175], v[240:243], a[24:27]
    v_exp_f32 v32, v32
    v_mfma_f32_16x16x32_bf16 a[24:27], a[168:171], v[124:127], a[24:27]
    ds_read_b64_tr_b16 a[162:163], v208 offset:4096
    v_mfma_f32_16x16x32_bf16 a[20:23], a[168:171], v[120:123], a[20:23]
    v_exp_f32 v33, v33
    v_mfma_f32_16x16x32_bf16 a[20:23], a[172:175], v[236:239], a[20:23]
    ds_read_b64_tr_b16 a[164:165], v208 offset:8192
    v_cvt_pk_bf16_f32 v82, v32, v33
    v_mfma_f32_16x16x32_bf16 a[16:19], a[172:175], v[232:235], a[16:19]
    v_exp_f32 v34, v34
    v_mfma_f32_16x16x32_bf16 a[16:19], a[168:171], v[116:119], a[16:19]
    ds_read_b64_tr_b16 a[166:167], v208 offset:12288
    s_add_u32 m0, s71, 131072
    s_mov_b32 s79, 45056
    v_mfma_f32_16x16x32_bf16 a[32:35], a[176:179], v[116:119], a[32:35]
    v_exp_f32 v35, v35
    v_mfma_f32_16x16x32_bf16 a[32:35], a[180:183], v[232:235], a[32:35]
    ds_read_b64_tr_b16 a[168:169], v209 offset:0
    v_cvt_pk_bf16_f32 v83, v34, v35
    v_mfma_f32_16x16x32_bf16 a[36:39], a[180:183], v[236:239], a[36:39]
    buffer_load_dwordx4 v231, s[44:47], s79 offen offset:0 sc1 lds
    v_mfma_f32_16x16x32_bf16 a[36:39], a[176:179], v[120:123], a[36:39]
    ds_read_b64_tr_b16 a[170:171], v209 offset:4096
    v_mfma_f32_16x16x32_bf16 a[40:43], a[176:179], v[124:127], a[40:43]
    v_exp_f32 v36, v36
    v_mfma_f32_16x16x32_bf16 a[40:43], a[180:183], v[240:243], a[40:43]
    ds_read_b64_tr_b16 a[172:173], v209 offset:8192
    v_mfma_f32_16x16x32_bf16 a[44:47], a[180:183], v[244:247], a[44:47]
    v_exp_f32 v37, v37
    v_mfma_f32_16x16x32_bf16 a[44:47], a[176:179], v[128:131], a[44:47]
    ds_read_b64_tr_b16 a[174:175], v209 offset:12288
    v_cvt_pk_bf16_f32 v84, v36, v37
    v_mfma_f32_16x16x32_bf16 a[60:63], a[184:187], v[128:131], a[60:63]
    v_exp_f32 v38, v38
    v_mfma_f32_16x16x32_bf16 a[60:63], a[188:191], v[244:247], a[60:63]
    ds_read_b64_tr_b16 a[176:177], v210 offset:0
    v_mfma_f32_16x16x32_bf16 a[56:59], a[188:191], v[240:243], a[56:59]
    v_exp_f32 v39, v39
    v_mfma_f32_16x16x32_bf16 a[56:59], a[184:187], v[124:127], a[56:59]
    ds_read_b64_tr_b16 a[178:179], v210 offset:4096
    v_cvt_pk_bf16_f32 v85, v38, v39
    v_mfma_f32_16x16x32_bf16 a[52:55], a[184:187], v[120:123], a[52:55]
    v_exp_f32 v40, v40
    v_mfma_f32_16x16x32_bf16 a[52:55], a[188:191], v[236:239], a[52:55]
    ds_read_b64_tr_b16 a[180:181], v210 offset:8192
    s_waitcnt lgkmcnt(3)
    v_mfma_f32_16x16x32_bf16 a[48:51], a[188:191], v[232:235], a[48:51]
    v_exp_f32 v41, v41
    v_mfma_f32_16x16x32_bf16 a[48:51], a[184:187], v[116:119], a[48:51]
    ds_read_b64_tr_b16 a[182:183], v210 offset:12288
    v_cvt_pk_bf16_f32 v88, v40, v41
    v_mfma_f32_16x16x32_bf16 a[64:67], a[160:163], v[116:119], a[64:67]
    v_exp_f32 v42, v42
    v_mfma_f32_16x16x32_bf16 a[64:67], a[164:167], v[232:235], a[64:67]
    ds_read_b64_tr_b16 a[184:185], v211 offset:0
    v_mfma_f32_16x16x32_bf16 a[68:71], a[164:167], v[236:239], a[68:71]
    v_exp_f32 v43, v43
    v_mfma_f32_16x16x32_bf16 a[68:71], a[160:163], v[120:123], a[68:71]
    ds_read_b64_tr_b16 a[186:187], v211 offset:4096
    v_cvt_pk_bf16_f32 v89, v42, v43
    v_mfma_f32_16x16x32_bf16 a[72:75], a[160:163], v[124:127], a[72:75]
    v_exp_f32 v44, v44
    v_mfma_f32_16x16x32_bf16 a[72:75], a[164:167], v[240:243], a[72:75]
    ds_read_b64_tr_b16 a[188:189], v211 offset:8192
    v_mfma_f32_16x16x32_bf16 a[76:79], a[164:167], v[244:247], a[76:79]
    v_exp_f32 v45, v45
    v_mfma_f32_16x16x32_bf16 a[76:79], a[160:163], v[128:131], a[76:79]
    ds_read_b64_tr_b16 a[190:191], v211 offset:12288
    v_cvt_pk_bf16_f32 v92, v44, v45
    v_mfma_f32_16x16x32_bf16 a[92:95], a[168:171], v[128:131], a[92:95]
    v_exp_f32 v46, v46
    v_mfma_f32_16x16x32_bf16 a[92:95], a[172:175], v[244:247], a[92:95]
    buffer_load_dwordx4 v231, s[44:47], s79 offen offset:1024 sc1 lds
    v_mfma_f32_16x16x32_bf16 a[88:91], a[172:175], v[240:243], a[88:91]
    v_exp_f32 v47, v47
    v_mfma_f32_16x16x32_bf16 a[88:91], a[168:171], v[124:127], a[88:91]
    buffer_load_dwordx4 v231, s[44:47], s79 offen offset:2048 sc1 lds
    v_cvt_pk_bf16_f32 v93, v46, v47
    v_mfma_f32_16x16x32_bf16 a[84:87], a[168:171], v[120:123], a[84:87]
    v_exp_f32 v48, v48
    v_mfma_f32_16x16x32_bf16 a[84:87], a[172:175], v[236:239], a[84:87]
    s_waitcnt vmcnt(24) lgkmcnt(0)
    s_barrier
    v_mfma_f32_16x16x32_bf16 a[80:83], a[172:175], v[232:235], a[80:83]
    v_exp_f32 v49, v49
    v_mfma_f32_16x16x32_bf16 a[80:83], a[168:171], v[116:119], a[80:83]
    ds_read_b128 a[128:131], v200 offset:32768
    v_cvt_pk_bf16_f32 v96, v48, v49
    v_mfma_f32_16x16x32_bf16 a[96:99], a[176:179], v[116:119], a[96:99]
    v_exp_f32 v50, v50
    v_mfma_f32_16x16x32_bf16 a[96:99], a[180:183], v[232:235], a[96:99]
    ds_read_b128 a[132:135], v201 offset:32768
    v_mfma_f32_16x16x32_bf16 a[100:103], a[180:183], v[236:239], a[100:103]
    v_exp_f32 v51, v51
    v_mfma_f32_16x16x32_bf16 a[100:103], a[176:179], v[120:123], a[100:103]
    ds_read_b128 a[136:139], v202 offset:32768
    v_cvt_pk_bf16_f32 v97, v50, v51
    v_mfma_f32_16x16x32_bf16 a[104:107], a[176:179], v[124:127], a[104:107]
    v_exp_f32 v52, v52
    v_mfma_f32_16x16x32_bf16 a[104:107], a[180:183], v[240:243], a[104:107]
    ds_read_b128 a[140:143], v203 offset:32768
    v_mfma_f32_16x16x32_bf16 a[108:111], a[180:183], v[244:247], a[108:111]
    v_exp_f32 v53, v53
    v_mfma_f32_16x16x32_bf16 a[108:111], a[176:179], v[128:131], a[108:111]
    ds_read_b128 a[144:147], v200 offset:36864
    v_cvt_pk_bf16_f32 v86, v52, v53
    v_mfma_f32_16x16x32_bf16 a[124:127], a[184:187], v[128:131], a[124:127]
    v_exp_f32 v54, v54
    v_mfma_f32_16x16x32_bf16 a[124:127], a[188:191], v[244:247], a[124:127]
    ds_read_b128 a[148:151], v201 offset:36864
    v_mfma_f32_16x16x32_bf16 a[120:123], a[188:191], v[240:243], a[120:123]
    v_exp_f32 v55, v55
    v_mfma_f32_16x16x32_bf16 a[120:123], a[184:187], v[124:127], a[120:123]
    ds_read_b128 a[152:155], v202 offset:36864
    v_cvt_pk_bf16_f32 v87, v54, v55
    v_mfma_f32_16x16x32_bf16 a[116:119], a[184:187], v[120:123], a[116:119]
    v_exp_f32 v56, v56
    v_mfma_f32_16x16x32_bf16 a[116:119], a[188:191], v[236:239], a[116:119]
    ds_read_b128 a[156:159], v203 offset:36864
    v_mfma_f32_16x16x32_bf16 a[112:115], a[188:191], v[232:235], a[112:115]
    v_exp_f32 v57, v57
    v_mfma_f32_16x16x32_bf16 a[112:115], a[184:187], v[116:119], a[112:115]
    s_waitcnt lgkmcnt(4)
    buffer_load_dwordx4 v231, s[44:47], s79 offen offset:3072 sc1 lds
    v_cvt_pk_bf16_f32 v90, v56, v57
    v_mfma_f32_16x16x32_bf16 v[4:7], a[128:131], v[132:135], v[100:103]
    v_exp_f32 v58, v58
    v_mfma_f32_16x16x32_bf16 v[4:7], a[132:135], v[136:139], v[4:7]
    ds_read_b64_tr_b16 a[160:161], v204 offset:16384
    v_mfma_f32_16x16x32_bf16 v[4:7], a[136:139], v[140:143], v[4:7]
    v_exp_f32 v59, v59
    v_mfma_f32_16x16x32_bf16 v[4:7], a[140:143], v[144:147], v[4:7]
    ds_read_b64_tr_b16 a[162:163], v204 offset:20480
    v_cvt_pk_bf16_f32 v91, v58, v59
    v_mfma_f32_16x16x32_bf16 v[8:11], a[140:143], v[160:163], v[104:107]
    v_exp_f32 v60, v60
    v_mfma_f32_16x16x32_bf16 v[8:11], a[136:139], v[156:159], v[8:11]
    ds_read_b64_tr_b16 a[164:165], v204 offset:24576
    v_mfma_f32_16x16x32_bf16 v[8:11], a[132:135], v[152:155], v[8:11]
    v_exp_f32 v61, v61
    v_mfma_f32_16x16x32_bf16 v[8:11], a[128:131], v[148:151], v[8:11]
    ds_read_b64_tr_b16 a[166:167], v204 offset:28672
    v_cvt_pk_bf16_f32 v94, v60, v61
    v_mfma_f32_16x16x32_bf16 v[12:15], a[128:131], v[164:167], v[108:111]
    v_exp_f32 v62, v62
    v_mfma_f32_16x16x32_bf16 v[12:15], a[132:135], v[168:171], v[12:15]
    ds_read_b64_tr_b16 a[168:169], v205 offset:16384
    v_mfma_f32_16x16x32_bf16 v[12:15], a[136:139], v[172:175], v[12:15]
    v_exp_f32 v63, v63
    v_mfma_f32_16x16x32_bf16 v[12:15], a[140:143], v[176:179], v[12:15]
    ds_read_b64_tr_b16 a[170:171], v205 offset:20480
    v_cvt_pk_bf16_f32 v95, v62, v63
    v_mfma_f32_16x16x32_bf16 v[16:19], a[140:143], v[192:195], v[112:115]
    v_exp_f32 v64, v64
    v_mfma_f32_16x16x32_bf16 v[16:19], a[136:139], v[188:191], v[16:19]
    ds_read_b64_tr_b16 a[172:173], v205 offset:24576
    s_waitcnt lgkmcnt(7)
    s_mov_b32 s79, 4096
    v_mfma_f32_16x16x32_bf16 v[16:19], a[132:135], v[184:187], v[16:19]
    v_exp_f32 v65, v65
    v_mfma_f32_16x16x32_bf16 v[16:19], a[128:131], v[180:183], v[16:19]
    ds_read_b64_tr_b16 a[174:175], v205 offset:28672
    v_cvt_pk_bf16_f32 v98, v64, v65
    v_mfma_f32_16x16x32_bf16 v[32:35], a[144:147], v[180:183], v[112:115]
    v_exp_f32 v66, v66
    v_mfma_f32_16x16x32_bf16 v[32:35], a[148:151], v[184:187], v[32:35]
    ds_read_b128 a[128:131], v200 offset:40960
    buffer_load_dwordx4 a[224:227], v231, s[44:47], s79 offen offset:0 sc1
    v_mfma_f32_16x16x32_bf16 v[32:35], a[152:155], v[188:191], v[32:35]
    v_exp_f32 v67, v67
    v_mfma_f32_16x16x32_bf16 v[32:35], a[156:159], v[192:195], v[32:35]
    ds_read_b128 a[132:135], v201 offset:40960
    v_cvt_pk_bf16_f32 v99, v66, v67
    v_mfma_f32_16x16x32_bf16 v[28:31], a[156:159], v[176:179], v[108:111]
    v_mfma_f32_16x16x32_bf16 v[28:31], a[152:155], v[172:175], v[28:31]
    ds_read_b128 a[136:139], v202 offset:40960
    buffer_load_dwordx4 a[228:231], v231, s[44:47], s79 offen offset:1024 sc1
    v_mfma_f32_16x16x32_bf16 v[28:31], a[148:151], v[168:171], v[28:31]
    v_exp_f32 v4, v4
    v_mfma_f32_16x16x32_bf16 v[28:31], a[144:147], v[164:167], v[28:31]
    ds_read_b128 a[140:143], v203 offset:40960
    v_mfma_f32_16x16x32_bf16 v[24:27], a[144:147], v[148:151], v[104:107]
    v_exp_f32 v5, v5
    v_mfma_f32_16x16x32_bf16 v[24:27], a[148:151], v[152:155], v[24:27]
    ds_read_b64_tr_b16 a[176:177], v206 offset:16384
    v_cvt_pk_bf16_f32 v116, v4, v5
    v_mfma_f32_16x16x32_bf16 v[24:27], a[152:155], v[156:159], v[24:27]
    v_exp_f32 v6, v6
    v_mfma_f32_16x16x32_bf16 v[24:27], a[156:159], v[160:163], v[24:27]
    ds_read_b64_tr_b16 a[178:179], v206 offset:20480
    buffer_load_dwordx4 a[232:235], v231, s[44:47], s79 offen offset:2048 sc1
    v_mfma_f32_16x16x32_bf16 v[20:23], a[156:159], v[144:147], v[100:103]
    v_exp_f32 v7, v7
    v_mfma_f32_16x16x32_bf16 v[20:23], a[152:155], v[140:143], v[20:23]
    ds_read_b64_tr_b16 a[180:181], v206 offset:24576
    v_cvt_pk_bf16_f32 v117, v6, v7
    v_mfma_f32_16x16x32_bf16 v[20:23], a[148:151], v[136:139], v[20:23]
    v_exp_f32 v8, v8
    v_mfma_f32_16x16x32_bf16 v[20:23], a[144:147], v[132:135], v[20:23]
    ds_read_b64_tr_b16 a[182:183], v206 offset:28672
    s_waitcnt lgkmcnt(4)
    v_mfma_f32_16x16x32_bf16 v[36:39], a[128:131], v[132:135], v[100:103]
    v_exp_f32 v9, v9
    v_mfma_f32_16x16x32_bf16 v[36:39], a[132:135], v[136:139], v[36:39]
    ds_read_b128 a[144:147], v200 offset:45056
    v_cvt_pk_bf16_f32 v120, v8, v9
    v_mfma_f32_16x16x32_bf16 v[36:39], a[136:139], v[140:143], v[36:39]
    v_exp_f32 v10, v10
    v_mfma_f32_16x16x32_bf16 v[36:39], a[140:143], v[144:147], v[36:39]
    ds_read_b128 a[148:151], v201 offset:45056
    buffer_load_dwordx4 a[236:239], v231, s[44:47], s79 offen offset:3072 sc1
    v_mfma_f32_16x16x32_bf16 v[40:43], a[140:143], v[160:163], v[104:107]
    v_exp_f32 v11, v11
    v_mfma_f32_16x16x32_bf16 v[40:43], a[136:139], v[156:159], v[40:43]
    ds_read_b128 a[152:155], v202 offset:45056
    v_cvt_pk_bf16_f32 v121, v10, v11
    v_mfma_f32_16x16x32_bf16 v[40:43], a[132:135], v[152:155], v[40:43]
    v_exp_f32 v12, v12
    v_mfma_f32_16x16x32_bf16 v[40:43], a[128:131], v[148:151], v[40:43]
    ds_read_b128 a[156:159], v203 offset:45056
    s_add_u32 m0, s71, 65536
    v_mfma_f32_16x16x32_bf16 v[44:47], a[128:131], v[164:167], v[108:111]
    v_exp_f32 v13, v13
    v_mfma_f32_16x16x32_bf16 v[44:47], a[132:135], v[168:171], v[44:47]
    ds_read_b64_tr_b16 a[184:185], v207 offset:16384
    v_cvt_pk_bf16_f32 v124, v12, v13
    v_mfma_f32_16x16x32_bf16 v[44:47], a[136:139], v[172:175], v[44:47]
    v_exp_f32 v14, v14
    v_mfma_f32_16x16x32_bf16 v[44:47], a[140:143], v[176:179], v[44:47]
    ds_read_b64_tr_b16 a[186:187], v207 offset:20480
    s_mov_b32 s79, 57344
    v_mfma_f32_16x16x32_bf16 v[48:51], a[140:143], v[192:195], v[112:115]
    v_exp_f32 v15, v15
    v_mfma_f32_16x16x32_bf16 v[48:51], a[136:139], v[188:191], v[48:51]
    ds_read_b64_tr_b16 a[188:189], v207 offset:24576
    v_cvt_pk_bf16_f32 v125, v14, v15
    v_mfma_f32_16x16x32_bf16 v[48:51], a[132:135], v[184:187], v[48:51]
    v_exp_f32 v16, v16
    v_mfma_f32_16x16x32_bf16 v[48:51], a[128:131], v[180:183], v[48:51]
    ds_read_b64_tr_b16 a[190:191], v207 offset:28672
    s_waitcnt lgkmcnt(4)
    v_mfma_f32_16x16x32_bf16 v[64:67], a[144:147], v[180:183], v[112:115]
    v_exp_f32 v17, v17
    v_mfma_f32_16x16x32_bf16 v[64:67], a[148:151], v[184:187], v[64:67]
    buffer_load_dwordx4 v231, s[44:47], s79 offen offset:0 sc1 lds
    v_cvt_pk_bf16_f32 v128, v16, v17
    v_mfma_f32_16x16x32_bf16 v[64:67], a[152:155], v[188:191], v[64:67]
    v_exp_f32 v18, v18
    v_mfma_f32_16x16x32_bf16 v[64:67], a[156:159], v[192:195], v[64:67]
    buffer_load_dwordx4 v231, s[44:47], s79 offen offset:1024 sc1 lds
    v_mfma_f32_16x16x32_bf16 v[60:63], a[156:159], v[176:179], v[108:111]
    v_exp_f32 v19, v19
    v_mfma_f32_16x16x32_bf16 v[60:63], a[152:155], v[172:175], v[60:63]
    v_cvt_pk_bf16_f32 v129, v18, v19
    v_mfma_f32_16x16x32_bf16 v[60:63], a[148:151], v[168:171], v[60:63]
    v_exp_f32 v20, v20
    v_mfma_f32_16x16x32_bf16 v[60:63], a[144:147], v[164:167], v[60:63]
    buffer_load_dwordx4 v231, s[44:47], s79 offen offset:2048 sc1 lds
    v_mfma_f32_16x16x32_bf16 v[56:59], a[144:147], v[148:151], v[104:107]
    v_exp_f32 v21, v21
    v_mfma_f32_16x16x32_bf16 v[56:59], a[148:151], v[152:155], v[56:59]
    v_cvt_pk_bf16_f32 v118, v20, v21
    v_mfma_f32_16x16x32_bf16 v[56:59], a[152:155], v[156:159], v[56:59]
    v_exp_f32 v22, v22
    v_mfma_f32_16x16x32_bf16 v[56:59], a[156:159], v[160:163], v[56:59]
    buffer_load_dwordx4 v231, s[44:47], s79 offen offset:3072 sc1 lds
    v_mfma_f32_16x16x32_bf16 v[52:55], a[156:159], v[144:147], v[100:103]
    v_exp_f32 v23, v23
    v_mfma_f32_16x16x32_bf16 v[52:55], a[152:155], v[140:143], v[52:55]
    s_add_u32 m0, s71, 16384
    v_cvt_pk_bf16_f32 v119, v22, v23
    v_mfma_f32_16x16x32_bf16 v[52:55], a[148:151], v[136:139], v[52:55]
    v_exp_f32 v24, v24
    v_mfma_f32_16x16x32_bf16 v[52:55], a[144:147], v[132:135], v[52:55]
    s_waitcnt lgkmcnt(0)
    s_mov_b32 s79, 61440
    v_smfmac_f32_16x16x64_bf16 a[196:199], v[196:199], v[76:83], v2
    v_exp_f32 v25, v25
    v_smfmac_f32_16x16x64_bf16 a[196:199], v[196:199], v[92:99], v2
    buffer_load_dwordx4 v231, s[44:47], s79 offen offset:0 sc1 lds
    v_cvt_pk_bf16_f32 v122, v24, v25
    v_smfmac_f32_16x16x64_bf16 a[192:195], v[196:199], v[84:91], v2
    v_exp_f32 v26, v26
    v_smfmac_f32_16x16x64_bf16 a[192:195], v[196:199], v[68:75], v2
    buffer_load_dwordx4 v231, s[44:47], s79 offen offset:1024 sc1 lds
    v_mfma_f32_16x16x32_bf16 a[0:3], a[160:163], v[68:71], a[0:3]
    v_exp_f32 v27, v27
    v_mfma_f32_16x16x32_bf16 a[0:3], a[164:167], v[84:87], a[0:3]
    v_cvt_pk_bf16_f32 v123, v26, v27
    v_mfma_f32_16x16x32_bf16 a[4:7], a[164:167], v[88:91], a[4:7]
    v_exp_f32 v28, v28
    v_mfma_f32_16x16x32_bf16 a[4:7], a[160:163], v[72:75], a[4:7]
    buffer_load_dwordx4 v231, s[44:47], s79 offen offset:2048 sc1 lds
    v_mfma_f32_16x16x32_bf16 a[8:11], a[160:163], v[76:79], a[8:11]
    v_exp_f32 v29, v29
    v_mfma_f32_16x16x32_bf16 a[8:11], a[164:167], v[92:95], a[8:11]
    v_cvt_pk_bf16_f32 v126, v28, v29
    v_mfma_f32_16x16x32_bf16 a[12:15], a[164:167], v[96:99], a[12:15]
    v_exp_f32 v30, v30
    v_mfma_f32_16x16x32_bf16 a[12:15], a[160:163], v[80:83], a[12:15]
    buffer_load_dwordx4 v231, s[44:47], s79 offen offset:3072 sc1 lds
    v_mfma_f32_16x16x32_bf16 a[28:31], a[168:171], v[80:83], a[28:31]
    v_exp_f32 v31, v31
    v_mfma_f32_16x16x32_bf16 a[28:31], a[172:175], v[96:99], a[28:31]
    ds_read_b64_tr_b16 a[160:161], v208 offset:16384
    v_cvt_pk_bf16_f32 v127, v30, v31
    v_mfma_f32_16x16x32_bf16 a[24:27], a[172:175], v[92:95], a[24:27]
    v_exp_f32 v32, v32
    v_mfma_f32_16x16x32_bf16 a[24:27], a[168:171], v[76:79], a[24:27]
    ds_read_b64_tr_b16 a[162:163], v208 offset:20480
    v_mfma_f32_16x16x32_bf16 a[20:23], a[168:171], v[72:75], a[20:23]
    v_exp_f32 v33, v33
    v_mfma_f32_16x16x32_bf16 a[20:23], a[172:175], v[88:91], a[20:23]
    ds_read_b64_tr_b16 a[164:165], v208 offset:24576
    v_cvt_pk_bf16_f32 v130, v32, v33
    v_mfma_f32_16x16x32_bf16 a[16:19], a[172:175], v[84:87], a[16:19]
    v_exp_f32 v34, v34
    v_mfma_f32_16x16x32_bf16 a[16:19], a[168:171], v[68:71], a[16:19]
    ds_read_b64_tr_b16 a[166:167], v208 offset:28672
    s_add_u32 m0, s71, 147456
    s_mov_b32 s79, 49152
    v_mfma_f32_16x16x32_bf16 a[32:35], a[176:179], v[68:71], a[32:35]
    v_exp_f32 v35, v35
    v_mfma_f32_16x16x32_bf16 a[32:35], a[180:183], v[84:87], a[32:35]
    ds_read_b64_tr_b16 a[168:169], v209 offset:16384
    v_cvt_pk_bf16_f32 v131, v34, v35
    v_mfma_f32_16x16x32_bf16 a[36:39], a[180:183], v[88:91], a[36:39]
    buffer_load_dwordx4 v231, s[44:47], s79 offen offset:0 sc1 lds
    v_mfma_f32_16x16x32_bf16 a[36:39], a[176:179], v[72:75], a[36:39]
    ds_read_b64_tr_b16 a[170:171], v209 offset:20480
    v_mfma_f32_16x16x32_bf16 a[40:43], a[176:179], v[76:79], a[40:43]
    v_exp_f32 v36, v36
    v_mfma_f32_16x16x32_bf16 a[40:43], a[180:183], v[92:95], a[40:43]
    ds_read_b64_tr_b16 a[172:173], v209 offset:24576
    v_mfma_f32_16x16x32_bf16 a[44:47], a[180:183], v[96:99], a[44:47]
    v_exp_f32 v37, v37
    v_mfma_f32_16x16x32_bf16 a[44:47], a[176:179], v[80:83], a[44:47]
    ds_read_b64_tr_b16 a[174:175], v209 offset:28672
    v_cvt_pk_bf16_f32 v232, v36, v37
    v_mfma_f32_16x16x32_bf16 a[60:63], a[184:187], v[80:83], a[60:63]
    v_exp_f32 v38, v38
    v_mfma_f32_16x16x32_bf16 a[60:63], a[188:191], v[96:99], a[60:63]
    ds_read_b64_tr_b16 a[176:177], v210 offset:16384
    v_mfma_f32_16x16x32_bf16 a[56:59], a[188:191], v[92:95], a[56:59]
    v_exp_f32 v39, v39
    v_mfma_f32_16x16x32_bf16 a[56:59], a[184:187], v[76:79], a[56:59]
    ds_read_b64_tr_b16 a[178:179], v210 offset:20480
    v_cvt_pk_bf16_f32 v233, v38, v39
    v_mfma_f32_16x16x32_bf16 a[52:55], a[184:187], v[72:75], a[52:55]
    v_exp_f32 v40, v40
    v_mfma_f32_16x16x32_bf16 a[52:55], a[188:191], v[88:91], a[52:55]
    ds_read_b64_tr_b16 a[180:181], v210 offset:24576
    s_waitcnt lgkmcnt(3)
    v_mfma_f32_16x16x32_bf16 a[48:51], a[188:191], v[84:87], a[48:51]
    v_exp_f32 v41, v41
    v_mfma_f32_16x16x32_bf16 a[48:51], a[184:187], v[68:71], a[48:51]
    ds_read_b64_tr_b16 a[182:183], v210 offset:28672
    v_cvt_pk_bf16_f32 v236, v40, v41
    v_mfma_f32_16x16x32_bf16 a[64:67], a[160:163], v[68:71], a[64:67]
    v_exp_f32 v42, v42
    v_mfma_f32_16x16x32_bf16 a[64:67], a[164:167], v[84:87], a[64:67]
    ds_read_b64_tr_b16 a[184:185], v211 offset:16384
    v_mfma_f32_16x16x32_bf16 a[68:71], a[164:167], v[88:91], a[68:71]
    v_exp_f32 v43, v43
    v_mfma_f32_16x16x32_bf16 a[68:71], a[160:163], v[72:75], a[68:71]
    ds_read_b64_tr_b16 a[186:187], v211 offset:20480
    v_cvt_pk_bf16_f32 v237, v42, v43
    v_mfma_f32_16x16x32_bf16 a[72:75], a[160:163], v[76:79], a[72:75]
    v_exp_f32 v44, v44
    v_mfma_f32_16x16x32_bf16 a[72:75], a[164:167], v[92:95], a[72:75]
    ds_read_b64_tr_b16 a[188:189], v211 offset:24576
    v_mfma_f32_16x16x32_bf16 a[76:79], a[164:167], v[96:99], a[76:79]
    v_exp_f32 v45, v45
    v_mfma_f32_16x16x32_bf16 a[76:79], a[160:163], v[80:83], a[76:79]
    ds_read_b64_tr_b16 a[190:191], v211 offset:28672
    v_cvt_pk_bf16_f32 v240, v44, v45
    v_mfma_f32_16x16x32_bf16 a[92:95], a[168:171], v[80:83], a[92:95]
    v_exp_f32 v46, v46
    v_mfma_f32_16x16x32_bf16 a[92:95], a[172:175], v[96:99], a[92:95]
    buffer_load_dwordx4 v231, s[44:47], s79 offen offset:1024 sc1 lds
    v_mfma_f32_16x16x32_bf16 a[88:91], a[172:175], v[92:95], a[88:91]
    v_exp_f32 v47, v47
    v_mfma_f32_16x16x32_bf16 a[88:91], a[168:171], v[76:79], a[88:91]
    buffer_load_dwordx4 v231, s[44:47], s79 offen offset:2048 sc1 lds
    v_cvt_pk_bf16_f32 v241, v46, v47
    v_mfma_f32_16x16x32_bf16 a[84:87], a[168:171], v[72:75], a[84:87]
    v_exp_f32 v48, v48
    v_mfma_f32_16x16x32_bf16 a[84:87], a[172:175], v[88:91], a[84:87]
    s_waitcnt vmcnt(32) lgkmcnt(0)
    s_barrier
    v_mfma_f32_16x16x32_bf16 a[80:83], a[172:175], v[84:87], a[80:83]
    v_exp_f32 v49, v49
    v_mfma_f32_16x16x32_bf16 a[80:83], a[168:171], v[68:71], a[80:83]
    ds_read_b128 a[128:131], v200 offset:49152
    v_cvt_pk_bf16_f32 v244, v48, v49
    v_mfma_f32_16x16x32_bf16 a[96:99], a[176:179], v[68:71], a[96:99]
    v_exp_f32 v50, v50
    v_mfma_f32_16x16x32_bf16 a[96:99], a[180:183], v[84:87], a[96:99]
    ds_read_b128 a[132:135], v201 offset:49152
    v_mfma_f32_16x16x32_bf16 a[100:103], a[180:183], v[88:91], a[100:103]
    v_exp_f32 v51, v51
    v_mfma_f32_16x16x32_bf16 a[100:103], a[176:179], v[72:75], a[100:103]
    ds_read_b128 a[136:139], v202 offset:49152
    v_cvt_pk_bf16_f32 v245, v50, v51
    v_mfma_f32_16x16x32_bf16 a[104:107], a[176:179], v[76:79], a[104:107]
    v_exp_f32 v52, v52
    v_mfma_f32_16x16x32_bf16 a[104:107], a[180:183], v[92:95], a[104:107]
    ds_read_b128 a[140:143], v203 offset:49152
    v_mfma_f32_16x16x32_bf16 a[108:111], a[180:183], v[96:99], a[108:111]
    v_exp_f32 v53, v53
    v_mfma_f32_16x16x32_bf16 a[108:111], a[176:179], v[80:83], a[108:111]
    ds_read_b128 a[144:147], v200 offset:53248
    v_cvt_pk_bf16_f32 v234, v52, v53
    v_mfma_f32_16x16x32_bf16 a[124:127], a[184:187], v[80:83], a[124:127]
    v_exp_f32 v54, v54
    v_mfma_f32_16x16x32_bf16 a[124:127], a[188:191], v[96:99], a[124:127]
    ds_read_b128 a[148:151], v201 offset:53248
    v_mfma_f32_16x16x32_bf16 a[120:123], a[188:191], v[92:95], a[120:123]
    v_exp_f32 v55, v55
    v_mfma_f32_16x16x32_bf16 a[120:123], a[184:187], v[76:79], a[120:123]
    ds_read_b128 a[152:155], v202 offset:53248
    v_cvt_pk_bf16_f32 v235, v54, v55
    v_mfma_f32_16x16x32_bf16 a[116:119], a[184:187], v[72:75], a[116:119]
    v_exp_f32 v56, v56
    v_mfma_f32_16x16x32_bf16 a[116:119], a[188:191], v[88:91], a[116:119]
    ds_read_b128 a[156:159], v203 offset:53248
    v_mfma_f32_16x16x32_bf16 a[112:115], a[188:191], v[84:87], a[112:115]
    v_exp_f32 v57, v57
    v_mfma_f32_16x16x32_bf16 a[112:115], a[184:187], v[68:71], a[112:115]
    s_waitcnt lgkmcnt(4)
    buffer_load_dwordx4 v231, s[44:47], s79 offen offset:3072 sc1 lds
    v_cvt_pk_bf16_f32 v238, v56, v57
    v_mfma_f32_16x16x32_bf16 v[4:7], a[128:131], v[132:135], v[100:103]
    v_exp_f32 v58, v58
    v_mfma_f32_16x16x32_bf16 v[4:7], a[132:135], v[136:139], v[4:7]
    ds_read_b64_tr_b16 a[160:161], v204 offset:32768
    v_mfma_f32_16x16x32_bf16 v[4:7], a[136:139], v[140:143], v[4:7]
    v_exp_f32 v59, v59
    v_mfma_f32_16x16x32_bf16 v[4:7], a[140:143], v[144:147], v[4:7]
    ds_read_b64_tr_b16 a[162:163], v204 offset:36864
    v_cvt_pk_bf16_f32 v239, v58, v59
    v_mfma_f32_16x16x32_bf16 v[8:11], a[140:143], v[160:163], v[104:107]
    v_exp_f32 v60, v60
    v_mfma_f32_16x16x32_bf16 v[8:11], a[136:139], v[156:159], v[8:11]
    ds_read_b64_tr_b16 a[164:165], v204 offset:40960
    v_mfma_f32_16x16x32_bf16 v[8:11], a[132:135], v[152:155], v[8:11]
    v_exp_f32 v61, v61
    v_mfma_f32_16x16x32_bf16 v[8:11], a[128:131], v[148:151], v[8:11]
    ds_read_b64_tr_b16 a[166:167], v204 offset:45056
    v_cvt_pk_bf16_f32 v242, v60, v61
    v_mfma_f32_16x16x32_bf16 v[12:15], a[128:131], v[164:167], v[108:111]
    v_exp_f32 v62, v62
    v_mfma_f32_16x16x32_bf16 v[12:15], a[132:135], v[168:171], v[12:15]
    ds_read_b64_tr_b16 a[168:169], v205 offset:32768
    v_mfma_f32_16x16x32_bf16 v[12:15], a[136:139], v[172:175], v[12:15]
    v_exp_f32 v63, v63
    v_mfma_f32_16x16x32_bf16 v[12:15], a[140:143], v[176:179], v[12:15]
    ds_read_b64_tr_b16 a[170:171], v205 offset:36864
    v_cvt_pk_bf16_f32 v243, v62, v63
    v_mfma_f32_16x16x32_bf16 v[16:19], a[140:143], v[192:195], v[112:115]
    v_exp_f32 v64, v64
    v_mfma_f32_16x16x32_bf16 v[16:19], a[136:139], v[188:191], v[16:19]
    ds_read_b64_tr_b16 a[172:173], v205 offset:40960
    s_waitcnt lgkmcnt(7)
    s_mov_b32 s79, 8192
    v_mfma_f32_16x16x32_bf16 v[16:19], a[132:135], v[184:187], v[16:19]
    v_exp_f32 v65, v65
    v_mfma_f32_16x16x32_bf16 v[16:19], a[128:131], v[180:183], v[16:19]
    ds_read_b64_tr_b16 a[174:175], v205 offset:45056
    v_cvt_pk_bf16_f32 v246, v64, v65
    v_mfma_f32_16x16x32_bf16 v[32:35], a[144:147], v[180:183], v[112:115]
    v_exp_f32 v66, v66
    v_mfma_f32_16x16x32_bf16 v[32:35], a[148:151], v[184:187], v[32:35]
    ds_read_b128 a[128:131], v200 offset:57344
    buffer_load_dwordx4 a[240:243], v231, s[44:47], s79 offen offset:0 sc1
    v_mfma_f32_16x16x32_bf16 v[32:35], a[152:155], v[188:191], v[32:35]
    v_exp_f32 v67, v67
    v_mfma_f32_16x16x32_bf16 v[32:35], a[156:159], v[192:195], v[32:35]
    ds_read_b128 a[132:135], v201 offset:57344
    v_cvt_pk_bf16_f32 v247, v66, v67
    v_mfma_f32_16x16x32_bf16 v[28:31], a[156:159], v[176:179], v[108:111]
    v_mfma_f32_16x16x32_bf16 v[28:31], a[152:155], v[172:175], v[28:31]
    ds_read_b128 a[136:139], v202 offset:57344
    buffer_load_dwordx4 a[244:247], v231, s[44:47], s79 offen offset:1024 sc1
    v_mfma_f32_16x16x32_bf16 v[28:31], a[148:151], v[168:171], v[28:31]
    v_exp_f32 v4, v4
    v_mfma_f32_16x16x32_bf16 v[28:31], a[144:147], v[164:167], v[28:31]
    ds_read_b128 a[140:143], v203 offset:57344
    v_mfma_f32_16x16x32_bf16 v[24:27], a[144:147], v[148:151], v[104:107]
    v_exp_f32 v5, v5
    v_mfma_f32_16x16x32_bf16 v[24:27], a[148:151], v[152:155], v[24:27]
    ds_read_b64_tr_b16 a[176:177], v206 offset:32768
    v_cvt_pk_bf16_f32 v68, v4, v5
    v_mfma_f32_16x16x32_bf16 v[24:27], a[152:155], v[156:159], v[24:27]
    v_exp_f32 v6, v6
    v_mfma_f32_16x16x32_bf16 v[24:27], a[156:159], v[160:163], v[24:27]
    ds_read_b64_tr_b16 a[178:179], v206 offset:36864
    buffer_load_dwordx4 a[248:251], v231, s[44:47], s79 offen offset:2048 sc1
    v_mfma_f32_16x16x32_bf16 v[20:23], a[156:159], v[144:147], v[100:103]
    v_exp_f32 v7, v7
    v_mfma_f32_16x16x32_bf16 v[20:23], a[152:155], v[140:143], v[20:23]
    ds_read_b64_tr_b16 a[180:181], v206 offset:40960
    v_cvt_pk_bf16_f32 v69, v6, v7
    v_mfma_f32_16x16x32_bf16 v[20:23], a[148:151], v[136:139], v[20:23]
    v_exp_f32 v8, v8
    v_mfma_f32_16x16x32_bf16 v[20:23], a[144:147], v[132:135], v[20:23]
    ds_read_b64_tr_b16 a[182:183], v206 offset:45056
    s_waitcnt lgkmcnt(4)
    v_mfma_f32_16x16x32_bf16 v[36:39], a[128:131], v[132:135], v[100:103]
    v_exp_f32 v9, v9
    v_mfma_f32_16x16x32_bf16 v[36:39], a[132:135], v[136:139], v[36:39]
    ds_read_b128 a[144:147], v200 offset:61440
    v_cvt_pk_bf16_f32 v72, v8, v9
    v_mfma_f32_16x16x32_bf16 v[36:39], a[136:139], v[140:143], v[36:39]
    v_exp_f32 v10, v10
    v_mfma_f32_16x16x32_bf16 v[36:39], a[140:143], v[144:147], v[36:39]
    ds_read_b128 a[148:151], v201 offset:61440
    buffer_load_dwordx4 a[252:255], v231, s[44:47], s79 offen offset:3072 sc1
    v_mfma_f32_16x16x32_bf16 v[40:43], a[140:143], v[160:163], v[104:107]
    v_exp_f32 v11, v11
    v_mfma_f32_16x16x32_bf16 v[40:43], a[136:139], v[156:159], v[40:43]
    ds_read_b128 a[152:155], v202 offset:61440
    v_cvt_pk_bf16_f32 v73, v10, v11
    v_mfma_f32_16x16x32_bf16 v[40:43], a[132:135], v[152:155], v[40:43]
    v_exp_f32 v12, v12
    v_mfma_f32_16x16x32_bf16 v[40:43], a[128:131], v[148:151], v[40:43]
    ds_read_b128 a[156:159], v203 offset:61440
    s_add_u32 m0, s71, 81920
    v_mfma_f32_16x16x32_bf16 v[44:47], a[128:131], v[164:167], v[108:111]
    v_exp_f32 v13, v13
    v_mfma_f32_16x16x32_bf16 v[44:47], a[132:135], v[168:171], v[44:47]
    ds_read_b64_tr_b16 a[184:185], v207 offset:32768
    v_cvt_pk_bf16_f32 v76, v12, v13
    v_mfma_f32_16x16x32_bf16 v[44:47], a[136:139], v[172:175], v[44:47]
    v_exp_f32 v14, v14
    v_mfma_f32_16x16x32_bf16 v[44:47], a[140:143], v[176:179], v[44:47]
    ds_read_b64_tr_b16 a[186:187], v207 offset:36864
    s_mov_b32 s79, 65536
    v_mfma_f32_16x16x32_bf16 v[48:51], a[140:143], v[192:195], v[112:115]
    v_exp_f32 v15, v15
    v_mfma_f32_16x16x32_bf16 v[48:51], a[136:139], v[188:191], v[48:51]
    ds_read_b64_tr_b16 a[188:189], v207 offset:40960
    v_cvt_pk_bf16_f32 v77, v14, v15
    v_mfma_f32_16x16x32_bf16 v[48:51], a[132:135], v[184:187], v[48:51]
    v_exp_f32 v16, v16
    v_mfma_f32_16x16x32_bf16 v[48:51], a[128:131], v[180:183], v[48:51]
    ds_read_b64_tr_b16 a[190:191], v207 offset:45056
    s_waitcnt lgkmcnt(4)
    v_mfma_f32_16x16x32_bf16 v[64:67], a[144:147], v[180:183], v[112:115]
    v_exp_f32 v17, v17
    v_mfma_f32_16x16x32_bf16 v[64:67], a[148:151], v[184:187], v[64:67]
    buffer_load_dwordx4 v231, s[44:47], s79 offen offset:0 sc1 lds
    v_cvt_pk_bf16_f32 v80, v16, v17
    v_mfma_f32_16x16x32_bf16 v[64:67], a[152:155], v[188:191], v[64:67]
    v_exp_f32 v18, v18
    v_mfma_f32_16x16x32_bf16 v[64:67], a[156:159], v[192:195], v[64:67]
    buffer_load_dwordx4 v231, s[44:47], s79 offen offset:1024 sc1 lds
    v_mfma_f32_16x16x32_bf16 v[60:63], a[156:159], v[176:179], v[108:111]
    v_exp_f32 v19, v19
    v_mfma_f32_16x16x32_bf16 v[60:63], a[152:155], v[172:175], v[60:63]
    v_cvt_pk_bf16_f32 v81, v18, v19
    v_mfma_f32_16x16x32_bf16 v[60:63], a[148:151], v[168:171], v[60:63]
    v_exp_f32 v20, v20
    v_mfma_f32_16x16x32_bf16 v[60:63], a[144:147], v[164:167], v[60:63]
    buffer_load_dwordx4 v231, s[44:47], s79 offen offset:2048 sc1 lds
    v_mfma_f32_16x16x32_bf16 v[56:59], a[144:147], v[148:151], v[104:107]
    v_exp_f32 v21, v21
    v_mfma_f32_16x16x32_bf16 v[56:59], a[148:151], v[152:155], v[56:59]
    v_cvt_pk_bf16_f32 v70, v20, v21
    v_mfma_f32_16x16x32_bf16 v[56:59], a[152:155], v[156:159], v[56:59]
    v_exp_f32 v22, v22
    v_mfma_f32_16x16x32_bf16 v[56:59], a[156:159], v[160:163], v[56:59]
    buffer_load_dwordx4 v231, s[44:47], s79 offen offset:3072 sc1 lds
    v_mfma_f32_16x16x32_bf16 v[52:55], a[156:159], v[144:147], v[100:103]
    v_exp_f32 v23, v23
    v_mfma_f32_16x16x32_bf16 v[52:55], a[152:155], v[140:143], v[52:55]
    s_add_u32 m0, s71, 32768
    v_cvt_pk_bf16_f32 v71, v22, v23
    v_mfma_f32_16x16x32_bf16 v[52:55], a[148:151], v[136:139], v[52:55]
    v_exp_f32 v24, v24
    v_mfma_f32_16x16x32_bf16 v[52:55], a[144:147], v[132:135], v[52:55]
    s_waitcnt lgkmcnt(0)
    s_mov_b32 s79, 69632
    v_smfmac_f32_16x16x64_bf16 a[196:199], v[196:199], v[124:131], v2
    v_exp_f32 v25, v25
    v_smfmac_f32_16x16x64_bf16 a[196:199], v[196:199], v[240:247], v2
    buffer_load_dwordx4 v231, s[44:47], s79 offen offset:0 sc1 lds
    v_cvt_pk_bf16_f32 v74, v24, v25
    v_smfmac_f32_16x16x64_bf16 a[192:195], v[196:199], v[232:239], v2
    v_exp_f32 v26, v26
    v_smfmac_f32_16x16x64_bf16 a[192:195], v[196:199], v[116:123], v2
    buffer_load_dwordx4 v231, s[44:47], s79 offen offset:1024 sc1 lds
    v_mfma_f32_16x16x32_bf16 a[0:3], a[160:163], v[116:119], a[0:3]
    v_exp_f32 v27, v27
    v_mfma_f32_16x16x32_bf16 a[0:3], a[164:167], v[232:235], a[0:3]
    v_cvt_pk_bf16_f32 v75, v26, v27
    v_mfma_f32_16x16x32_bf16 a[4:7], a[164:167], v[236:239], a[4:7]
    v_exp_f32 v28, v28
    v_mfma_f32_16x16x32_bf16 a[4:7], a[160:163], v[120:123], a[4:7]
    buffer_load_dwordx4 v231, s[44:47], s79 offen offset:2048 sc1 lds
    v_exp_f32 v36, v36
    v_mfma_f32_16x16x32_bf16 a[8:11], a[160:163], v[124:127], a[8:11]
    v_exp_f32 v29, v29
    v_mfma_f32_16x16x32_bf16 a[8:11], a[164:167], v[240:243], a[8:11]
    v_cvt_pk_bf16_f32 v78, v28, v29
    v_exp_f32 v37, v37
    v_mfma_f32_16x16x32_bf16 a[12:15], a[164:167], v[244:247], a[12:15]
    v_exp_f32 v30, v30
    v_mfma_f32_16x16x32_bf16 a[12:15], a[160:163], v[128:131], a[12:15]
    buffer_load_dwordx4 v231, s[44:47], s79 offen offset:3072 sc1 lds
    v_exp_f32 v38, v38
    v_cvt_pk_bf16_f32 v84, v36, v37
    v_mfma_f32_16x16x32_bf16 a[28:31], a[168:171], v[128:131], a[28:31]
    v_exp_f32 v31, v31
    v_mfma_f32_16x16x32_bf16 a[28:31], a[172:175], v[244:247], a[28:31]
    ds_read_b64_tr_b16 a[160:161], v208 offset:32768
    v_cvt_pk_bf16_f32 v79, v30, v31
    v_exp_f32 v39, v39
    v_mfma_f32_16x16x32_bf16 a[24:27], a[172:175], v[240:243], a[24:27]
    s_mov_b32 s79, 20480
    buffer_load_dwordx4 v[132:135], v231, s[44:47], s79 offen offset:0 sc1
    v_exp_f32 v32, v32
    v_mfma_f32_16x16x32_bf16 a[24:27], a[168:171], v[124:127], a[24:27]
    ds_read_b64_tr_b16 a[162:163], v208 offset:36864
    v_mfma_f32_16x16x32_bf16 a[20:23], a[168:171], v[120:123], a[20:23]
    buffer_load_dwordx4 v[136:139], v231, s[44:47], s79 offen offset:1024 sc1
    v_exp_f32 v33, v33
    v_mfma_f32_16x16x32_bf16 a[20:23], a[172:175], v[236:239], a[20:23]
    ds_read_b64_tr_b16 a[164:165], v208 offset:40960
    v_cvt_pk_bf16_f32 v82, v32, v33
    v_exp_f32 v40, v40
    v_mfma_f32_16x16x32_bf16 a[16:19], a[172:175], v[232:235], a[16:19]
    buffer_load_dwordx4 v[140:143], v231, s[44:47], s79 offen offset:2048 sc1
    v_exp_f32 v34, v34
    v_cvt_pk_bf16_f32 v85, v38, v39
    v_mfma_f32_16x16x32_bf16 a[16:19], a[168:171], v[116:119], a[16:19]
    ds_read_b64_tr_b16 a[166:167], v208 offset:45056
    v_mfma_f32_16x16x32_bf16 a[32:35], a[176:179], v[116:119], a[32:35]
    buffer_load_dwordx4 v[144:147], v231, s[44:47], s79 offen offset:3072 sc1
    v_exp_f32 v35, v35
    v_mfma_f32_16x16x32_bf16 a[32:35], a[180:183], v[232:235], a[32:35]
    ds_read_b64_tr_b16 a[168:169], v209 offset:32768
    v_cvt_pk_bf16_f32 v83, v34, v35
    v_exp_f32 v41, v41
    v_mfma_f32_16x16x32_bf16 a[36:39], a[180:183], v[236:239], a[36:39]
    s_mov_b32 s79, 24576
    buffer_load_dwordx4 v[148:151], v231, s[44:47], s79 offen offset:0 sc1
    v_mfma_f32_16x16x32_bf16 a[36:39], a[176:179], v[120:123], a[36:39]
    ds_read_b64_tr_b16 a[170:171], v209 offset:36864
    v_exp_f32 v42, v42
    v_cvt_pk_bf16_f32 v88, v40, v41
    v_mfma_f32_16x16x32_bf16 a[40:43], a[176:179], v[124:127], a[40:43]
    v_exp_f32 v43, v43
    v_mfma_f32_16x16x32_bf16 a[40:43], a[180:183], v[240:243], a[40:43]
    ds_read_b64_tr_b16 a[172:173], v209 offset:40960
    buffer_load_dwordx4 v[152:155], v231, s[44:47], s79 offen offset:1024 sc1
    v_exp_f32 v44, v44
    v_mfma_f32_16x16x32_bf16 a[44:47], a[180:183], v[244:247], a[44:47]
    v_cvt_pk_bf16_f32 v89, v42, v43
    v_mfma_f32_16x16x32_bf16 a[44:47], a[176:179], v[128:131], a[44:47]
    ds_read_b64_tr_b16 a[174:175], v209 offset:45056
    buffer_load_dwordx4 v[156:159], v231, s[44:47], s79 offen offset:2048 sc1
    v_exp_f32 v45, v45
    v_mfma_f32_16x16x32_bf16 a[60:63], a[184:187], v[128:131], a[60:63]
    v_exp_f32 v46, v46
    v_mfma_f32_16x16x32_bf16 a[60:63], a[188:191], v[244:247], a[60:63]
    ds_read_b64_tr_b16 a[176:177], v210 offset:32768
    buffer_load_dwordx4 v[160:163], v231, s[44:47], s79 offen offset:3072 sc1
    v_cvt_pk_bf16_f32 v92, v44, v45
    v_mfma_f32_16x16x32_bf16 a[56:59], a[188:191], v[240:243], a[56:59]
    v_exp_f32 v47, v47
    v_mfma_f32_16x16x32_bf16 a[56:59], a[184:187], v[124:127], a[56:59]
    ds_read_b64_tr_b16 a[178:179], v210 offset:36864
    s_mov_b32 s79, 28672
    buffer_load_dwordx4 v[164:167], v231, s[44:47], s79 offen offset:0 sc1
    v_mfma_f32_16x16x32_bf16 a[52:55], a[184:187], v[120:123], a[52:55]
    v_exp_f32 v48, v48
    v_cvt_pk_bf16_f32 v93, v46, v47
    v_mfma_f32_16x16x32_bf16 a[52:55], a[188:191], v[236:239], a[52:55]
    ds_read_b64_tr_b16 a[180:181], v210 offset:40960
    s_waitcnt lgkmcnt(3)
    buffer_load_dwordx4 v[168:171], v231, s[44:47], s79 offen offset:1024 sc1
    v_mfma_f32_16x16x32_bf16 a[48:51], a[188:191], v[232:235], a[48:51]
    v_exp_f32 v49, v49
    v_mfma_f32_16x16x32_bf16 a[48:51], a[184:187], v[116:119], a[48:51]
    ds_read_b64_tr_b16 a[182:183], v210 offset:45056
    v_exp_f32 v50, v50
    v_cvt_pk_bf16_f32 v96, v48, v49
    v_mfma_f32_16x16x32_bf16 a[64:67], a[160:163], v[116:119], a[64:67]
    buffer_load_dwordx4 v[172:175], v231, s[44:47], s79 offen offset:2048 sc1
    v_mfma_f32_16x16x32_bf16 a[64:67], a[164:167], v[232:235], a[64:67]
    ds_read_b64_tr_b16 a[184:185], v211 offset:32768
    v_exp_f32 v51, v51
    v_mfma_f32_16x16x32_bf16 a[68:71], a[164:167], v[236:239], a[68:71]
    buffer_load_dwordx4 v[176:179], v231, s[44:47], s79 offen offset:3072 sc1
    v_mfma_f32_16x16x32_bf16 a[68:71], a[160:163], v[120:123], a[68:71]
    ds_read_b64_tr_b16 a[186:187], v211 offset:36864
    v_mfma_f32_16x16x32_bf16 a[72:75], a[160:163], v[124:127], a[72:75]
    s_mov_b32 s79, 32768
    buffer_load_dwordx4 v[180:183], v231, s[44:47], s79 offen offset:0 sc1
    v_exp_f32 v52, v52
    v_mfma_f32_16x16x32_bf16 a[72:75], a[164:167], v[240:243], a[72:75]
    ds_read_b64_tr_b16 a[188:189], v211 offset:40960
    v_cvt_pk_bf16_f32 v97, v50, v51
    v_mfma_f32_16x16x32_bf16 a[76:79], a[164:167], v[244:247], a[76:79]
    buffer_load_dwordx4 v[184:187], v231, s[44:47], s79 offen offset:1024 sc1
    v_exp_f32 v53, v53
    v_mfma_f32_16x16x32_bf16 a[76:79], a[160:163], v[128:131], a[76:79]
    ds_read_b64_tr_b16 a[190:191], v211 offset:45056
    v_mfma_f32_16x16x32_bf16 a[92:95], a[168:171], v[128:131], a[92:95]
    buffer_load_dwordx4 v[188:191], v231, s[44:47], s79 offen offset:2048 sc1
    v_exp_f32 v54, v54
    v_cvt_pk_bf16_f32 v86, v52, v53
    v_mfma_f32_16x16x32_bf16 a[92:95], a[172:175], v[244:247], a[92:95]
    v_exp_f32 v55, v55
    v_mfma_f32_16x16x32_bf16 a[88:91], a[172:175], v[240:243], a[88:91]
    v_exp_f32 v56, v56
    v_cvt_pk_bf16_f32 v87, v54, v55
    v_mfma_f32_16x16x32_bf16 a[88:91], a[168:171], v[124:127], a[88:91]
    s_waitcnt vmcnt(40)
    buffer_load_dwordx4 v[192:195], v231, s[44:47], s79 offen offset:3072 sc1
    v_mfma_f32_16x16x32_bf16 a[84:87], a[168:171], v[120:123], a[84:87]
    v_exp_f32 v57, v57
    v_exp_f32 v58, v58
    v_mfma_f32_16x16x32_bf16 a[84:87], a[172:175], v[236:239], a[84:87]
    s_waitcnt vmcnt(52) lgkmcnt(0)
    s_barrier
    s_mov_b32 s79, 36864
    buffer_load_dwordx4 a[128:131], v231, s[44:47], s79 offen offset:0 sc1
    v_mfma_f32_16x16x32_bf16 a[80:83], a[172:175], v[232:235], a[80:83]
    v_cvt_pk_bf16_f32 v90, v56, v57
    v_mfma_f32_16x16x32_bf16 a[80:83], a[168:171], v[116:119], a[80:83]
    ds_read_b64_tr_b16 a[160:161], v204 offset:49152
    buffer_load_dwordx4 a[132:135], v231, s[44:47], s79 offen offset:1024 sc1
    v_exp_f32 v59, v59
    v_mfma_f32_16x16x32_bf16 a[96:99], a[176:179], v[116:119], a[96:99]
    v_exp_f32 v60, v60
    v_mfma_f32_16x16x32_bf16 a[96:99], a[180:183], v[232:235], a[96:99]
    ds_read_b64_tr_b16 a[162:163], v204 offset:53248
    buffer_load_dwordx4 a[136:139], v231, s[44:47], s79 offen offset:2048 sc1
    v_cvt_pk_bf16_f32 v91, v58, v59
    v_mfma_f32_16x16x32_bf16 a[100:103], a[180:183], v[236:239], a[100:103]
    v_exp_f32 v61, v61
    v_mfma_f32_16x16x32_bf16 a[100:103], a[176:179], v[120:123], a[100:103]
    ds_read_b64_tr_b16 a[164:165], v204 offset:57344
    buffer_load_dwordx4 a[140:143], v231, s[44:47], s79 offen offset:3072 sc1
    v_exp_f32 v62, v62
    v_mfma_f32_16x16x32_bf16 a[104:107], a[176:179], v[124:127], a[104:107]
    v_cvt_pk_bf16_f32 v94, v60, v61
    v_mfma_f32_16x16x32_bf16 a[104:107], a[180:183], v[240:243], a[104:107]
    ds_read_b64_tr_b16 a[166:167], v204 offset:61440
    v_exp_f32 v63, v63
    v_mfma_f32_16x16x32_bf16 a[108:111], a[180:183], v[244:247], a[108:111]
    s_mov_b32 s79, 40960
    buffer_load_dwordx4 a[144:147], v231, s[44:47], s79 offen offset:0 sc1
    v_mfma_f32_16x16x32_bf16 a[108:111], a[176:179], v[128:131], a[108:111]
    ds_read_b64_tr_b16 a[168:169], v205 offset:49152
    v_exp_f32 v64, v64
    v_cvt_pk_bf16_f32 v95, v62, v63
    v_mfma_f32_16x16x32_bf16 a[124:127], a[184:187], v[128:131], a[124:127]
    buffer_load_dwordx4 a[148:151], v231, s[44:47], s79 offen offset:1024 sc1
    v_mfma_f32_16x16x32_bf16 a[124:127], a[188:191], v[244:247], a[124:127]
    ds_read_b64_tr_b16 a[170:171], v205 offset:53248
    v_exp_f32 v65, v65
    v_mfma_f32_16x16x32_bf16 a[120:123], a[188:191], v[240:243], a[120:123]
    buffer_load_dwordx4 a[152:155], v231, s[44:47], s79 offen offset:2048 sc1
    v_mfma_f32_16x16x32_bf16 a[120:123], a[184:187], v[124:127], a[120:123]
    ds_read_b64_tr_b16 a[172:173], v205 offset:57344
    v_exp_f32 v66, v66
    v_cvt_pk_bf16_f32 v98, v64, v65
    v_mfma_f32_16x16x32_bf16 a[116:119], a[184:187], v[120:123], a[116:119]
    buffer_load_dwordx4 a[156:159], v231, s[44:47], s79 offen offset:3072 sc1
    v_mfma_f32_16x16x32_bf16 a[116:119], a[188:191], v[236:239], a[116:119]
    ds_read_b64_tr_b16 a[174:175], v205 offset:61440
    v_exp_f32 v67, v67
    s_nop 0
    v_cvt_pk_bf16_f32 v99, v66, v67
    v_mfma_f32_16x16x32_bf16 a[112:115], a[188:191], v[232:235], a[112:115]
    v_mfma_f32_16x16x32_bf16 a[112:115], a[184:187], v[116:119], a[112:115]
    v_smfmac_f32_16x16x64_bf16 a[196:199], v[196:199], v[76:83], v2
    ds_read_b64_tr_b16 a[176:177], v206 offset:49152
    s_mov_b32 s69, 131072
    s_mov_b32 s75, 262144
    s_mov_b32 s76, 393216
    v_smfmac_f32_16x16x64_bf16 a[196:199], v[196:199], v[92:99], v2
    ds_read_b64_tr_b16 a[178:179], v206 offset:53248
    s_mul_i32 s67, s64, 524288
    v_add_u32 v222, s67, v231
    v_smfmac_f32_16x16x64_bf16 a[192:195], v[196:199], v[84:91], v2
    ds_read_b64_tr_b16 a[180:181], v206 offset:57344
    v_smfmac_f32_16x16x64_bf16 a[192:195], v[196:199], v[68:75], v2
    ds_read_b64_tr_b16 a[182:183], v206 offset:61440
    s_waitcnt lgkmcnt(8)
    v_mfma_f32_16x16x32_bf16 a[0:3], a[160:163], v[68:71], a[0:3]
    ds_read_b64_tr_b16 a[184:185], v207 offset:49152
    v_mfma_f32_16x16x32_bf16 a[0:3], a[164:167], v[84:87], a[0:3]
    ds_read_b64_tr_b16 a[186:187], v207 offset:53248
    v_mfma_f32_16x16x32_bf16 a[4:7], a[164:167], v[88:91], a[4:7]
    ds_read_b64_tr_b16 a[188:189], v207 offset:57344
    v_mfma_f32_16x16x32_bf16 a[4:7], a[160:163], v[72:75], a[4:7]
    ds_read_b64_tr_b16 a[190:191], v207 offset:61440
    v_mfma_f32_16x16x32_bf16 a[8:11], a[160:163], v[76:79], a[8:11]
    s_add_u32 m0, s71, 98304
    s_mov_b32 s79, 73728
    buffer_load_dwordx4 v231, s[44:47], s79 offen offset:0 sc1 lds
    v_accvgpr_read_b32 v230, a198
    v_accvgpr_read_b32 v251, a199
    v_mfma_f32_16x16x32_bf16 a[8:11], a[164:167], v[92:95], a[8:11]
    v_accvgpr_read_b32 v229, a196
    v_accvgpr_read_b32 v250, a197
    v_mfma_f32_16x16x32_bf16 a[12:15], a[164:167], v[96:99], a[12:15]
    v_accvgpr_read_b32 v228, a194
    v_accvgpr_read_b32 v249, a195
    v_mfma_f32_16x16x32_bf16 a[12:15], a[160:163], v[80:83], a[12:15]
    s_waitcnt lgkmcnt(8)
    v_accvgpr_read_b32 v227, a192
    v_accvgpr_read_b32 v248, a193
    v_mfma_f32_16x16x32_bf16 a[28:31], a[168:171], v[80:83], a[28:31]
    v_add_f32 v230, v230, v251
    v_mfma_f32_16x16x32_bf16 a[28:31], a[172:175], v[96:99], a[28:31]
    ds_read_b64_tr_b16 a[160:161], v208 offset:49152
    v_add_f32 v229, v229, v250
    v_mfma_f32_16x16x32_bf16 a[24:27], a[172:175], v[92:95], a[24:27]
    v_add_f32 v228, v228, v249
    v_mfma_f32_16x16x32_bf16 a[24:27], a[168:171], v[76:79], a[24:27]
    ds_read_b64_tr_b16 a[162:163], v208 offset:53248
    buffer_load_dwordx4 v231, s[44:47], s79 offen offset:1024 sc1 lds
    v_add_f32 v227, v227, v248
    v_mfma_f32_16x16x32_bf16 a[20:23], a[168:171], v[72:75], a[20:23]
    v_rcp_f32 v251, v230
    v_mfma_f32_16x16x32_bf16 a[20:23], a[172:175], v[88:91], a[20:23]
    ds_read_b64_tr_b16 a[164:165], v208 offset:57344
    v_rcp_f32 v250, v229
    v_mfma_f32_16x16x32_bf16 a[16:19], a[172:175], v[84:87], a[16:19]
    v_rcp_f32 v249, v228
    v_mfma_f32_16x16x32_bf16 a[16:19], a[168:171], v[68:71], a[16:19]
    s_waitcnt lgkmcnt(3)
    ds_read_b64_tr_b16 a[166:167], v208 offset:61440
    v_rcp_f32 v248, v227
    v_mfma_f32_16x16x32_bf16 a[32:35], a[176:179], v[68:71], a[32:35]
    v_mfma_f32_16x16x32_bf16 a[32:35], a[180:183], v[84:87], a[32:35]
    ds_read_b64_tr_b16 a[168:169], v209 offset:49152
    v_mfma_f32_16x16x32_bf16 a[36:39], a[180:183], v[88:91], a[36:39]
    buffer_load_dwordx4 v231, s[44:47], s79 offen offset:2048 sc1 lds
    v_mfma_f32_16x16x32_bf16 a[36:39], a[176:179], v[72:75], a[36:39]
    ds_read_b64_tr_b16 a[170:171], v209 offset:53248
    v_accvgpr_read_b32 v4, a0
    v_accvgpr_read_b32 v5, a1
    v_accvgpr_read_b32 v6, a2
    v_mfma_f32_16x16x32_bf16 a[40:43], a[176:179], v[76:79], a[40:43]
    v_accvgpr_read_b32 v7, a3
    v_accvgpr_read_b32 v8, a16
    v_accvgpr_read_b32 v9, a17
    v_accvgpr_read_b32 v10, a18
    v_mfma_f32_16x16x32_bf16 a[40:43], a[180:183], v[92:95], a[40:43]
    ds_read_b64_tr_b16 a[172:173], v209 offset:57344
    v_accvgpr_read_b32 v11, a19
    v_mul_f32 v4, v4, v248
    v_mul_f32 v5, v5, v248
    v_mfma_f32_16x16x32_bf16 a[44:47], a[180:183], v[96:99], a[44:47]
    v_mul_f32 v6, v6, v248
    v_mul_f32 v7, v7, v248
    v_mul_f32 v8, v8, v248
    v_mul_f32 v9, v9, v248
    v_mfma_f32_16x16x32_bf16 a[44:47], a[176:179], v[80:83], a[44:47]
    ds_read_b64_tr_b16 a[174:175], v209 offset:61440
    v_mul_f32 v10, v10, v248
    v_mul_f32 v11, v11, v248
    v_cvt_pk_bf16_f32 v12, v4, v5
    v_mfma_f32_16x16x32_bf16 a[60:63], a[184:187], v[80:83], a[60:63]
    v_cvt_pk_bf16_f32 v13, v6, v7
    v_cvt_pk_bf16_f32 v14, v8, v9
    v_cvt_pk_bf16_f32 v15, v10, v11
    buffer_store_dwordx4 v[12:15], v222, s[20:23], 0 offen offset:0 sc1
    v_mfma_f32_16x16x32_bf16 a[60:63], a[188:191], v[96:99], a[60:63]
    ds_read_b64_tr_b16 a[176:177], v210 offset:49152
    buffer_load_dwordx4 v231, s[44:47], s79 offen offset:3072 sc1 lds
    v_accvgpr_read_b32 v16, a4
    v_accvgpr_read_b32 v17, a5
    v_mfma_f32_16x16x32_bf16 a[56:59], a[188:191], v[92:95], a[56:59]
    v_accvgpr_read_b32 v18, a6
    v_accvgpr_read_b32 v19, a7
    v_accvgpr_read_b32 v20, a20
    v_accvgpr_read_b32 v21, a21
    v_mfma_f32_16x16x32_bf16 a[56:59], a[184:187], v[76:79], a[56:59]
    ds_read_b64_tr_b16 a[178:179], v210 offset:53248
    v_accvgpr_read_b32 v22, a22
    v_accvgpr_read_b32 v23, a23
    v_mul_f32 v16, v16, v249
    v_mfma_f32_16x16x32_bf16 a[52:55], a[184:187], v[72:75], a[52:55]
    v_mul_f32 v17, v17, v249
    v_mul_f32 v18, v18, v249
    v_mul_f32 v19, v19, v249
    v_mul_f32 v20, v20, v249
    v_mfma_f32_16x16x32_bf16 a[52:55], a[188:191], v[88:91], a[52:55]
    ds_read_b64_tr_b16 a[180:181], v210 offset:57344
    s_waitcnt lgkmcnt(3)
    v_mul_f32 v21, v21, v249
    v_mul_f32 v22, v22, v249
    v_mfma_f32_16x16x32_bf16 a[48:51], a[188:191], v[84:87], a[48:51]
    v_mul_f32 v23, v23, v249
    v_cvt_pk_bf16_f32 v24, v16, v17
    v_cvt_pk_bf16_f32 v25, v18, v19
    v_cvt_pk_bf16_f32 v26, v20, v21
    v_mfma_f32_16x16x32_bf16 a[48:51], a[184:187], v[68:71], a[48:51]
    ds_read_b64_tr_b16 a[182:183], v210 offset:61440
    v_cvt_pk_bf16_f32 v27, v22, v23
    buffer_store_dwordx4 v[24:27], v222, s[20:23], s69 offen offset:0 sc1
    v_accvgpr_read_b32 v28, a8
    v_mfma_f32_16x16x32_bf16 a[64:67], a[160:163], v[68:71], a[64:67]
    v_accvgpr_read_b32 v29, a9
    v_accvgpr_read_b32 v30, a10
    v_accvgpr_read_b32 v31, a11
    v_accvgpr_read_b32 v32, a24
    v_mfma_f32_16x16x32_bf16 a[64:67], a[164:167], v[84:87], a[64:67]
    ds_read_b64_tr_b16 a[184:185], v211 offset:49152
    s_add_u32 m0, s71, 49152
    s_mov_b32 s79, 77824
    buffer_load_dwordx4 v231, s[44:47], s79 offen offset:0 sc1 lds
    v_mfma_f32_16x16x32_bf16 a[68:71], a[164:167], v[88:91], a[68:71]
    v_accvgpr_read_b32 v33, a25
    v_accvgpr_read_b32 v34, a26
    v_accvgpr_read_b32 v35, a27
    v_mul_f32 v28, v28, v250
    v_mfma_f32_16x16x32_bf16 a[68:71], a[160:163], v[72:75], a[68:71]
    ds_read_b64_tr_b16 a[186:187], v211 offset:53248
    v_mul_f32 v29, v29, v250
    v_mul_f32 v30, v30, v250
    v_mul_f32 v31, v31, v250
    v_mfma_f32_16x16x32_bf16 a[72:75], a[160:163], v[76:79], a[72:75]
    v_mul_f32 v32, v32, v250
    v_mul_f32 v33, v33, v250
    v_mul_f32 v34, v34, v250
    v_mul_f32 v35, v35, v250
    v_mfma_f32_16x16x32_bf16 a[72:75], a[164:167], v[92:95], a[72:75]
    ds_read_b64_tr_b16 a[188:189], v211 offset:57344
    v_cvt_pk_bf16_f32 v36, v28, v29
    v_cvt_pk_bf16_f32 v37, v30, v31
    v_cvt_pk_bf16_f32 v38, v32, v33
    v_mfma_f32_16x16x32_bf16 a[76:79], a[164:167], v[96:99], a[76:79]
    v_cvt_pk_bf16_f32 v39, v34, v35
    buffer_store_dwordx4 v[36:39], v222, s[20:23], s75 offen offset:0 sc1
    v_accvgpr_read_b32 v40, a12
    v_accvgpr_read_b32 v41, a13
    v_mfma_f32_16x16x32_bf16 a[76:79], a[160:163], v[80:83], a[76:79]
    ds_read_b64_tr_b16 a[190:191], v211 offset:61440
    v_accvgpr_read_b32 v42, a14
    v_accvgpr_read_b32 v43, a15
    v_accvgpr_read_b32 v44, a28
    v_mfma_f32_16x16x32_bf16 a[92:95], a[168:171], v[80:83], a[92:95]
    buffer_load_dwordx4 v231, s[44:47], s79 offen offset:1024 sc1 lds
    v_accvgpr_read_b32 v45, a29
    v_accvgpr_read_b32 v46, a30
    v_accvgpr_read_b32 v47, a31
    v_mul_f32 v40, v40, v251
    v_mul_f32 v41, v41, v251
    v_mul_f32 v42, v42, v251
    v_mul_f32 v43, v43, v251
    v_mul_f32 v44, v44, v251
    v_mul_f32 v45, v45, v251
    v_mul_f32 v46, v46, v251
    v_mul_f32 v47, v47, v251
    v_cvt_pk_bf16_f32 v48, v40, v41
    v_cvt_pk_bf16_f32 v49, v42, v43
    v_cvt_pk_bf16_f32 v50, v44, v45
    v_cvt_pk_bf16_f32 v51, v46, v47
    buffer_store_dwordx4 v[48:51], v222, s[20:23], s76 offen offset:0 sc1
    v_mfma_f32_16x16x32_bf16 a[92:95], a[172:175], v[96:99], a[92:95]
    v_accvgpr_read_b32 v4, a32
    v_accvgpr_read_b32 v5, a33
    v_accvgpr_read_b32 v6, a34
    v_accvgpr_read_b32 v7, a35
    v_mfma_f32_16x16x32_bf16 a[88:91], a[172:175], v[92:95], a[88:91]
    v_accvgpr_read_b32 v8, a48
    v_accvgpr_read_b32 v9, a49
    v_accvgpr_read_b32 v10, a50
    v_accvgpr_read_b32 v11, a51
    v_mfma_f32_16x16x32_bf16 a[88:91], a[168:171], v[76:79], a[88:91]
    v_mul_f32 v4, v4, v248
    v_mul_f32 v5, v5, v248
    v_mul_f32 v6, v6, v248
    v_mul_f32 v7, v7, v248
    v_mfma_f32_16x16x32_bf16 a[84:87], a[168:171], v[72:75], a[84:87]
    v_mul_f32 v8, v8, v248
    v_mul_f32 v9, v9, v248
    v_mul_f32 v10, v10, v248
    v_mul_f32 v11, v11, v248
    v_mfma_f32_16x16x32_bf16 a[84:87], a[172:175], v[88:91], a[84:87]
    s_waitcnt lgkmcnt(0)
    v_cvt_pk_bf16_f32 v12, v4, v5
    v_cvt_pk_bf16_f32 v13, v6, v7
    v_cvt_pk_bf16_f32 v14, v8, v9
    v_mfma_f32_16x16x32_bf16 a[80:83], a[172:175], v[84:87], a[80:83]
    v_cvt_pk_bf16_f32 v15, v10, v11
    v_add_u32 v222, 32768, v222
    v_mfma_f32_16x16x32_bf16 a[80:83], a[168:171], v[68:71], a[80:83]
    buffer_load_dwordx4 v231, s[44:47], s79 offen offset:2048 sc1 lds
    s_waitcnt vmcnt(40)
    buffer_store_dwordx4 v[12:15], v222, s[20:23], 0 offen offset:0 sc1
    v_accvgpr_read_b32 v16, a36
    v_accvgpr_read_b32 v17, a37
    v_mfma_f32_16x16x32_bf16 a[96:99], a[176:179], v[68:71], a[96:99]
    v_accvgpr_read_b32 v18, a38
    v_accvgpr_read_b32 v19, a39
    v_accvgpr_read_b32 v20, a52
    v_accvgpr_read_b32 v21, a53
    v_mfma_f32_16x16x32_bf16 a[96:99], a[180:183], v[84:87], a[96:99]
    v_accvgpr_read_b32 v22, a54
    v_accvgpr_read_b32 v23, a55
    v_mul_f32 v16, v16, v249
    v_mul_f32 v17, v17, v249
    v_mfma_f32_16x16x32_bf16 a[100:103], a[180:183], v[88:91], a[100:103]
    v_mul_f32 v18, v18, v249
    v_mul_f32 v19, v19, v249
    v_mul_f32 v20, v20, v249
    v_mul_f32 v21, v21, v249
    v_mfma_f32_16x16x32_bf16 a[100:103], a[176:179], v[72:75], a[100:103]
    v_mul_f32 v22, v22, v249
    v_mul_f32 v23, v23, v249
    v_cvt_pk_bf16_f32 v24, v16, v17
    v_cvt_pk_bf16_f32 v25, v18, v19
    v_mfma_f32_16x16x32_bf16 a[104:107], a[176:179], v[76:79], a[104:107]
    v_cvt_pk_bf16_f32 v26, v20, v21
    v_cvt_pk_bf16_f32 v27, v22, v23
    buffer_store_dwordx4 v[24:27], v222, s[20:23], s69 offen offset:0 sc1
    v_accvgpr_read_b32 v28, a40
    v_mfma_f32_16x16x32_bf16 a[104:107], a[180:183], v[92:95], a[104:107]
    v_accvgpr_read_b32 v29, a41
    v_accvgpr_read_b32 v30, a42
    v_accvgpr_read_b32 v31, a43
    v_accvgpr_read_b32 v32, a56
    v_mfma_f32_16x16x32_bf16 a[108:111], a[180:183], v[96:99], a[108:111]
    buffer_load_dwordx4 v231, s[44:47], s79 offen offset:3072 sc1 lds
    v_accvgpr_read_b32 v33, a57
    v_accvgpr_read_b32 v34, a58
    v_accvgpr_read_b32 v35, a59
    v_mfma_f32_16x16x32_bf16 a[108:111], a[176:179], v[80:83], a[108:111]
    v_mul_f32 v28, v28, v250
    v_mul_f32 v29, v29, v250
    v_mul_f32 v30, v30, v250
    v_mul_f32 v31, v31, v250
    v_mfma_f32_16x16x32_bf16 a[124:127], a[184:187], v[80:83], a[124:127]
    v_mul_f32 v32, v32, v250
    v_mul_f32 v33, v33, v250
    v_mul_f32 v34, v34, v250
    v_mul_f32 v35, v35, v250
    v_mfma_f32_16x16x32_bf16 a[124:127], a[188:191], v[96:99], a[124:127]
    v_cvt_pk_bf16_f32 v36, v28, v29
    v_cvt_pk_bf16_f32 v37, v30, v31
    v_cvt_pk_bf16_f32 v38, v32, v33
    v_cvt_pk_bf16_f32 v39, v34, v35
    v_mfma_f32_16x16x32_bf16 a[120:123], a[188:191], v[92:95], a[120:123]
    buffer_store_dwordx4 v[36:39], v222, s[20:23], s75 offen offset:0 sc1
    v_accvgpr_read_b32 v40, a44
    v_mfma_f32_16x16x32_bf16 a[120:123], a[184:187], v[76:79], a[120:123]
    v_accvgpr_read_b32 v41, a45
    v_accvgpr_read_b32 v42, a46
    v_accvgpr_read_b32 v43, a47
    v_accvgpr_read_b32 v44, a60
    v_mfma_f32_16x16x32_bf16 a[116:119], a[184:187], v[72:75], a[116:119]
    v_accvgpr_read_b32 v45, a61
    v_accvgpr_read_b32 v46, a62
    v_accvgpr_read_b32 v47, a63
    v_mul_f32 v40, v40, v251
    v_mfma_f32_16x16x32_bf16 a[116:119], a[188:191], v[88:91], a[116:119]
    v_mul_f32 v41, v41, v251
    v_mul_f32 v42, v42, v251
    v_mul_f32 v43, v43, v251
    v_mul_f32 v44, v44, v251
    v_mfma_f32_16x16x32_bf16 a[112:115], a[188:191], v[84:87], a[112:115]
    v_mul_f32 v45, v45, v251
    v_mul_f32 v46, v46, v251
    v_mul_f32 v47, v47, v251
    v_cvt_pk_bf16_f32 v48, v40, v41
    v_mfma_f32_16x16x32_bf16 a[112:115], a[184:187], v[68:71], a[112:115]
    v_cvt_pk_bf16_f32 v49, v42, v43
    v_cvt_pk_bf16_f32 v50, v44, v45
    v_cvt_pk_bf16_f32 v51, v46, v47
    buffer_store_dwordx4 v[48:51], v222, s[20:23], s76 offen offset:0 sc1
L_tail:
    v_accvgpr_read_b32 v4, a64
    v_accvgpr_read_b32 v5, a65
    v_accvgpr_read_b32 v6, a66
    v_accvgpr_read_b32 v7, a67
    v_accvgpr_read_b32 v8, a80
    s_mov_b32 s79, 12288
    buffer_load_dwordx4 v[232:235], v231, s[44:47], s79 offen offset:0 sc1
    v_accvgpr_read_b32 v9, a81
    v_accvgpr_read_b32 v10, a82
    v_accvgpr_read_b32 v11, a83
    v_pk_mul_f32 v[4:5], v[4:5], v[248:249] op_sel:[0,0] op_sel_hi:[1,0]
    v_pk_mul_f32 v[6:7], v[6:7], v[248:249] op_sel:[0,0] op_sel_hi:[1,0]
    buffer_load_dwordx4 v[236:239], v231, s[44:47], s79 offen offset:1024 sc1
    v_pk_mul_f32 v[8:9], v[8:9], v[248:249] op_sel:[0,0] op_sel_hi:[1,0]
    v_pk_mul_f32 v[10:11], v[10:11], v[248:249] op_sel:[0,0] op_sel_hi:[1,0]
    v_cvt_pk_bf16_f32 v12, v4, v5
    v_cvt_pk_bf16_f32 v13, v6, v7
    v_cvt_pk_bf16_f32 v14, v8, v9
    buffer_load_dwordx4 v[240:243], v231, s[44:47], s79 offen offset:2048 sc1
    v_cvt_pk_bf16_f32 v15, v10, v11
    v_add_u32 v222, 32768, v222
    buffer_store_dwordx4 v[12:15], v222, s[20:23], 0 offen offset:0 sc1
    v_accvgpr_read_b32 v16, a68
    v_accvgpr_read_b32 v17, a69
    buffer_load_dwordx4 v[244:247], v231, s[44:47], s79 offen offset:3072 sc1
    v_accvgpr_read_b32 v18, a70
    v_accvgpr_read_b32 v19, a71
    v_accvgpr_read_b32 v20, a84
    v_accvgpr_read_b32 v21, a85
    v_accvgpr_read_b32 v22, a86
    s_mov_b32 s79, 16384
    buffer_load_dwordx4 v[116:119], v231, s[44:47], s79 offen offset:0 sc1
    v_accvgpr_read_b32 v23, a87
    v_pk_mul_f32 v[16:17], v[16:17], v[248:249] op_sel:[0,1] op_sel_hi:[1,1]
    v_pk_mul_f32 v[18:19], v[18:19], v[248:249] op_sel:[0,1] op_sel_hi:[1,1]
    v_pk_mul_f32 v[20:21], v[20:21], v[248:249] op_sel:[0,1] op_sel_hi:[1,1]
    v_pk_mul_f32 v[22:23], v[22:23], v[248:249] op_sel:[0,1] op_sel_hi:[1,1]
    buffer_load_dwordx4 v[120:123], v231, s[44:47], s79 offen offset:1024 sc1
    v_cvt_pk_bf16_f32 v24, v16, v17
    v_cvt_pk_bf16_f32 v25, v18, v19
    v_cvt_pk_bf16_f32 v26, v20, v21
    v_cvt_pk_bf16_f32 v27, v22, v23
    buffer_store_dwordx4 v[24:27], v222, s[20:23], s69 offen offset:0 sc1
    buffer_load_dwordx4 v[124:127], v231, s[44:47], s79 offen offset:2048 sc1
    v_accvgpr_read_b32 v28, a72
    v_accvgpr_read_b32 v29, a73
    v_accvgpr_read_b32 v30, a74
    v_accvgpr_read_b32 v31, a75
    v_accvgpr_read_b32 v32, a88
    buffer_load_dwordx4 v[128:131], v231, s[44:47], s79 offen offset:3072 sc1
    v_accvgpr_read_b32 v33, a89
    v_accvgpr_read_b32 v34, a90
    v_accvgpr_read_b32 v35, a91
    v_pk_mul_f32 v[28:29], v[28:29], v[250:251] op_sel:[0,0] op_sel_hi:[1,0]
    v_pk_mul_f32 v[30:31], v[30:31], v[250:251] op_sel:[0,0] op_sel_hi:[1,0]
    s_mov_b32 s79, 81920
    buffer_load_dwordx4 a[160:163], v231, s[44:47], s79 offen offset:0 sc1
    v_pk_mul_f32 v[32:33], v[32:33], v[250:251] op_sel:[0,0] op_sel_hi:[1,0]
    v_pk_mul_f32 v[34:35], v[34:35], v[250:251] op_sel:[0,0] op_sel_hi:[1,0]
    v_cvt_pk_bf16_f32 v36, v28, v29
    v_cvt_pk_bf16_f32 v37, v30, v31
    v_cvt_pk_bf16_f32 v38, v32, v33
    buffer_load_dwordx4 a[164:167], v231, s[44:47], s79 offen offset:1024 sc1
    v_cvt_pk_bf16_f32 v39, v34, v35
    buffer_store_dwordx4 v[36:39], v222, s[20:23], s75 offen offset:0 sc1
    v_accvgpr_read_b32 v40, a76
    v_accvgpr_read_b32 v41, a77
    v_accvgpr_read_b32 v42, a78
    buffer_load_dwordx4 a[168:171], v231, s[44:47], s79 offen offset:2048 sc1
    v_accvgpr_read_b32 v43, a79
    v_accvgpr_read_b32 v44, a92
    v_accvgpr_read_b32 v45, a93
    v_accvgpr_read_b32 v46, a94
    v_accvgpr_read_b32 v47, a95
    buffer_load_dwordx4 a[172:175], v231, s[44:47], s79 offen offset:3072 sc1
    v_pk_mul_f32 v[40:41], v[40:41], v[250:251] op_sel:[0,1] op_sel_hi:[1,1]
    v_pk_mul_f32 v[42:43], v[42:43], v[250:251] op_sel:[0,1] op_sel_hi:[1,1]
    v_pk_mul_f32 v[44:45], v[44:45], v[250:251] op_sel:[0,1] op_sel_hi:[1,1]
    v_pk_mul_f32 v[46:47], v[46:47], v[250:251] op_sel:[0,1] op_sel_hi:[1,1]
    v_cvt_pk_bf16_f32 v48, v40, v41
    s_mov_b32 s79, 86016
    s_waitcnt vmcnt(40)
    buffer_load_dwordx4 a[176:179], v231, s[44:47], s79 offen offset:0 sc1
    v_cvt_pk_bf16_f32 v49, v42, v43
    v_cvt_pk_bf16_f32 v50, v44, v45
    v_cvt_pk_bf16_f32 v51, v46, v47
    buffer_store_dwordx4 v[48:51], v222, s[20:23], s76 offen offset:0 sc1
    v_accvgpr_read_b32 v4, a96
    buffer_load_dwordx4 a[180:183], v231, s[44:47], s79 offen offset:1024 sc1
    v_accvgpr_read_b32 v5, a97
    v_accvgpr_read_b32 v6, a98
    v_accvgpr_read_b32 v7, a99
    v_accvgpr_read_b32 v8, a112
    v_accvgpr_read_b32 v9, a113
    buffer_load_dwordx4 a[184:187], v231, s[44:47], s79 offen offset:2048 sc1
    v_accvgpr_read_b32 v10, a114
    v_accvgpr_read_b32 v11, a115
    v_pk_mul_f32 v[4:5], v[4:5], v[248:249] op_sel:[0,0] op_sel_hi:[1,0]
    v_pk_mul_f32 v[6:7], v[6:7], v[248:249] op_sel:[0,0] op_sel_hi:[1,0]
    v_pk_mul_f32 v[8:9], v[8:9], v[248:249] op_sel:[0,0] op_sel_hi:[1,0]
    buffer_load_dwordx4 a[188:191], v231, s[44:47], s79 offen offset:3072 sc1
    v_pk_mul_f32 v[10:11], v[10:11], v[248:249] op_sel:[0,0] op_sel_hi:[1,0]
    v_cvt_pk_bf16_f32 v12, v4, v5
    v_cvt_pk_bf16_f32 v13, v6, v7
    v_cvt_pk_bf16_f32 v14, v8, v9
    v_cvt_pk_bf16_f32 v15, v10, v11
    s_mov_b32 s79, 90112
    buffer_load_dwordx4 a[192:195], v231, s[44:47], s79 offen offset:0 sc1
    v_add_u32 v222, 32768, v222
    buffer_store_dwordx4 v[12:15], v222, s[20:23], 0 offen offset:0 sc1
    v_accvgpr_read_b32 v16, a100
    v_accvgpr_read_b32 v17, a101
    v_accvgpr_read_b32 v18, a102
    buffer_load_dwordx4 a[196:199], v231, s[44:47], s79 offen offset:1024 sc1
    v_accvgpr_read_b32 v19, a103
    v_accvgpr_read_b32 v20, a116
    v_accvgpr_read_b32 v21, a117
    v_accvgpr_read_b32 v22, a118
    v_accvgpr_read_b32 v23, a119
    buffer_load_dwordx4 a[200:203], v231, s[44:47], s79 offen offset:2048 sc1
    v_pk_mul_f32 v[16:17], v[16:17], v[248:249] op_sel:[0,1] op_sel_hi:[1,1]
    v_pk_mul_f32 v[18:19], v[18:19], v[248:249] op_sel:[0,1] op_sel_hi:[1,1]
    v_pk_mul_f32 v[20:21], v[20:21], v[248:249] op_sel:[0,1] op_sel_hi:[1,1]
    v_pk_mul_f32 v[22:23], v[22:23], v[248:249] op_sel:[0,1] op_sel_hi:[1,1]
    v_cvt_pk_bf16_f32 v24, v16, v17
    buffer_load_dwordx4 a[204:207], v231, s[44:47], s79 offen offset:3072 sc1
    v_cvt_pk_bf16_f32 v25, v18, v19
    v_cvt_pk_bf16_f32 v26, v20, v21
    v_cvt_pk_bf16_f32 v27, v22, v23
    buffer_store_dwordx4 v[24:27], v222, s[20:23], s69 offen offset:0 sc1
    v_accvgpr_read_b32 v28, a104
    s_mov_b32 s79, 94208
    buffer_load_dwordx4 v[52:55], v231, s[44:47], s79 offen offset:0 sc1
    v_accvgpr_read_b32 v29, a105
    v_accvgpr_read_b32 v30, a106
    v_accvgpr_read_b32 v31, a107
    v_accvgpr_read_b32 v32, a120
    v_accvgpr_read_b32 v33, a121
    buffer_load_dwordx4 v[56:59], v231, s[44:47], s79 offen offset:1024 sc1
    v_accvgpr_read_b32 v34, a122
    v_accvgpr_read_b32 v35, a123
    v_pk_mul_f32 v[28:29], v[28:29], v[250:251] op_sel:[0,0] op_sel_hi:[1,0]
    v_pk_mul_f32 v[30:31], v[30:31], v[250:251] op_sel:[0,0] op_sel_hi:[1,0]
    v_pk_mul_f32 v[32:33], v[32:33], v[250:251] op_sel:[0,0] op_sel_hi:[1,0]
    buffer_load_dwordx4 v[60:63], v231, s[44:47], s79 offen offset:2048 sc1
    v_pk_mul_f32 v[34:35], v[34:35], v[250:251] op_sel:[0,0] op_sel_hi:[1,0]
    v_cvt_pk_bf16_f32 v36, v28, v29
    v_cvt_pk_bf16_f32 v37, v30, v31
    v_cvt_pk_bf16_f32 v38, v32, v33
    v_cvt_pk_bf16_f32 v39, v34, v35
    buffer_load_dwordx4 v[64:67], v231, s[44:47], s79 offen offset:3072 sc1
    buffer_store_dwordx4 v[36:39], v222, s[20:23], s75 offen offset:0 sc1
    v_accvgpr_read_b32 v40, a108
    v_accvgpr_read_b32 v41, a109
    v_accvgpr_read_b32 v42, a110
    v_accvgpr_read_b32 v43, a111
    v_accvgpr_read_b32 v44, a124
    v_accvgpr_read_b32 v45, a125
    v_accvgpr_read_b32 v46, a126
    v_accvgpr_read_b32 v47, a127
    v_pk_mul_f32 v[40:41], v[40:41], v[250:251] op_sel:[0,1] op_sel_hi:[1,1]
    v_pk_mul_f32 v[42:43], v[42:43], v[250:251] op_sel:[0,1] op_sel_hi:[1,1]
    v_pk_mul_f32 v[44:45], v[44:45], v[250:251] op_sel:[0,1] op_sel_hi:[1,1]
    v_pk_mul_f32 v[46:47], v[46:47], v[250:251] op_sel:[0,1] op_sel_hi:[1,1]
    v_cvt_pk_bf16_f32 v48, v40, v41
    v_cvt_pk_bf16_f32 v49, v42, v43
    v_cvt_pk_bf16_f32 v50, v44, v45
    v_cvt_pk_bf16_f32 v51, v46, v47
    buffer_store_dwordx4 v[48:51], v222, s[20:23], s76 offen offset:0 sc1
    v_mov_b32 v221, 0x4b800000
    v_cmp_nle_f32 vcc, v227, v221
    v_cmp_nle_f32 s[48:49], v228, v221
    s_nop 0
    s_or_b64 vcc, vcc, s[48:49]
    v_cmp_nle_f32 s[48:49], v229, v221
    s_nop 0
    s_or_b64 vcc, vcc, s[48:49]
    v_cmp_nle_f32 s[48:49], v230, v221
    s_nop 0
    s_or_b64 vcc, vcc, s[48:49]
    s_cmp_lg_u64 vcc, 0
    s_cselect_b32 s67, 1, 0
    v_mov_b32 v221, s67
    s_lshl_b32 s68, s64, 2
    s_add_u32 s68, s68, 126976
    v_mov_b32 v222, s68
    s_barrier
    ds_write_b32 v222, v221
    v_mov_b32 v222, 126976
    v_mov_b32 v197, s82
    v_lshlrev_b32 v198, 20, v0
    s_add_u32 s24, s54, 30408704
    s_addc_u32 s25, s55, 0
    s_mov_b32 s26, 0x2800
    s_mov_b32 s27, 0x20000
    s_mul_i32 s67, s64, 3072
    s_add_u32 m0, s67, 114688
    s_nop 0
    buffer_load_dwordx4 v231, s[24:27], s67 offen offset:0 sc1 lds
    buffer_load_dwordx4 v231, s[24:27], s67 offen offset:1024 sc1 lds
    buffer_load_dwordx4 v231, s[24:27], s67 offen offset:2048 sc1 lds
    s_add_u32 s68, s64, 1
    s_and_b32 s68, s68, 3
    s_mul_i32 s68, s68, 12288
    s_add_u32 s68, s68, 0
    v_add_u32 v226, s68, v231
    s_add_u32 s68, s64, 2
    s_and_b32 s68, s68, 3
    s_mul_i32 s68, s68, 12288
    s_add_u32 s68, s68, 4096
    v_add_u32 v227, s68, v231
    s_add_u32 s68, s64, 3
    s_and_b32 s68, s68, 3
    s_mul_i32 s68, s68, 12288
    s_add_u32 s68, s68, 8192
    v_add_u32 v228, s68, v231
    s_mul_i32 s68, s64, 12288
    v_add_u32 v229, s68, v231
    v_and_b32 v220, 48, v218
    s_lshl_b32 s67, s78, 8
    s_add_u32 s67, s67, 114688
    v_add_u32 v216, s67, v220
    s_add_u32 s67, s71, 0
    v_add_u32 v223, s67, v231
    s_add_u32 s67, s71, 65536
    v_add_u32 v224, s67, v231
    s_add_u32 s67, s71, 131072
    v_add_u32 v225, s67, v231
    s_lshl_b32 s67, s77, 16
    s_lshl_b32 s68, s78, 7
    s_add_u32 s67, s67, s68
    s_add_u32 s8, s58, s67
    s_addc_u32 s9, s59, 0
    s_mov_b32 s10, 0xfc80
    s_mov_b32 s11, 0x20000
    s_add_u32 s28, s52, s67
    s_addc_u32 s29, s53, 0
    s_mov_b32 s30, 0xfc80
    s_mov_b32 s31, 0x20000
    v_and_b32 v220, 15, v218
    v_lshrrev_b32 v221, 4, v218
    s_lshl_b32 s67, s64, 14
    v_lshlrev_b32 v196, 10, v220
    v_lshl_add_u32 v196, v221, 3, v196
    v_add_u32 v196, s67, v196
    s_mul_i32 s67, s77, 524288
    s_add_u32 s67, s67, 2097152
    s_add_u32 s4, s54, s67
    s_addc_u32 s5, s55, 0
    s_mov_b32 s6, 0x80000
    s_mov_b32 s7, 0x20000
    s_lshl_b32 s67, s64, 15
    s_add_u32 s68, s64, 1
    s_and_b32 s68, s68, 3
    s_mul_i32 s69, s68, 131072
    s_add_u32 s69, s69, s67
    s_add_u32 s68, s64, 2
    s_and_b32 s68, s68, 3
    s_mul_i32 s70, s68, 131072
    s_add_u32 s70, s70, s67
    s_add_u32 s68, s64, 3
    s_and_b32 s68, s68, 3
    s_mul_i32 s75, s68, 131072
    s_add_u32 s75, s75, s67
    s_add_u32 s68, s64, 4
    s_and_b32 s68, s68, 3
    s_mul_i32 s76, s68, 131072
    s_add_u32 s76, s76, s67
    s_waitcnt lgkmcnt(0)
    s_waitcnt vmcnt(40)
    buffer_load_dwordx2 v[248:249], v196, s[8:11], 0 offen offset:0
    buffer_load_dwordx2 v[250:251], v196, s[8:11], 0 offen offset:32
    buffer_load_dwordx2 v[252:253], v196, s[8:11], 0 offen offset:64
    buffer_load_dwordx2 v[254:255], v196, s[8:11], 0 offen offset:96
    s_waitcnt vmcnt(7)
    s_barrier
    ds_read_b128 v[204:207], v222
    s_waitcnt lgkmcnt(0)
    v_or3_b32 v221, v204, v205, v206
    v_or_b32 v221, v221, v207
    s_nop 0
    v_readfirstlane_b32 s72, v221
    s_lshl_b32 s67, s66, 12
    s_lshl_b32 s68, s65, 7
    s_add_u32 s67, s67, s68
    s_add_u32 s67, s67, 65536
    s_andn2_b32 s72, s72, s73
    s_cbranch_scc1 L_retry
    buffer_store_dword v197, v198, s[40:43], s67 offen sc1
    s_cmp_eq_u32 s2, 0
    s_mov_b32 s67, 14336
    s_cselect_b32 s67, s67, 0x100000
    buffer_store_dword v197, v198, s[40:43], s67 offen sc1
    s_lshr_b32 s68, s77, 2
    s_lshl_b32 s68, s68, 12
    s_add_u32 s68, s68, 65536
    s_cmp_eq_u32 s64, 1
    s_cselect_b32 s68, s68, 0x100000
    v_and_b32 v199, 31, v218
    v_lshlrev_b32 v199, 7, v199
    v_add_u32 v199, s68, v199
    s_mov_b32 s79, 98304
    buffer_load_dwordx4 v[68:71], v231, s[44:47], s79 offen offset:0 sc1
    buffer_load_dwordx4 v[72:75], v231, s[44:47], s79 offen offset:1024 sc1
    buffer_load_dwordx4 v[76:79], v231, s[44:47], s79 offen offset:2048 sc1
    buffer_load_dwordx4 v[80:83], v231, s[44:47], s79 offen offset:3072 sc1
    s_mov_b32 s79, 102400
    buffer_load_dwordx4 v[84:87], v231, s[44:47], s79 offen offset:0 sc1
    buffer_load_dwordx4 v[88:91], v231, s[44:47], s79 offen offset:1024 sc1
    buffer_load_dwordx4 v[92:95], v231, s[44:47], s79 offen offset:2048 sc1
    buffer_load_dwordx4 v[96:99], v231, s[44:47], s79 offen offset:3072 sc1
    s_mov_b32 s79, 106496
    buffer_load_dwordx4 v[100:103], v231, s[44:47], s79 offen offset:0 sc1
    buffer_load_dwordx4 v[104:107], v231, s[44:47], s79 offen offset:1024 sc1
    buffer_load_dwordx4 v[108:111], v231, s[44:47], s79 offen offset:2048 sc1
    buffer_load_dwordx4 v[112:115], v231, s[44:47], s79 offen offset:3072 sc1
    s_mov_b32 s79, 110592
    buffer_load_dwordx4 v[36:39], v231, s[44:47], s79 offen offset:0 sc1
    buffer_load_dwordx4 v[40:43], v231, s[44:47], s79 offen offset:1024 sc1
    buffer_load_dwordx4 v[44:47], v231, s[44:47], s79 offen offset:2048 sc1
    buffer_load_dwordx4 v[48:51], v231, s[44:47], s79 offen offset:3072 sc1
    buffer_load_dword v230, v199, s[40:43], 0 offen sc1
    s_mov_b32 s79, 122880
    buffer_load_dwordx4 v[4:7], v231, s[44:47], s79 offen offset:0 sc1
    buffer_load_dwordx4 v[8:11], v231, s[44:47], s79 offen offset:1024 sc1
    buffer_load_dwordx4 v[12:15], v231, s[44:47], s79 offen offset:2048 sc1
    buffer_load_dwordx4 v[16:19], v231, s[44:47], s79 offen offset:3072 sc1
    s_mov_b32 s79, 126976
    buffer_load_dwordx4 v[20:23], v231, s[44:47], s79 offen offset:0 sc1
    buffer_load_dwordx4 v[24:27], v231, s[44:47], s79 offen offset:1024 sc1
    buffer_load_dwordx4 v[28:31], v231, s[44:47], s79 offen offset:2048 sc1
    buffer_load_dwordx4 v[32:35], v231, s[44:47], s79 offen offset:3072 sc1
    s_cmp_lg_u32 s64, 1
    s_cbranch_scc1 L_h1_ok
    buffer_load_dword v1, v199, s[40:43], 0 offen sc1
    s_waitcnt vmcnt(9)
    v_xor_b32 v230, s82, v230
    v_cmp_ne_u32 vcc, 0, v230
    s_nop 0
    s_and_b32 s67, vcc_lo, 0xffffffff
    s_cmp_eq_u32 s67, 0
    s_cbranch_scc1 L_h1_ok
    s_waitcnt vmcnt(0)
    s_mov_b32 s72, 0
    s_branch L_h1_chk
L_h1_spin:
    buffer_load_dword v1, v199, s[40:43], 0 offen offset:0 sc1
    s_waitcnt vmcnt(0)
L_h1_chk:
    v_xor_b32 v1, s82, v1
    v_cmp_ne_u32 vcc, 0, v1
    s_add_u32 s72, s72, 1
    s_and_b32 s67, vcc_lo, 0xffffffff
    s_cmp_eq_u32 s67, 0
    s_cbranch_scc1 L_h1_ok
    s_sleep 2
    s_cmp_lt_u32 s72, 400000
    s_cbranch_scc1 L_h1_spin
L_h1_ok:
    s_waitcnt lgkmcnt(0)
    s_barrier
    buffer_load_dwordx4 a[64:67], v231, s[4:7], s69 offen offset:0 sc1
    buffer_load_dwordx4 a[68:71], v231, s[4:7], s70 offen offset:0 sc1
    buffer_load_dwordx4 a[72:75], v231, s[4:7], s75 offen offset:0 sc1
    buffer_load_dwordx4 a[76:79], v231, s[4:7], s76 offen offset:0 sc1
    buffer_load_dwordx4 a[80:83], v231, s[4:7], s69 offen offset:1024 sc1
    buffer_load_dwordx4 a[84:87], v231, s[4:7], s70 offen offset:1024 sc1
    buffer_load_dwordx4 a[88:91], v231, s[4:7], s75 offen offset:1024 sc1
    buffer_load_dwordx4 a[92:95], v231, s[4:7], s76 offen offset:1024 sc1
    buffer_load_dwordx4 a[96:99], v231, s[4:7], s69 offen offset:2048 sc1
    buffer_load_dwordx4 a[100:103], v231, s[4:7], s70 offen offset:2048 sc1
    buffer_load_dwordx4 a[104:107], v231, s[4:7], s75 offen offset:2048 sc1
    buffer_load_dwordx4 a[108:111], v231, s[4:7], s76 offen offset:2048 sc1
    buffer_load_dwordx4 a[112:115], v231, s[4:7], s69 offen offset:3072 sc1
    buffer_load_dwordx4 a[116:119], v231, s[4:7], s70 offen offset:3072 sc1
    buffer_load_dwordx4 a[120:123], v231, s[4:7], s75 offen offset:3072 sc1
    buffer_load_dwordx4 a[124:127], v231, s[4:7], s76 offen offset:3072 sc1
    s_add_u32 s69, s69, 4096
    s_add_u32 s70, s70, 4096
    s_add_u32 s75, s75, 4096
    s_add_u32 s76, s76, 4096
    s_mul_i32 s74, s78, 339
    s_add_u32 s74, s74, 26
    s_lshr_b32 s74, s74, 6
    s_lshl_b32 s74, s74, 1
    s_mul_i32 s67, s64, 3
    s_add_u32 s67, s67, s74
    s_lshl_b32 s67, s67, 14
    s_add_u32 s67, s67, 39845888
    s_add_u32 s32, s54, s67
    s_addc_u32 s33, s55, 0
    s_mov_b32 s34, 0xc000
    s_mov_b32 s35, 0x20000
    s_mul_i32 s67, s78, 176128
    s_add_u32 s67, s67, 37748736
    s_add_u32 s36, s54, s67
    s_addc_u32 s37, s55, 0
    s_mov_b32 s38, 0x2b000
    s_mov_b32 s39, 0x20000
    s_lshl_b32 s67, s77, 16
    s_add_u32 s67, s67, 18874368
    s_add_u32 s12, s54, s67
    s_addc_u32 s13, s55, 0
    s_mov_b32 s14, 0x10000
    s_mov_b32 s15, 0x20000
    s_lshl_b32 s67, s77, 12
    s_add_u32 s67, s67, 29360128
    s_add_u32 s16, s54, s67
    s_addc_u32 s17, s55, 0
    s_mov_b32 s18, 0x1000
    s_mov_b32 s19, 0x20000
    s_waitcnt vmcnt(8)
    v_mfma_f32_16x16x32_bf16 a[0:3], a[208:211], a[64:67], 0
    buffer_load_dwordx4 a[12:15], v231, s[4:7], s69 offen offset:0 sc1
    v_mfma_f32_16x16x32_bf16 a[0:3], a[224:227], a[80:83], a[0:3]
    v_mfma_f32_16x16x32_bf16 a[4:7], a[224:227], a[84:87], 0
    v_mfma_f32_16x16x32_bf16 a[4:7], a[208:211], a[68:71], a[4:7]
    v_mfma_f32_16x16x32_bf16 a[8:11], a[208:211], a[72:75], 0
    v_mfma_f32_16x16x32_bf16 a[8:11], a[224:227], a[88:91], a[8:11]
    v_mfma_f32_16x16x32_bf16 v[200:203], a[224:227], a[92:95], 0
    v_mfma_f32_16x16x32_bf16 v[200:203], a[208:211], a[76:79], v[200:203]
    buffer_load_dwordx4 a[28:31], v231, s[4:7], s70 offen offset:0 sc1
    v_mfma_f32_16x16x32_bf16 v[204:207], a[212:215], a[76:79], 0
    v_mfma_f32_16x16x32_bf16 v[204:207], a[228:231], a[92:95], v[204:207]
    v_mfma_f32_16x16x32_bf16 a[24:27], a[228:231], a[88:91], 0
    v_mfma_f32_16x16x32_bf16 a[24:27], a[212:215], a[72:75], a[24:27]
    v_mfma_f32_16x16x32_bf16 a[20:23], a[212:215], a[68:71], 0
    v_mfma_f32_16x16x32_bf16 a[20:23], a[228:231], a[84:87], a[20:23]
    v_mfma_f32_16x16x32_bf16 a[16:19], a[228:231], a[80:83], 0
    v_mfma_f32_16x16x32_bf16 a[16:19], a[212:215], a[64:67], a[16:19]
    buffer_load_dwordx4 a[44:47], v231, s[4:7], s75 offen offset:0 sc1
    v_mfma_f32_16x16x32_bf16 a[32:35], a[216:219], a[64:67], 0
    v_mfma_f32_16x16x32_bf16 a[32:35], a[232:235], a[80:83], a[32:35]
    v_mfma_f32_16x16x32_bf16 a[36:39], a[232:235], a[84:87], 0
    v_mfma_f32_16x16x32_bf16 a[36:39], a[216:219], a[68:71], a[36:39]
    v_mfma_f32_16x16x32_bf16 a[40:43], a[216:219], a[72:75], 0
    v_mfma_f32_16x16x32_bf16 a[40:43], a[232:235], a[88:91], a[40:43]
    v_mfma_f32_16x16x32_bf16 v[208:211], a[232:235], a[92:95], 0
    buffer_load_dwordx4 a[60:63], v231, s[4:7], s76 offen offset:0 sc1
    v_mfma_f32_16x16x32_bf16 v[208:211], a[216:219], a[76:79], v[208:211]
    v_mfma_f32_16x16x32_bf16 v[212:215], a[220:223], a[76:79], 0
    v_mfma_f32_16x16x32_bf16 v[212:215], a[236:239], a[92:95], v[212:215]
    v_mfma_f32_16x16x32_bf16 a[56:59], a[236:239], a[88:91], 0
    v_mfma_f32_16x16x32_bf16 a[56:59], a[220:223], a[72:75], a[56:59]
    v_mfma_f32_16x16x32_bf16 a[52:55], a[220:223], a[68:71], 0
    v_mfma_f32_16x16x32_bf16 a[52:55], a[236:239], a[84:87], a[52:55]
    v_mfma_f32_16x16x32_bf16 a[48:51], a[236:239], a[80:83], 0
    v_mfma_f32_16x16x32_bf16 a[48:51], a[220:223], a[64:67], a[48:51]
    s_waitcnt vmcnt(4)
    v_mfma_f32_16x16x32_bf16 a[0:3], a[240:243], a[96:99], a[0:3]
    buffer_load_dwordx4 a[208:211], v231, s[4:7], s69 offen offset:1024 sc1
    v_mfma_f32_16x16x32_bf16 a[0:3], v[232:235], a[112:115], a[0:3]
    v_mfma_f32_16x16x32_bf16 a[4:7], v[232:235], a[116:119], a[4:7]
    buffer_load_dwordx4 a[212:215], v231, s[4:7], s70 offen offset:1024 sc1
    v_mfma_f32_16x16x32_bf16 a[4:7], a[240:243], a[100:103], a[4:7]
    v_mfma_f32_16x16x32_bf16 a[8:11], a[240:243], a[104:107], a[8:11]
    v_mfma_f32_16x16x32_bf16 a[8:11], v[232:235], a[120:123], a[8:11]
    buffer_load_dwordx4 a[216:219], v231, s[4:7], s75 offen offset:1024 sc1
    v_mfma_f32_16x16x32_bf16 v[200:203], v[232:235], a[124:127], v[200:203]
    v_mfma_f32_16x16x32_bf16 v[200:203], a[240:243], a[108:111], v[200:203]
    buffer_load_dwordx4 a[220:223], v231, s[4:7], s76 offen offset:1024 sc1
    v_mfma_f32_16x16x32_bf16 v[204:207], a[244:247], a[108:111], v[204:207]
    v_mfma_f32_16x16x32_bf16 v[204:207], v[236:239], a[124:127], v[204:207]
    v_mfma_f32_16x16x32_bf16 a[24:27], v[236:239], a[120:123], a[24:27]
    buffer_load_dwordx4 a[64:67], v231, s[4:7], s69 offen offset:2048 sc1
    v_mfma_f32_16x16x32_bf16 a[24:27], a[244:247], a[104:107], a[24:27]
    v_mfma_f32_16x16x32_bf16 a[20:23], a[244:247], a[100:103], a[20:23]
    buffer_load_dwordx4 a[68:71], v231, s[4:7], s70 offen offset:2048 sc1
    v_mfma_f32_16x16x32_bf16 a[20:23], v[236:239], a[116:119], a[20:23]
    v_mfma_f32_16x16x32_bf16 a[16:19], v[236:239], a[112:115], a[16:19]
    v_mfma_f32_16x16x32_bf16 a[16:19], a[244:247], a[96:99], a[16:19]
    buffer_load_dwordx4 a[72:75], v231, s[4:7], s75 offen offset:2048 sc1
    v_mfma_f32_16x16x32_bf16 a[32:35], a[248:251], a[96:99], a[32:35]
    v_mfma_f32_16x16x32_bf16 a[32:35], v[240:243], a[112:115], a[32:35]
    buffer_load_dwordx4 a[76:79], v231, s[4:7], s76 offen offset:2048 sc1
    v_mfma_f32_16x16x32_bf16 a[36:39], v[240:243], a[116:119], a[36:39]
    v_mfma_f32_16x16x32_bf16 a[36:39], a[248:251], a[100:103], a[36:39]
    v_mfma_f32_16x16x32_bf16 a[40:43], a[248:251], a[104:107], a[40:43]
    buffer_load_dwordx4 a[80:83], v231, s[4:7], s69 offen offset:3072 sc1
    v_mfma_f32_16x16x32_bf16 a[40:43], v[240:243], a[120:123], a[40:43]
    v_mfma_f32_16x16x32_bf16 v[208:211], v[240:243], a[124:127], v[208:211]
    buffer_load_dwordx4 a[84:87], v231, s[4:7], s70 offen offset:3072 sc1
    v_mfma_f32_16x16x32_bf16 v[208:211], a[248:251], a[108:111], v[208:211]
    v_mfma_f32_16x16x32_bf16 v[212:215], a[252:255], a[108:111], v[212:215]
    v_mfma_f32_16x16x32_bf16 v[212:215], v[244:247], a[124:127], v[212:215]
    buffer_load_dwordx4 a[88:91], v231, s[4:7], s75 offen offset:3072 sc1
    v_mfma_f32_16x16x32_bf16 a[56:59], v[244:247], a[120:123], a[56:59]
    v_mfma_f32_16x16x32_bf16 a[56:59], a[252:255], a[104:107], a[56:59]
    buffer_load_dwordx4 a[92:95], v231, s[4:7], s76 offen offset:3072 sc1
    s_add_u32 s69, s69, 4096
    s_add_u32 s70, s70, 4096
    s_add_u32 s75, s75, 4096
    s_add_u32 s76, s76, 4096
    v_mfma_f32_16x16x32_bf16 a[52:55], a[252:255], a[100:103], a[52:55]
    v_mfma_f32_16x16x32_bf16 a[52:55], v[244:247], a[116:119], a[52:55]
    v_mfma_f32_16x16x32_bf16 a[48:51], v[244:247], a[112:115], a[48:51]
    v_mfma_f32_16x16x32_bf16 a[48:51], a[252:255], a[96:99], a[48:51]
    s_waitcnt vmcnt(8)
    v_mfma_f32_16x16x32_bf16 a[0:3], v[116:119], a[12:15], a[0:3]
    buffer_load_dwordx4 a[96:99], v231, s[4:7], s69 offen offset:0 sc1
    v_mfma_f32_16x16x32_bf16 a[0:3], v[132:135], a[208:211], a[0:3]
    v_mfma_f32_16x16x32_bf16 a[4:7], v[132:135], a[212:215], a[4:7]
    buffer_load_dwordx4 a[100:103], v231, s[4:7], s70 offen offset:0 sc1
    v_mfma_f32_16x16x32_bf16 a[4:7], v[116:119], a[28:31], a[4:7]
    v_mfma_f32_16x16x32_bf16 a[8:11], v[116:119], a[44:47], a[8:11]
    v_mfma_f32_16x16x32_bf16 a[8:11], v[132:135], a[216:219], a[8:11]
    buffer_load_dwordx4 a[104:107], v231, s[4:7], s75 offen offset:0 sc1
    v_mfma_f32_16x16x32_bf16 v[200:203], v[132:135], a[220:223], v[200:203]
    v_mfma_f32_16x16x32_bf16 v[200:203], v[116:119], a[60:63], v[200:203]
    buffer_load_dwordx4 a[108:111], v231, s[4:7], s76 offen offset:0 sc1
    v_mfma_f32_16x16x32_bf16 v[204:207], v[120:123], a[60:63], v[204:207]
    v_mfma_f32_16x16x32_bf16 v[204:207], v[136:139], a[220:223], v[204:207]
    v_mfma_f32_16x16x32_bf16 a[24:27], v[136:139], a[216:219], a[24:27]
    buffer_load_dwordx4 a[112:115], v231, s[4:7], s69 offen offset:1024 sc1
    v_mfma_f32_16x16x32_bf16 a[24:27], v[120:123], a[44:47], a[24:27]
    v_mfma_f32_16x16x32_bf16 a[20:23], v[120:123], a[28:31], a[20:23]
    buffer_load_dwordx4 a[116:119], v231, s[4:7], s70 offen offset:1024 sc1
    v_mfma_f32_16x16x32_bf16 a[20:23], v[136:139], a[212:215], a[20:23]
    v_mfma_f32_16x16x32_bf16 a[16:19], v[136:139], a[208:211], a[16:19]
    v_mfma_f32_16x16x32_bf16 a[16:19], v[120:123], a[12:15], a[16:19]
    buffer_load_dwordx4 a[120:123], v231, s[4:7], s75 offen offset:1024 sc1
    v_mfma_f32_16x16x32_bf16 a[32:35], v[124:127], a[12:15], a[32:35]
    v_mfma_f32_16x16x32_bf16 a[32:35], v[140:143], a[208:211], a[32:35]
    buffer_load_dwordx4 a[124:127], v231, s[4:7], s76 offen offset:1024 sc1
    v_mfma_f32_16x16x32_bf16 a[36:39], v[140:143], a[212:215], a[36:39]
    v_mfma_f32_16x16x32_bf16 a[36:39], v[124:127], a[28:31], a[36:39]
    v_mfma_f32_16x16x32_bf16 a[40:43], v[124:127], a[44:47], a[40:43]
    s_mov_b32 s79, 114688
    buffer_load_dwordx4 v[232:235], v231, s[44:47], s79 offen offset:0 sc1
    v_mfma_f32_16x16x32_bf16 a[40:43], v[140:143], a[216:219], a[40:43]
    v_mfma_f32_16x16x32_bf16 v[208:211], v[140:143], a[220:223], v[208:211]
    buffer_load_dwordx4 v[236:239], v231, s[44:47], s79 offen offset:1024 sc1
    v_mfma_f32_16x16x32_bf16 v[208:211], v[124:127], a[60:63], v[208:211]
    v_mfma_f32_16x16x32_bf16 v[212:215], v[128:131], a[60:63], v[212:215]
    v_mfma_f32_16x16x32_bf16 v[212:215], v[144:147], a[220:223], v[212:215]
    buffer_load_dwordx4 v[240:243], v231, s[44:47], s79 offen offset:2048 sc1
    v_mfma_f32_16x16x32_bf16 a[56:59], v[144:147], a[216:219], a[56:59]
    v_mfma_f32_16x16x32_bf16 a[56:59], v[128:131], a[44:47], a[56:59]
    buffer_load_dwordx4 v[244:247], v231, s[44:47], s79 offen offset:3072 sc1
    v_mfma_f32_16x16x32_bf16 a[52:55], v[128:131], a[28:31], a[52:55]
    v_mfma_f32_16x16x32_bf16 a[52:55], v[144:147], a[212:215], a[52:55]
    v_mfma_f32_16x16x32_bf16 a[48:51], v[144:147], a[208:211], a[48:51]
    v_mfma_f32_16x16x32_bf16 a[48:51], v[128:131], a[12:15], a[48:51]
    s_waitcnt vmcnt(12)
    v_mfma_f32_16x16x32_bf16 a[0:3], v[148:151], a[64:67], a[0:3]
    buffer_load_dwordx4 a[12:15], v231, s[4:7], s69 offen offset:2048 sc1
    v_mfma_f32_16x16x32_bf16 a[0:3], v[164:167], a[80:83], a[0:3]
    v_mfma_f32_16x16x32_bf16 a[4:7], v[164:167], a[84:87], a[4:7]
    buffer_load_dwordx4 a[28:31], v231, s[4:7], s70 offen offset:2048 sc1
    v_mfma_f32_16x16x32_bf16 a[4:7], v[148:151], a[68:71], a[4:7]
    v_mfma_f32_16x16x32_bf16 a[8:11], v[148:151], a[72:75], a[8:11]
    v_mfma_f32_16x16x32_bf16 a[8:11], v[164:167], a[88:91], a[8:11]
    buffer_load_dwordx4 a[44:47], v231, s[4:7], s75 offen offset:2048 sc1
    v_mfma_f32_16x16x32_bf16 v[200:203], v[164:167], a[92:95], v[200:203]
    v_mfma_f32_16x16x32_bf16 v[200:203], v[148:151], a[76:79], v[200:203]
    buffer_load_dwordx4 a[60:63], v231, s[4:7], s76 offen offset:2048 sc1
    v_mfma_f32_16x16x32_bf16 v[204:207], v[152:155], a[76:79], v[204:207]
    v_mfma_f32_16x16x32_bf16 v[204:207], v[168:171], a[92:95], v[204:207]
    v_mfma_f32_16x16x32_bf16 a[24:27], v[168:171], a[88:91], a[24:27]
    buffer_load_dwordx4 a[208:211], v231, s[4:7], s69 offen offset:3072 sc1
    v_mfma_f32_16x16x32_bf16 a[24:27], v[152:155], a[72:75], a[24:27]
    v_mfma_f32_16x16x32_bf16 a[20:23], v[152:155], a[68:71], a[20:23]
    buffer_load_dwordx4 a[212:215], v231, s[4:7], s70 offen offset:3072 sc1
    v_mfma_f32_16x16x32_bf16 a[20:23], v[168:171], a[84:87], a[20:23]
    v_mfma_f32_16x16x32_bf16 a[16:19], v[168:171], a[80:83], a[16:19]
    v_mfma_f32_16x16x32_bf16 a[16:19], v[152:155], a[64:67], a[16:19]
    buffer_load_dwordx4 a[216:219], v231, s[4:7], s75 offen offset:3072 sc1
    v_mfma_f32_16x16x32_bf16 a[32:35], v[156:159], a[64:67], a[32:35]
    v_mfma_f32_16x16x32_bf16 a[32:35], v[172:175], a[80:83], a[32:35]
    buffer_load_dwordx4 a[220:223], v231, s[4:7], s76 offen offset:3072 sc1
    v_mfma_f32_16x16x32_bf16 a[36:39], v[172:175], a[84:87], a[36:39]
    v_mfma_f32_16x16x32_bf16 a[36:39], v[156:159], a[68:71], a[36:39]
    v_mfma_f32_16x16x32_bf16 a[40:43], v[156:159], a[72:75], a[40:43]
    s_add_u32 s69, s69, 4096
    s_add_u32 s70, s70, 4096
    s_add_u32 s75, s75, 4096
    s_add_u32 s76, s76, 4096
    s_mov_b32 s79, 118784
    buffer_load_dwordx4 v[116:119], v231, s[44:47], s79 offen offset:0 sc1
    v_mfma_f32_16x16x32_bf16 a[40:43], v[172:175], a[88:91], a[40:43]
    v_mfma_f32_16x16x32_bf16 v[208:211], v[172:175], a[92:95], v[208:211]
    buffer_load_dwordx4 v[120:123], v231, s[44:47], s79 offen offset:1024 sc1
    v_mfma_f32_16x16x32_bf16 v[208:211], v[156:159], a[76:79], v[208:211]
    v_mfma_f32_16x16x32_bf16 v[212:215], v[160:163], a[76:79], v[212:215]
    v_mfma_f32_16x16x32_bf16 v[212:215], v[176:179], a[92:95], v[212:215]
    buffer_load_dwordx4 v[124:127], v231, s[44:47], s79 offen offset:2048 sc1
    v_mfma_f32_16x16x32_bf16 a[56:59], v[176:179], a[88:91], a[56:59]
    v_mfma_f32_16x16x32_bf16 a[56:59], v[160:163], a[72:75], a[56:59]
    buffer_load_dwordx4 v[128:131], v231, s[44:47], s79 offen offset:3072 sc1
    v_mfma_f32_16x16x32_bf16 a[52:55], v[160:163], a[68:71], a[52:55]
    v_mfma_f32_16x16x32_bf16 a[52:55], v[176:179], a[84:87], a[52:55]
    v_mfma_f32_16x16x32_bf16 a[48:51], v[176:179], a[80:83], a[48:51]
    v_mfma_f32_16x16x32_bf16 a[48:51], v[160:163], a[64:67], a[48:51]
    s_waitcnt vmcnt(16)
    v_mfma_f32_16x16x32_bf16 a[0:3], v[180:183], a[96:99], a[0:3]
    buffer_load_dwordx4 a[64:67], v231, s[4:7], s69 offen offset:0 sc1
    v_mfma_f32_16x16x32_bf16 a[0:3], a[128:131], a[112:115], a[0:3]
    ds_read_b128 v[132:135], v225 offset:0
    v_mfma_f32_16x16x32_bf16 a[4:7], a[128:131], a[116:119], a[4:7]
    v_mfma_f32_16x16x32_bf16 a[4:7], v[180:183], a[100:103], a[4:7]
    buffer_load_dwordx4 a[68:71], v231, s[4:7], s70 offen offset:0 sc1
    v_mfma_f32_16x16x32_bf16 a[8:11], v[180:183], a[104:107], a[8:11]
    ds_read_b128 v[136:139], v225 offset:1024
    v_mfma_f32_16x16x32_bf16 a[8:11], a[128:131], a[120:123], a[8:11]
    v_mfma_f32_16x16x32_bf16 v[200:203], a[128:131], a[124:127], v[200:203]
    v_mfma_f32_16x16x32_bf16 v[200:203], v[180:183], a[108:111], v[200:203]
    buffer_load_dwordx4 a[72:75], v231, s[4:7], s75 offen offset:0 sc1
    ds_read_b128 v[140:143], v225 offset:2048
    v_mfma_f32_16x16x32_bf16 v[204:207], v[184:187], a[108:111], v[204:207]
    v_mfma_f32_16x16x32_bf16 v[204:207], a[132:135], a[124:127], v[204:207]
    v_mfma_f32_16x16x32_bf16 a[24:27], a[132:135], a[120:123], a[24:27]
    ds_read_b128 v[144:147], v225 offset:3072
    v_mfma_f32_16x16x32_bf16 a[24:27], v[184:187], a[104:107], a[24:27]
    buffer_load_dwordx4 a[76:79], v231, s[4:7], s76 offen offset:0 sc1
    v_mfma_f32_16x16x32_bf16 a[20:23], v[184:187], a[100:103], a[20:23]
    v_mfma_f32_16x16x32_bf16 a[20:23], a[132:135], a[116:119], a[20:23]
    v_mfma_f32_16x16x32_bf16 a[16:19], a[132:135], a[112:115], a[16:19]
    v_mfma_f32_16x16x32_bf16 a[16:19], v[184:187], a[96:99], a[16:19]
    buffer_load_dwordx4 a[80:83], v231, s[4:7], s69 offen offset:1024 sc1
    v_mfma_f32_16x16x32_bf16 a[32:35], v[188:191], a[96:99], a[32:35]
    v_mfma_f32_16x16x32_bf16 a[32:35], a[136:139], a[112:115], a[32:35]
    v_mfma_f32_16x16x32_bf16 a[36:39], a[136:139], a[116:119], a[36:39]
    buffer_load_dwordx4 a[84:87], v231, s[4:7], s70 offen offset:1024 sc1
    v_mfma_f32_16x16x32_bf16 a[36:39], v[188:191], a[100:103], a[36:39]
    v_mfma_f32_16x16x32_bf16 a[40:43], v[188:191], a[104:107], a[40:43]
    v_mfma_f32_16x16x32_bf16 a[40:43], a[136:139], a[120:123], a[40:43]
    v_mfma_f32_16x16x32_bf16 v[208:211], a[136:139], a[124:127], v[208:211]
    buffer_load_dwordx4 a[88:91], v231, s[4:7], s75 offen offset:1024 sc1
    v_mfma_f32_16x16x32_bf16 v[208:211], v[188:191], a[108:111], v[208:211]
    v_mfma_f32_16x16x32_bf16 v[212:215], v[192:195], a[108:111], v[212:215]
    v_mfma_f32_16x16x32_bf16 v[212:215], a[140:143], a[124:127], v[212:215]
    v_mfma_f32_16x16x32_bf16 a[56:59], a[140:143], a[120:123], a[56:59]
    buffer_load_dwordx4 a[92:95], v231, s[4:7], s76 offen offset:1024 sc1
    v_mfma_f32_16x16x32_bf16 a[56:59], v[192:195], a[104:107], a[56:59]
    v_mfma_f32_16x16x32_bf16 a[52:55], v[192:195], a[100:103], a[52:55]
    v_mfma_f32_16x16x32_bf16 a[52:55], a[140:143], a[116:119], a[52:55]
    v_mfma_f32_16x16x32_bf16 a[48:51], a[140:143], a[112:115], a[48:51]
    v_mfma_f32_16x16x32_bf16 a[48:51], v[192:195], a[96:99], a[48:51]
    s_waitcnt vmcnt(12) lgkmcnt(0)
    v_mfma_f32_16x16x32_bf16 a[0:3], a[144:147], a[12:15], a[0:3]
    buffer_load_dwordx4 a[96:99], v231, s[4:7], s69 offen offset:2048 sc1
    v_mfma_f32_16x16x32_bf16 a[0:3], v[132:135], a[208:211], a[0:3]
    ds_read_b128 v[148:151], v225 offset:16384
    v_mfma_f32_16x16x32_bf16 a[4:7], v[132:135], a[212:215], a[4:7]
    v_mfma_f32_16x16x32_bf16 a[4:7], a[144:147], a[28:31], a[4:7]
    buffer_load_dwordx4 a[100:103], v231, s[4:7], s70 offen offset:2048 sc1
    v_mfma_f32_16x16x32_bf16 a[8:11], a[144:147], a[44:47], a[8:11]
    ds_read_b128 v[152:155], v225 offset:17408
    v_mfma_f32_16x16x32_bf16 a[8:11], v[132:135], a[216:219], a[8:11]
    v_mfma_f32_16x16x32_bf16 v[200:203], v[132:135], a[220:223], v[200:203]
    v_mfma_f32_16x16x32_bf16 v[200:203], a[144:147], a[60:63], v[200:203]
    buffer_load_dwordx4 a[104:107], v231, s[4:7], s75 offen offset:2048 sc1
    ds_read_b128 v[156:159], v225 offset:18432
    v_mfma_f32_16x16x32_bf16 v[204:207], a[148:151], a[60:63], v[204:207]
    v_mfma_f32_16x16x32_bf16 v[204:207], v[136:139], a[220:223], v[204:207]
    v_mfma_f32_16x16x32_bf16 a[24:27], v[136:139], a[216:219], a[24:27]
    ds_read_b128 v[160:163], v225 offset:19456
    v_mfma_f32_16x16x32_bf16 a[24:27], a[148:151], a[44:47], a[24:27]
    buffer_load_dwordx4 a[108:111], v231, s[4:7], s76 offen offset:2048 sc1
    v_mfma_f32_16x16x32_bf16 a[20:23], a[148:151], a[28:31], a[20:23]
    v_mfma_f32_16x16x32_bf16 a[20:23], v[136:139], a[212:215], a[20:23]
    ds_read_b128 v[164:167], v223 offset:0
    v_mfma_f32_16x16x32_bf16 a[16:19], v[136:139], a[208:211], a[16:19]
    v_mfma_f32_16x16x32_bf16 a[16:19], a[148:151], a[12:15], a[16:19]
    buffer_load_dwordx4 a[112:115], v231, s[4:7], s69 offen offset:3072 sc1
    v_mfma_f32_16x16x32_bf16 a[32:35], a[152:155], a[12:15], a[32:35]
    ds_read_b128 v[168:171], v223 offset:1024
    v_mfma_f32_16x16x32_bf16 a[32:35], v[140:143], a[208:211], a[32:35]
    v_mfma_f32_16x16x32_bf16 a[36:39], v[140:143], a[212:215], a[36:39]
    buffer_load_dwordx4 a[116:119], v231, s[4:7], s70 offen offset:3072 sc1
    v_mfma_f32_16x16x32_bf16 a[36:39], a[152:155], a[28:31], a[36:39]
    ds_read_b128 v[172:175], v223 offset:2048
    v_mfma_f32_16x16x32_bf16 a[40:43], a[152:155], a[44:47], a[40:43]
    v_mfma_f32_16x16x32_bf16 a[40:43], v[140:143], a[216:219], a[40:43]
    v_mfma_f32_16x16x32_bf16 v[208:211], v[140:143], a[220:223], v[208:211]
    buffer_load_dwordx4 a[120:123], v231, s[4:7], s75 offen offset:3072 sc1
    ds_read_b128 v[176:179], v223 offset:3072
    v_mfma_f32_16x16x32_bf16 v[208:211], a[152:155], a[60:63], v[208:211]
    v_mfma_f32_16x16x32_bf16 v[212:215], a[156:159], a[60:63], v[212:215]
    v_mfma_f32_16x16x32_bf16 v[212:215], v[144:147], a[220:223], v[212:215]
    v_mfma_f32_16x16x32_bf16 a[56:59], v[144:147], a[216:219], a[56:59]
    buffer_load_dwordx4 a[124:127], v231, s[4:7], s76 offen offset:3072 sc1
    s_add_u32 s69, s69, 4096
    s_add_u32 s70, s70, 4096
    s_add_u32 s75, s75, 4096
    s_add_u32 s76, s76, 4096
    v_mfma_f32_16x16x32_bf16 a[56:59], a[156:159], a[44:47], a[56:59]
    v_mfma_f32_16x16x32_bf16 a[52:55], a[156:159], a[28:31], a[52:55]
    v_mfma_f32_16x16x32_bf16 a[52:55], v[144:147], a[212:215], a[52:55]
    v_mfma_f32_16x16x32_bf16 a[48:51], v[144:147], a[208:211], a[48:51]
    v_mfma_f32_16x16x32_bf16 a[48:51], a[156:159], a[12:15], a[48:51]
    s_waitcnt vmcnt(8) lgkmcnt(0)
    v_mfma_f32_16x16x32_bf16 a[0:3], v[148:151], a[64:67], a[0:3]
    buffer_load_dwordx4 a[12:15], v231, s[4:7], s69 offen offset:0 sc1
    v_mfma_f32_16x16x32_bf16 a[0:3], v[164:167], a[80:83], a[0:3]
    ds_read_b128 v[180:183], v224 offset:0
    v_mfma_f32_16x16x32_bf16 a[4:7], v[164:167], a[84:87], a[4:7]
    v_mfma_f32_16x16x32_bf16 a[4:7], v[148:151], a[68:71], a[4:7]
    buffer_load_dwordx4 a[28:31], v231, s[4:7], s70 offen offset:0 sc1
    v_mfma_f32_16x16x32_bf16 a[8:11], v[148:151], a[72:75], a[8:11]
    ds_read_b128 v[184:187], v224 offset:1024
    v_mfma_f32_16x16x32_bf16 a[8:11], v[164:167], a[88:91], a[8:11]
    v_mfma_f32_16x16x32_bf16 v[200:203], v[164:167], a[92:95], v[200:203]
    v_mfma_f32_16x16x32_bf16 v[200:203], v[148:151], a[76:79], v[200:203]
    buffer_load_dwordx4 a[44:47], v231, s[4:7], s75 offen offset:0 sc1
    ds_read_b128 v[188:191], v224 offset:2048
    v_mfma_f32_16x16x32_bf16 v[204:207], v[152:155], a[76:79], v[204:207]
    v_mfma_f32_16x16x32_bf16 v[204:207], v[168:171], a[92:95], v[204:207]
    v_mfma_f32_16x16x32_bf16 a[24:27], v[168:171], a[88:91], a[24:27]
    ds_read_b128 v[192:195], v224 offset:3072
    v_mfma_f32_16x16x32_bf16 a[24:27], v[152:155], a[72:75], a[24:27]
    buffer_load_dwordx4 a[60:63], v231, s[4:7], s76 offen offset:0 sc1
    v_mfma_f32_16x16x32_bf16 a[20:23], v[152:155], a[68:71], a[20:23]
    v_mfma_f32_16x16x32_bf16 a[20:23], v[168:171], a[84:87], a[20:23]
    ds_read_b128 v[132:135], v223 offset:16384
    v_mfma_f32_16x16x32_bf16 a[16:19], v[168:171], a[80:83], a[16:19]
    v_mfma_f32_16x16x32_bf16 a[16:19], v[152:155], a[64:67], a[16:19]
    buffer_load_dwordx4 a[208:211], v231, s[4:7], s69 offen offset:1024 sc1
    v_mfma_f32_16x16x32_bf16 a[32:35], v[156:159], a[64:67], a[32:35]
    ds_read_b128 v[136:139], v223 offset:17408
    v_mfma_f32_16x16x32_bf16 a[32:35], v[172:175], a[80:83], a[32:35]
    v_mfma_f32_16x16x32_bf16 a[36:39], v[172:175], a[84:87], a[36:39]
    buffer_load_dwordx4 a[212:215], v231, s[4:7], s70 offen offset:1024 sc1
    v_mfma_f32_16x16x32_bf16 a[36:39], v[156:159], a[68:71], a[36:39]
    ds_read_b128 v[140:143], v223 offset:18432
    v_mfma_f32_16x16x32_bf16 a[40:43], v[156:159], a[72:75], a[40:43]
    v_mfma_f32_16x16x32_bf16 a[40:43], v[172:175], a[88:91], a[40:43]
    v_mfma_f32_16x16x32_bf16 v[208:211], v[172:175], a[92:95], v[208:211]
    buffer_load_dwordx4 a[216:219], v231, s[4:7], s75 offen offset:1024 sc1
    ds_read_b128 v[144:147], v223 offset:19456
    v_mfma_f32_16x16x32_bf16 v[208:211], v[156:159], a[76:79], v[208:211]
    v_mfma_f32_16x16x32_bf16 v[212:215], v[160:163], a[76:79], v[212:215]
    v_mfma_f32_16x16x32_bf16 v[212:215], v[176:179], a[92:95], v[212:215]
    v_mfma_f32_16x16x32_bf16 a[56:59], v[176:179], a[88:91], a[56:59]
    buffer_load_dwordx4 a[220:223], v231, s[4:7], s76 offen offset:1024 sc1
    v_mfma_f32_16x16x32_bf16 a[56:59], v[160:163], a[72:75], a[56:59]
    v_mfma_f32_16x16x32_bf16 a[52:55], v[160:163], a[68:71], a[52:55]
    v_mfma_f32_16x16x32_bf16 a[52:55], v[176:179], a[84:87], a[52:55]
    v_mfma_f32_16x16x32_bf16 a[48:51], v[176:179], a[80:83], a[48:51]
    v_mfma_f32_16x16x32_bf16 a[48:51], v[160:163], a[64:67], a[48:51]
    s_waitcnt vmcnt(8) lgkmcnt(0)
    v_mfma_f32_16x16x32_bf16 a[0:3], v[180:183], a[96:99], a[0:3]
    buffer_load_dwordx4 a[64:67], v231, s[4:7], s69 offen offset:2048 sc1
    v_mfma_f32_16x16x32_bf16 a[0:3], v[132:135], a[112:115], a[0:3]
    ds_read_b128 v[148:151], v224 offset:16384
    v_mfma_f32_16x16x32_bf16 a[4:7], v[132:135], a[116:119], a[4:7]
    v_mfma_f32_16x16x32_bf16 a[4:7], v[180:183], a[100:103], a[4:7]
    buffer_load_dwordx4 a[68:71], v231, s[4:7], s70 offen offset:2048 sc1
    v_mfma_f32_16x16x32_bf16 a[8:11], v[180:183], a[104:107], a[8:11]
    ds_read_b128 v[152:155], v224 offset:17408
    v_mfma_f32_16x16x32_bf16 a[8:11], v[132:135], a[120:123], a[8:11]
    v_mfma_f32_16x16x32_bf16 v[200:203], v[132:135], a[124:127], v[200:203]
    v_mfma_f32_16x16x32_bf16 v[200:203], v[180:183], a[108:111], v[200:203]
    buffer_load_dwordx4 a[72:75], v231, s[4:7], s75 offen offset:2048 sc1
    ds_read_b128 v[156:159], v224 offset:18432
    v_mfma_f32_16x16x32_bf16 v[204:207], v[184:187], a[108:111], v[204:207]
    v_mfma_f32_16x16x32_bf16 v[204:207], v[136:139], a[124:127], v[204:207]
    v_mfma_f32_16x16x32_bf16 a[24:27], v[136:139], a[120:123], a[24:27]
    ds_read_b128 v[160:163], v224 offset:19456
    v_mfma_f32_16x16x32_bf16 a[24:27], v[184:187], a[104:107], a[24:27]
    buffer_load_dwordx4 a[76:79], v231, s[4:7], s76 offen offset:2048 sc1
    v_mfma_f32_16x16x32_bf16 a[20:23], v[184:187], a[100:103], a[20:23]
    v_mfma_f32_16x16x32_bf16 a[20:23], v[136:139], a[116:119], a[20:23]
    ds_read_b128 v[164:167], v223 offset:32768
    v_mfma_f32_16x16x32_bf16 a[16:19], v[136:139], a[112:115], a[16:19]
    v_mfma_f32_16x16x32_bf16 a[16:19], v[184:187], a[96:99], a[16:19]
    buffer_load_dwordx4 a[80:83], v231, s[4:7], s69 offen offset:3072 sc1
    v_mfma_f32_16x16x32_bf16 a[32:35], v[188:191], a[96:99], a[32:35]
    ds_read_b128 v[168:171], v223 offset:33792
    v_mfma_f32_16x16x32_bf16 a[32:35], v[140:143], a[112:115], a[32:35]
    v_mfma_f32_16x16x32_bf16 a[36:39], v[140:143], a[116:119], a[36:39]
    buffer_load_dwordx4 a[84:87], v231, s[4:7], s70 offen offset:3072 sc1
    v_mfma_f32_16x16x32_bf16 a[36:39], v[188:191], a[100:103], a[36:39]
    ds_read_b128 v[172:175], v223 offset:34816
    v_mfma_f32_16x16x32_bf16 a[40:43], v[188:191], a[104:107], a[40:43]
    v_mfma_f32_16x16x32_bf16 a[40:43], v[140:143], a[120:123], a[40:43]
    v_mfma_f32_16x16x32_bf16 v[208:211], v[140:143], a[124:127], v[208:211]
    buffer_load_dwordx4 a[88:91], v231, s[4:7], s75 offen offset:3072 sc1
    ds_read_b128 v[176:179], v223 offset:35840
    v_mfma_f32_16x16x32_bf16 v[208:211], v[188:191], a[108:111], v[208:211]
    v_mfma_f32_16x16x32_bf16 v[212:215], v[192:195], a[108:111], v[212:215]
    v_mfma_f32_16x16x32_bf16 v[212:215], v[144:147], a[124:127], v[212:215]
    v_mfma_f32_16x16x32_bf16 a[56:59], v[144:147], a[120:123], a[56:59]
    buffer_load_dwordx4 a[92:95], v231, s[4:7], s76 offen offset:3072 sc1
    s_add_u32 s69, s69, 4096
    s_add_u32 s70, s70, 4096
    s_add_u32 s75, s75, 4096
    s_add_u32 s76, s76, 4096
    v_mfma_f32_16x16x32_bf16 a[56:59], v[192:195], a[104:107], a[56:59]
    v_mfma_f32_16x16x32_bf16 a[52:55], v[192:195], a[100:103], a[52:55]
    v_mfma_f32_16x16x32_bf16 a[52:55], v[144:147], a[116:119], a[52:55]
    v_mfma_f32_16x16x32_bf16 a[48:51], v[144:147], a[112:115], a[48:51]
    v_mfma_f32_16x16x32_bf16 a[48:51], v[192:195], a[96:99], a[48:51]
    s_waitcnt vmcnt(8) lgkmcnt(0)
    v_mfma_f32_16x16x32_bf16 a[0:3], v[148:151], a[12:15], a[0:3]
    buffer_load_dwordx4 a[96:99], v231, s[4:7], s69 offen offset:0 sc1
    v_mfma_f32_16x16x32_bf16 a[0:3], v[164:167], a[208:211], a[0:3]
    ds_read_b128 v[180:183], v224 offset:32768
    v_mfma_f32_16x16x32_bf16 a[4:7], v[164:167], a[212:215], a[4:7]
    v_mfma_f32_16x16x32_bf16 a[4:7], v[148:151], a[28:31], a[4:7]
    buffer_load_dwordx4 a[100:103], v231, s[4:7], s70 offen offset:0 sc1
    v_mfma_f32_16x16x32_bf16 a[8:11], v[148:151], a[44:47], a[8:11]
    ds_read_b128 v[184:187], v224 offset:33792
    v_mfma_f32_16x16x32_bf16 a[8:11], v[164:167], a[216:219], a[8:11]
    v_mfma_f32_16x16x32_bf16 v[200:203], v[164:167], a[220:223], v[200:203]
    v_mfma_f32_16x16x32_bf16 v[200:203], v[148:151], a[60:63], v[200:203]
    buffer_load_dwordx4 a[104:107], v231, s[4:7], s75 offen offset:0 sc1
    ds_read_b128 v[188:191], v224 offset:34816
    v_mfma_f32_16x16x32_bf16 v[204:207], v[152:155], a[60:63], v[204:207]
    v_mfma_f32_16x16x32_bf16 v[204:207], v[168:171], a[220:223], v[204:207]
    v_mfma_f32_16x16x32_bf16 a[24:27], v[168:171], a[216:219], a[24:27]
    ds_read_b128 v[192:195], v224 offset:35840
    v_mfma_f32_16x16x32_bf16 a[24:27], v[152:155], a[44:47], a[24:27]
    buffer_load_dwordx4 a[108:111], v231, s[4:7], s76 offen offset:0 sc1
    v_mfma_f32_16x16x32_bf16 a[20:23], v[152:155], a[28:31], a[20:23]
    v_mfma_f32_16x16x32_bf16 a[20:23], v[168:171], a[212:215], a[20:23]
    ds_read_b128 v[132:135], v223 offset:49152
    v_mfma_f32_16x16x32_bf16 a[16:19], v[168:171], a[208:211], a[16:19]
    v_mfma_f32_16x16x32_bf16 a[16:19], v[152:155], a[12:15], a[16:19]
    buffer_load_dwordx4 a[112:115], v231, s[4:7], s69 offen offset:1024 sc1
    v_mfma_f32_16x16x32_bf16 a[32:35], v[156:159], a[12:15], a[32:35]
    ds_read_b128 v[136:139], v223 offset:50176
    v_mfma_f32_16x16x32_bf16 a[32:35], v[172:175], a[208:211], a[32:35]
    v_mfma_f32_16x16x32_bf16 a[36:39], v[172:175], a[212:215], a[36:39]
    buffer_load_dwordx4 a[116:119], v231, s[4:7], s70 offen offset:1024 sc1
    v_mfma_f32_16x16x32_bf16 a[36:39], v[156:159], a[28:31], a[36:39]
    ds_read_b128 v[140:143], v223 offset:51200
    v_mfma_f32_16x16x32_bf16 a[40:43], v[156:159], a[44:47], a[40:43]
    v_mfma_f32_16x16x32_bf16 a[40:43], v[172:175], a[216:219], a[40:43]
    v_mfma_f32_16x16x32_bf16 v[208:211], v[172:175], a[220:223], v[208:211]
    buffer_load_dwordx4 a[120:123], v231, s[4:7], s75 offen offset:1024 sc1
    ds_read_b128 v[144:147], v223 offset:52224
    v_mfma_f32_16x16x32_bf16 v[208:211], v[156:159], a[60:63], v[208:211]
    v_mfma_f32_16x16x32_bf16 v[212:215], v[160:163], a[60:63], v[212:215]
    v_mfma_f32_16x16x32_bf16 v[212:215], v[176:179], a[220:223], v[212:215]
    v_mfma_f32_16x16x32_bf16 a[56:59], v[176:179], a[216:219], a[56:59]
    buffer_load_dwordx4 a[124:127], v231, s[4:7], s76 offen offset:1024 sc1
    v_mfma_f32_16x16x32_bf16 a[56:59], v[160:163], a[44:47], a[56:59]
    v_mfma_f32_16x16x32_bf16 a[52:55], v[160:163], a[28:31], a[52:55]
    v_mfma_f32_16x16x32_bf16 a[52:55], v[176:179], a[212:215], a[52:55]
    v_mfma_f32_16x16x32_bf16 a[48:51], v[176:179], a[208:211], a[48:51]
    v_mfma_f32_16x16x32_bf16 a[48:51], v[160:163], a[12:15], a[48:51]
    s_waitcnt vmcnt(8) lgkmcnt(0)
    v_mfma_f32_16x16x32_bf16 a[0:3], v[180:183], a[64:67], a[0:3]
    buffer_load_dwordx4 a[12:15], v231, s[4:7], s69 offen offset:2048 sc1
    v_mfma_f32_16x16x32_bf16 a[0:3], v[132:135], a[80:83], a[0:3]
    v_mfma_f32_16x16x32_bf16 a[4:7], v[132:135], a[84:87], a[4:7]
    v_mfma_f32_16x16x32_bf16 a[4:7], v[180:183], a[68:71], a[4:7]
    buffer_load_dwordx4 a[28:31], v231, s[4:7], s70 offen offset:2048 sc1
    v_mfma_f32_16x16x32_bf16 a[8:11], v[180:183], a[72:75], a[8:11]
    v_mfma_f32_16x16x32_bf16 a[8:11], v[132:135], a[88:91], a[8:11]
    v_mfma_f32_16x16x32_bf16 v[200:203], v[132:135], a[92:95], v[200:203]
    v_mfma_f32_16x16x32_bf16 v[200:203], v[180:183], a[76:79], v[200:203]
    buffer_load_dwordx4 a[44:47], v231, s[4:7], s75 offen offset:2048 sc1
    v_mfma_f32_16x16x32_bf16 v[204:207], v[184:187], a[76:79], v[204:207]
    v_mfma_f32_16x16x32_bf16 v[204:207], v[136:139], a[92:95], v[204:207]
    v_mfma_f32_16x16x32_bf16 a[24:27], v[136:139], a[88:91], a[24:27]
    v_mfma_f32_16x16x32_bf16 a[24:27], v[184:187], a[72:75], a[24:27]
    buffer_load_dwordx4 a[60:63], v231, s[4:7], s76 offen offset:2048 sc1
    v_mfma_f32_16x16x32_bf16 a[20:23], v[184:187], a[68:71], a[20:23]
    v_mfma_f32_16x16x32_bf16 a[20:23], v[136:139], a[84:87], a[20:23]
    v_mfma_f32_16x16x32_bf16 a[16:19], v[136:139], a[80:83], a[16:19]
    v_mfma_f32_16x16x32_bf16 a[16:19], v[184:187], a[64:67], a[16:19]
    buffer_load_dwordx4 a[208:211], v231, s[4:7], s69 offen offset:3072 sc1
    v_mfma_f32_16x16x32_bf16 a[32:35], v[188:191], a[64:67], a[32:35]
    v_mfma_f32_16x16x32_bf16 a[32:35], v[140:143], a[80:83], a[32:35]
    v_mfma_f32_16x16x32_bf16 a[36:39], v[140:143], a[84:87], a[36:39]
    buffer_load_dwordx4 a[212:215], v231, s[4:7], s70 offen offset:3072 sc1
    v_mfma_f32_16x16x32_bf16 a[36:39], v[188:191], a[68:71], a[36:39]
    v_mfma_f32_16x16x32_bf16 a[40:43], v[188:191], a[72:75], a[40:43]
    v_mfma_f32_16x16x32_bf16 a[40:43], v[140:143], a[88:91], a[40:43]
    v_mfma_f32_16x16x32_bf16 v[208:211], v[140:143], a[92:95], v[208:211]
    buffer_load_dwordx4 a[216:219], v231, s[4:7], s75 offen offset:3072 sc1
    v_mfma_f32_16x16x32_bf16 v[208:211], v[188:191], a[76:79], v[208:211]
    v_mfma_f32_16x16x32_bf16 v[212:215], v[192:195], a[76:79], v[212:215]
    v_mfma_f32_16x16x32_bf16 v[212:215], v[144:147], a[92:95], v[212:215]
    v_mfma_f32_16x16x32_bf16 a[56:59], v[144:147], a[88:91], a[56:59]
    buffer_load_dwordx4 a[220:223], v231, s[4:7], s76 offen offset:3072 sc1
    s_add_u32 s69, s69, 4096
    s_add_u32 s70, s70, 4096
    s_add_u32 s75, s75, 4096
    s_add_u32 s76, s76, 4096
    v_mfma_f32_16x16x32_bf16 a[56:59], v[192:195], a[72:75], a[56:59]
    v_mfma_f32_16x16x32_bf16 a[52:55], v[192:195], a[68:71], a[52:55]
    v_mfma_f32_16x16x32_bf16 a[52:55], v[144:147], a[84:87], a[52:55]
    v_mfma_f32_16x16x32_bf16 a[48:51], v[144:147], a[80:83], a[48:51]
    v_mfma_f32_16x16x32_bf16 a[48:51], v[192:195], a[64:67], a[48:51]
    s_waitcnt vmcnt(8)
    v_mfma_f32_16x16x32_bf16 a[0:3], a[160:163], a[96:99], a[0:3]
    buffer_load_dwordx4 a[64:67], v231, s[4:7], s69 offen offset:0 sc1
    v_mfma_f32_16x16x32_bf16 a[0:3], a[176:179], a[112:115], a[0:3]
    v_mfma_f32_16x16x32_bf16 a[4:7], a[176:179], a[116:119], a[4:7]
    v_mfma_f32_16x16x32_bf16 a[4:7], a[160:163], a[100:103], a[4:7]
    buffer_load_dwordx4 a[68:71], v231, s[4:7], s70 offen offset:0 sc1
    v_mfma_f32_16x16x32_bf16 a[8:11], a[160:163], a[104:107], a[8:11]
    v_mfma_f32_16x16x32_bf16 a[8:11], a[176:179], a[120:123], a[8:11]
    v_mfma_f32_16x16x32_bf16 v[200:203], a[176:179], a[124:127], v[200:203]
    v_mfma_f32_16x16x32_bf16 v[200:203], a[160:163], a[108:111], v[200:203]
    buffer_load_dwordx4 a[72:75], v231, s[4:7], s75 offen offset:0 sc1
    v_mfma_f32_16x16x32_bf16 v[204:207], a[164:167], a[108:111], v[204:207]
    v_mfma_f32_16x16x32_bf16 v[204:207], a[180:183], a[124:127], v[204:207]
    v_mfma_f32_16x16x32_bf16 a[24:27], a[180:183], a[120:123], a[24:27]
    v_mfma_f32_16x16x32_bf16 a[24:27], a[164:167], a[104:107], a[24:27]
    buffer_load_dwordx4 a[76:79], v231, s[4:7], s76 offen offset:0 sc1
    v_mfma_f32_16x16x32_bf16 a[20:23], a[164:167], a[100:103], a[20:23]
    v_mfma_f32_16x16x32_bf16 a[20:23], a[180:183], a[116:119], a[20:23]
    v_mfma_f32_16x16x32_bf16 a[16:19], a[180:183], a[112:115], a[16:19]
    v_mfma_f32_16x16x32_bf16 a[16:19], a[164:167], a[96:99], a[16:19]
    buffer_load_dwordx4 a[80:83], v231, s[4:7], s69 offen offset:1024 sc1
    v_mfma_f32_16x16x32_bf16 a[32:35], a[168:171], a[96:99], a[32:35]
    v_mfma_f32_16x16x32_bf16 a[32:35], a[184:187], a[112:115], a[32:35]
    v_mfma_f32_16x16x32_bf16 a[36:39], a[184:187], a[116:119], a[36:39]
    buffer_load_dwordx4 a[84:87], v231, s[4:7], s70 offen offset:1024 sc1
    v_mfma_f32_16x16x32_bf16 a[36:39], a[168:171], a[100:103], a[36:39]
    v_mfma_f32_16x16x32_bf16 a[40:43], a[168:171], a[104:107], a[40:43]
    v_mfma_f32_16x16x32_bf16 a[40:43], a[184:187], a[120:123], a[40:43]
    v_mfma_f32_16x16x32_bf16 v[208:211], a[184:187], a[124:127], v[208:211]
    buffer_load_dwordx4 a[88:91], v231, s[4:7], s75 offen offset:1024 sc1
    v_mfma_f32_16x16x32_bf16 v[208:211], a[168:171], a[108:111], v[208:211]
    v_mfma_f32_16x16x32_bf16 v[212:215], a[172:175], a[108:111], v[212:215]
    v_mfma_f32_16x16x32_bf16 v[212:215], a[188:191], a[124:127], v[212:215]
    v_mfma_f32_16x16x32_bf16 a[56:59], a[188:191], a[120:123], a[56:59]
    buffer_load_dwordx4 a[92:95], v231, s[4:7], s76 offen offset:1024 sc1
    v_mfma_f32_16x16x32_bf16 a[56:59], a[172:175], a[104:107], a[56:59]
    v_mfma_f32_16x16x32_bf16 a[52:55], a[172:175], a[100:103], a[52:55]
    v_mfma_f32_16x16x32_bf16 a[52:55], a[188:191], a[116:119], a[52:55]
    v_mfma_f32_16x16x32_bf16 a[48:51], a[188:191], a[112:115], a[48:51]
    v_mfma_f32_16x16x32_bf16 a[48:51], a[172:175], a[96:99], a[48:51]
    s_waitcnt vmcnt(8)
    s_barrier
    v_mfma_f32_16x16x32_bf16 a[0:3], a[192:195], a[12:15], a[0:3]
    buffer_load_dwordx4 a[96:99], v231, s[4:7], s69 offen offset:2048 sc1
    v_mfma_f32_16x16x32_bf16 a[0:3], v[52:55], a[208:211], a[0:3]
    v_mfma_f32_16x16x32_bf16 a[4:7], v[52:55], a[212:215], a[4:7]
    v_mfma_f32_16x16x32_bf16 a[4:7], a[192:195], a[28:31], a[4:7]
    buffer_load_dwordx4 a[100:103], v231, s[4:7], s70 offen offset:2048 sc1
    v_mfma_f32_16x16x32_bf16 a[8:11], a[192:195], a[44:47], a[8:11]
    v_mfma_f32_16x16x32_bf16 a[8:11], v[52:55], a[216:219], a[8:11]
    v_mfma_f32_16x16x32_bf16 v[200:203], v[52:55], a[220:223], v[200:203]
    v_mfma_f32_16x16x32_bf16 v[200:203], a[192:195], a[60:63], v[200:203]
    buffer_load_dwordx4 a[104:107], v231, s[4:7], s75 offen offset:2048 sc1
    v_mfma_f32_16x16x32_bf16 v[204:207], a[196:199], a[60:63], v[204:207]
    v_mfma_f32_16x16x32_bf16 v[204:207], v[56:59], a[220:223], v[204:207]
    v_mfma_f32_16x16x32_bf16 a[24:27], v[56:59], a[216:219], a[24:27]
    v_mfma_f32_16x16x32_bf16 a[24:27], a[196:199], a[44:47], a[24:27]
    buffer_load_dwordx4 a[108:111], v231, s[4:7], s76 offen offset:2048 sc1
    v_mfma_f32_16x16x32_bf16 a[20:23], a[196:199], a[28:31], a[20:23]
    v_mfma_f32_16x16x32_bf16 a[20:23], v[56:59], a[212:215], a[20:23]
    v_mfma_f32_16x16x32_bf16 a[16:19], v[56:59], a[208:211], a[16:19]
    v_mfma_f32_16x16x32_bf16 a[16:19], a[196:199], a[12:15], a[16:19]
    buffer_load_dwordx4 a[112:115], v231, s[4:7], s69 offen offset:3072 sc1
    v_mfma_f32_16x16x32_bf16 a[32:35], a[200:203], a[12:15], a[32:35]
    v_mfma_f32_16x16x32_bf16 a[32:35], v[60:63], a[208:211], a[32:35]
    v_mfma_f32_16x16x32_bf16 a[36:39], v[60:63], a[212:215], a[36:39]
    buffer_load_dwordx4 a[116:119], v231, s[4:7], s70 offen offset:3072 sc1
    v_mfma_f32_16x16x32_bf16 a[36:39], a[200:203], a[28:31], a[36:39]
    v_mfma_f32_16x16x32_bf16 a[40:43], a[200:203], a[44:47], a[40:43]
    v_mfma_f32_16x16x32_bf16 a[40:43], v[60:63], a[216:219], a[40:43]
    v_mfma_f32_16x16x32_bf16 v[208:211], v[60:63], a[220:223], v[208:211]
    buffer_load_dwordx4 a[120:123], v231, s[4:7], s75 offen offset:3072 sc1
    v_mfma_f32_16x16x32_bf16 v[208:211], a[200:203], a[60:63], v[208:211]
    v_mfma_f32_16x16x32_bf16 v[212:215], a[204:207], a[60:63], v[212:215]
    v_mfma_f32_16x16x32_bf16 v[212:215], v[64:67], a[220:223], v[212:215]
    v_mfma_f32_16x16x32_bf16 a[56:59], v[64:67], a[216:219], a[56:59]
    buffer_load_dwordx4 a[124:127], v231, s[4:7], s76 offen offset:3072 sc1
    s_add_u32 s69, s69, 4096
    s_add_u32 s70, s70, 4096
    s_add_u32 s75, s75, 4096
    s_add_u32 s76, s76, 4096
    v_mfma_f32_16x16x32_bf16 a[56:59], a[204:207], a[44:47], a[56:59]
    v_mfma_f32_16x16x32_bf16 a[52:55], a[204:207], a[28:31], a[52:55]
    v_mfma_f32_16x16x32_bf16 a[52:55], v[64:67], a[212:215], a[52:55]
    v_mfma_f32_16x16x32_bf16 a[48:51], v[64:67], a[208:211], a[48:51]
    v_mfma_f32_16x16x32_bf16 a[48:51], a[204:207], a[12:15], a[48:51]
    s_waitcnt vmcnt(8)
    v_mfma_f32_16x16x32_bf16 a[0:3], v[68:71], a[64:67], a[0:3]
    buffer_load_dwordx4 a[12:15], v231, s[4:7], s69 offen offset:0 sc1
    v_mfma_f32_16x16x32_bf16 a[0:3], v[84:87], a[80:83], a[0:3]
    v_mfma_f32_16x16x32_bf16 a[4:7], v[84:87], a[84:87], a[4:7]
    v_mfma_f32_16x16x32_bf16 a[4:7], v[68:71], a[68:71], a[4:7]
    buffer_load_dwordx4 a[28:31], v231, s[4:7], s70 offen offset:0 sc1
    v_mfma_f32_16x16x32_bf16 a[8:11], v[68:71], a[72:75], a[8:11]
    v_mfma_f32_16x16x32_bf16 a[8:11], v[84:87], a[88:91], a[8:11]
    v_mfma_f32_16x16x32_bf16 v[200:203], v[84:87], a[92:95], v[200:203]
    v_mfma_f32_16x16x32_bf16 v[200:203], v[68:71], a[76:79], v[200:203]
    buffer_load_dwordx4 a[44:47], v231, s[4:7], s75 offen offset:0 sc1
    v_mfma_f32_16x16x32_bf16 v[204:207], v[72:75], a[76:79], v[204:207]
    v_mfma_f32_16x16x32_bf16 v[204:207], v[88:91], a[92:95], v[204:207]
    v_mfma_f32_16x16x32_bf16 a[24:27], v[88:91], a[88:91], a[24:27]
    v_mfma_f32_16x16x32_bf16 a[24:27], v[72:75], a[72:75], a[24:27]
    buffer_load_dwordx4 a[60:63], v231, s[4:7], s76 offen offset:0 sc1
    v_mfma_f32_16x16x32_bf16 a[20:23], v[72:75], a[68:71], a[20:23]
    v_mfma_f32_16x16x32_bf16 a[20:23], v[88:91], a[84:87], a[20:23]
    v_mfma_f32_16x16x32_bf16 a[16:19], v[88:91], a[80:83], a[16:19]
    v_mfma_f32_16x16x32_bf16 a[16:19], v[72:75], a[64:67], a[16:19]
    buffer_load_dwordx4 a[208:211], v231, s[4:7], s69 offen offset:1024 sc1
    v_mfma_f32_16x16x32_bf16 a[32:35], v[76:79], a[64:67], a[32:35]
    v_mfma_f32_16x16x32_bf16 a[32:35], v[92:95], a[80:83], a[32:35]
    v_mfma_f32_16x16x32_bf16 a[36:39], v[92:95], a[84:87], a[36:39]
    buffer_load_dwordx4 a[212:215], v231, s[4:7], s70 offen offset:1024 sc1
    v_mfma_f32_16x16x32_bf16 a[36:39], v[76:79], a[68:71], a[36:39]
    v_mfma_f32_16x16x32_bf16 a[40:43], v[76:79], a[72:75], a[40:43]
    v_mfma_f32_16x16x32_bf16 a[40:43], v[92:95], a[88:91], a[40:43]
    v_mfma_f32_16x16x32_bf16 v[208:211], v[92:95], a[92:95], v[208:211]
    buffer_load_dwordx4 a[216:219], v231, s[4:7], s75 offen offset:1024 sc1
    v_mfma_f32_16x16x32_bf16 v[208:211], v[76:79], a[76:79], v[208:211]
    v_mfma_f32_16x16x32_bf16 v[212:215], v[80:83], a[76:79], v[212:215]
    v_mfma_f32_16x16x32_bf16 v[212:215], v[96:99], a[92:95], v[212:215]
    v_mfma_f32_16x16x32_bf16 a[56:59], v[96:99], a[88:91], a[56:59]
    buffer_load_dwordx4 a[220:223], v231, s[4:7], s76 offen offset:1024 sc1
    v_mfma_f32_16x16x32_bf16 a[56:59], v[80:83], a[72:75], a[56:59]
    v_mfma_f32_16x16x32_bf16 a[52:55], v[80:83], a[68:71], a[52:55]
    v_mfma_f32_16x16x32_bf16 a[52:55], v[96:99], a[84:87], a[52:55]
    v_mfma_f32_16x16x32_bf16 a[48:51], v[96:99], a[80:83], a[48:51]
    v_mfma_f32_16x16x32_bf16 a[48:51], v[80:83], a[64:67], a[48:51]
    s_waitcnt vmcnt(8)
    v_mfma_f32_16x16x32_bf16 a[0:3], v[100:103], a[96:99], a[0:3]
    buffer_load_dwordx4 a[64:67], v231, s[4:7], s69 offen offset:2048 sc1
    v_mfma_f32_16x16x32_bf16 a[0:3], v[36:39], a[112:115], a[0:3]
    ds_read_b128 v[68:71], v216 offset:0
    v_mfma_f32_16x16x32_bf16 a[4:7], v[36:39], a[116:119], a[4:7]
    v_mfma_f32_16x16x32_bf16 a[4:7], v[100:103], a[100:103], a[4:7]
    buffer_load_dwordx4 a[68:71], v231, s[4:7], s70 offen offset:2048 sc1
    ds_read_b128 v[84:87], v216 offset:4096
    v_mfma_f32_16x16x32_bf16 a[8:11], v[100:103], a[104:107], a[8:11]
    v_mfma_f32_16x16x32_bf16 a[8:11], v[36:39], a[120:123], a[8:11]
    ds_read_b128 v[72:75], v216 offset:64
    v_mfma_f32_16x16x32_bf16 v[200:203], v[36:39], a[124:127], v[200:203]
    v_mfma_f32_16x16x32_bf16 v[200:203], v[100:103], a[108:111], v[200:203]
    buffer_load_dwordx4 a[72:75], v231, s[4:7], s75 offen offset:2048 sc1
    ds_read_b128 v[88:91], v216 offset:4160
    v_mfma_f32_16x16x32_bf16 v[204:207], v[104:107], a[108:111], v[204:207]
    v_mfma_f32_16x16x32_bf16 v[204:207], v[40:43], a[124:127], v[204:207]
    ds_read_b128 v[76:79], v216 offset:128
    v_mfma_f32_16x16x32_bf16 a[24:27], v[40:43], a[120:123], a[24:27]
    v_mfma_f32_16x16x32_bf16 a[24:27], v[104:107], a[104:107], a[24:27]
    buffer_load_dwordx4 a[76:79], v231, s[4:7], s76 offen offset:2048 sc1
    ds_read_b128 v[92:95], v216 offset:4224
    v_mfma_f32_16x16x32_bf16 a[20:23], v[104:107], a[100:103], a[20:23]
    v_mfma_f32_16x16x32_bf16 a[20:23], v[40:43], a[116:119], a[20:23]
    ds_read_b128 v[80:83], v216 offset:192
    v_mfma_f32_16x16x32_bf16 a[16:19], v[40:43], a[112:115], a[16:19]
    v_mfma_f32_16x16x32_bf16 a[16:19], v[104:107], a[96:99], a[16:19]
    buffer_load_dwordx4 a[80:83], v231, s[4:7], s69 offen offset:3072 sc1
    ds_read_b128 v[96:99], v216 offset:4288
    v_mfma_f32_16x16x32_bf16 a[32:35], v[108:111], a[96:99], a[32:35]
    v_lshlrev_b32 v52, 16, v248
    v_mfma_f32_16x16x32_bf16 a[32:35], v[44:47], a[112:115], a[32:35]
    v_and_b32 v53, 0xffff0000, v248
    v_mfma_f32_16x16x32_bf16 a[36:39], v[44:47], a[116:119], a[36:39]
    buffer_load_dwordx4 a[84:87], v231, s[4:7], s70 offen offset:3072 sc1
    v_lshlrev_b32 v54, 16, v249
    v_mfma_f32_16x16x32_bf16 a[36:39], v[108:111], a[100:103], a[36:39]
    v_and_b32 v55, 0xffff0000, v249
    v_mfma_f32_16x16x32_bf16 a[40:43], v[108:111], a[104:107], a[40:43]
    v_lshlrev_b32 v56, 16, v250
    v_mfma_f32_16x16x32_bf16 a[40:43], v[44:47], a[120:123], a[40:43]
    v_and_b32 v57, 0xffff0000, v250
    v_mfma_f32_16x16x32_bf16 v[208:211], v[44:47], a[124:127], v[208:211]
    buffer_load_dwordx4 a[88:91], v231, s[4:7], s75 offen offset:3072 sc1
    v_lshlrev_b32 v58, 16, v251
    v_mfma_f32_16x16x32_bf16 v[208:211], v[108:111], a[108:111], v[208:211]
    v_and_b32 v59, 0xffff0000, v251
    v_mfma_f32_16x16x32_bf16 v[212:215], v[112:115], a[108:111], v[212:215]
    v_lshlrev_b32 v60, 16, v252
    v_mfma_f32_16x16x32_bf16 v[212:215], v[48:51], a[124:127], v[212:215]
    v_and_b32 v61, 0xffff0000, v252
    v_mfma_f32_16x16x32_bf16 a[56:59], v[48:51], a[120:123], a[56:59]
    buffer_load_dwordx4 a[92:95], v231, s[4:7], s76 offen offset:3072 sc1
    s_add_u32 s69, s69, 4096
    s_add_u32 s70, s70, 4096
    s_add_u32 s75, s75, 4096
    s_add_u32 s76, s76, 4096
    v_lshlrev_b32 v62, 16, v253
    v_mfma_f32_16x16x32_bf16 a[56:59], v[112:115], a[104:107], a[56:59]
    v_and_b32 v63, 0xffff0000, v253
    v_mfma_f32_16x16x32_bf16 a[52:55], v[112:115], a[100:103], a[52:55]
    v_lshlrev_b32 v64, 16, v254
    v_mfma_f32_16x16x32_bf16 a[52:55], v[48:51], a[116:119], a[52:55]
    v_and_b32 v65, 0xffff0000, v254
    v_mfma_f32_16x16x32_bf16 a[48:51], v[48:51], a[112:115], a[48:51]
    v_lshlrev_b32 v66, 16, v255
    v_mfma_f32_16x16x32_bf16 a[48:51], v[112:115], a[96:99], a[48:51]
    v_and_b32 v67, 0xffff0000, v255
    s_waitcnt vmcnt(8)
    v_mfma_f32_16x16x32_bf16 a[0:3], v[232:235], a[12:15], a[0:3]
    v_mfma_f32_16x16x32_bf16 a[0:3], v[116:119], a[208:211], a[0:3]
    v_mfma_f32_16x16x32_bf16 a[4:7], v[116:119], a[212:215], a[4:7]
    v_mfma_f32_16x16x32_bf16 a[4:7], v[232:235], a[28:31], a[4:7]
    v_mfma_f32_16x16x32_bf16 a[8:11], v[232:235], a[44:47], a[8:11]
    v_mfma_f32_16x16x32_bf16 a[8:11], v[116:119], a[216:219], a[8:11]
    v_mfma_f32_16x16x32_bf16 v[200:203], v[116:119], a[220:223], v[200:203]
    v_mfma_f32_16x16x32_bf16 v[200:203], v[232:235], a[60:63], v[200:203]
    v_mfma_f32_16x16x32_bf16 v[204:207], v[236:239], a[60:63], v[204:207]
    v_mfma_f32_16x16x32_bf16 v[204:207], v[120:123], a[220:223], v[204:207]
    v_mfma_f32_16x16x32_bf16 a[24:27], v[120:123], a[216:219], a[24:27]
    v_mfma_f32_16x16x32_bf16 a[24:27], v[236:239], a[44:47], a[24:27]
    v_mfma_f32_16x16x32_bf16 a[20:23], v[236:239], a[28:31], a[20:23]
    v_mfma_f32_16x16x32_bf16 a[20:23], v[120:123], a[212:215], a[20:23]
    v_mfma_f32_16x16x32_bf16 a[16:19], v[120:123], a[208:211], a[16:19]
    v_mfma_f32_16x16x32_bf16 a[16:19], v[236:239], a[12:15], a[16:19]
    v_mfma_f32_16x16x32_bf16 a[32:35], v[240:243], a[12:15], a[32:35]
    v_mfma_f32_16x16x32_bf16 a[32:35], v[124:127], a[208:211], a[32:35]
    v_mfma_f32_16x16x32_bf16 a[36:39], v[124:127], a[212:215], a[36:39]
    v_mfma_f32_16x16x32_bf16 a[36:39], v[240:243], a[28:31], a[36:39]
    v_mfma_f32_16x16x32_bf16 a[40:43], v[240:243], a[44:47], a[40:43]
    v_mfma_f32_16x16x32_bf16 a[40:43], v[124:127], a[216:219], a[40:43]
    v_mfma_f32_16x16x32_bf16 v[208:211], v[124:127], a[220:223], v[208:211]
    v_mfma_f32_16x16x32_bf16 v[208:211], v[240:243], a[60:63], v[208:211]
    v_mfma_f32_16x16x32_bf16 v[212:215], v[244:247], a[60:63], v[212:215]
    v_mfma_f32_16x16x32_bf16 v[212:215], v[128:131], a[220:223], v[212:215]
    v_mfma_f32_16x16x32_bf16 a[56:59], v[128:131], a[216:219], a[56:59]
    v_mfma_f32_16x16x32_bf16 a[56:59], v[244:247], a[44:47], a[56:59]
    v_mfma_f32_16x16x32_bf16 a[52:55], v[244:247], a[28:31], a[52:55]
    v_mfma_f32_16x16x32_bf16 a[52:55], v[128:131], a[212:215], a[52:55]
    v_mfma_f32_16x16x32_bf16 a[48:51], v[128:131], a[208:211], a[48:51]
    v_mfma_f32_16x16x32_bf16 a[48:51], v[244:247], a[12:15], a[48:51]
    s_waitcnt vmcnt(0)
    v_mfma_f32_16x16x32_bf16 a[0:3], v[4:7], a[64:67], a[0:3]
    v_mfma_f32_16x16x32_bf16 a[16:19], v[8:11], a[64:67], a[16:19]
    s_mov_b32 s79, 0
    buffer_load_dwordx4 a[128:131], v231, s[32:35], s79 offen offset:0 sc1
    v_mfma_f32_16x16x32_bf16 a[32:35], v[12:15], a[64:67], a[32:35]
    v_mfma_f32_16x16x32_bf16 a[48:51], v[16:19], a[64:67], a[48:51]
    s_mov_b32 s79, 16384
    buffer_load_dwordx4 a[132:135], v231, s[32:35], s79 offen offset:0 sc1
    v_mfma_f32_16x16x32_bf16 a[0:3], v[20:23], a[80:83], a[0:3]
    v_mfma_f32_16x16x32_bf16 a[16:19], v[24:27], a[80:83], a[16:19]
    v_mfma_f32_16x16x32_bf16 a[32:35], v[28:31], a[80:83], a[32:35]
    v_mfma_f32_16x16x32_bf16 a[48:51], v[32:35], a[80:83], a[48:51]
    v_mfma_f32_16x16x32_bf16 a[4:7], v[4:7], a[68:71], a[4:7]
    v_mfma_f32_16x16x32_bf16 a[20:23], v[8:11], a[68:71], a[20:23]
    s_mov_b32 s79, 32768
    buffer_load_dwordx4 a[136:139], v231, s[32:35], s79 offen offset:0 sc1
    v_mfma_f32_16x16x32_bf16 a[36:39], v[12:15], a[68:71], a[36:39]
    v_mfma_f32_16x16x32_bf16 a[52:55], v[16:19], a[68:71], a[52:55]
    s_mov_b32 s79, 0
    buffer_load_dwordx4 a[140:143], v231, s[32:35], s79 offen offset:1024 sc1
    v_mfma_f32_16x16x32_bf16 a[4:7], v[20:23], a[84:87], a[4:7]
    ds_write_b128 v226, a[0:3] offset:0
    v_mfma_f32_16x16x32_bf16 a[20:23], v[24:27], a[84:87], a[20:23]
    ds_write_b128 v226, a[16:19] offset:1024
    v_mfma_f32_16x16x32_bf16 a[36:39], v[28:31], a[84:87], a[36:39]
    ds_write_b128 v226, a[32:35] offset:2048
    v_mfma_f32_16x16x32_bf16 a[52:55], v[32:35], a[84:87], a[52:55]
    ds_write_b128 v226, a[48:51] offset:3072
    v_mfma_f32_16x16x32_bf16 a[8:11], v[4:7], a[72:75], a[8:11]
    v_mfma_f32_16x16x32_bf16 a[24:27], v[8:11], a[72:75], a[24:27]
    s_mov_b32 s79, 16384
    buffer_load_dwordx4 a[144:147], v231, s[32:35], s79 offen offset:1024 sc1
    v_mfma_f32_16x16x32_bf16 a[40:43], v[12:15], a[72:75], a[40:43]
    v_mfma_f32_16x16x32_bf16 a[56:59], v[16:19], a[72:75], a[56:59]
    s_mov_b32 s79, 32768
    buffer_load_dwordx4 a[148:151], v231, s[32:35], s79 offen offset:1024 sc1
    v_mfma_f32_16x16x32_bf16 a[8:11], v[20:23], a[88:91], a[8:11]
    ds_write_b128 v227, a[4:7] offset:0
    v_mfma_f32_16x16x32_bf16 a[24:27], v[24:27], a[88:91], a[24:27]
    ds_write_b128 v227, a[20:23] offset:1024
    v_mfma_f32_16x16x32_bf16 a[40:43], v[28:31], a[88:91], a[40:43]
    ds_write_b128 v227, a[36:39] offset:2048
    v_mfma_f32_16x16x32_bf16 a[56:59], v[32:35], a[88:91], a[56:59]
    ds_write_b128 v227, a[52:55] offset:3072
    v_mfma_f32_16x16x32_bf16 v[200:203], v[4:7], a[76:79], v[200:203]
    v_mfma_f32_16x16x32_bf16 v[204:207], v[8:11], a[76:79], v[204:207]
    s_mov_b32 s79, 0
    buffer_load_dwordx4 a[152:155], v231, s[32:35], s79 offen offset:2048 sc1
    v_mfma_f32_16x16x32_bf16 v[208:211], v[12:15], a[76:79], v[208:211]
    v_mfma_f32_16x16x32_bf16 v[212:215], v[16:19], a[76:79], v[212:215]
    s_mov_b32 s79, 16384
    buffer_load_dwordx4 a[156:159], v231, s[32:35], s79 offen offset:2048 sc1
    v_mfma_f32_16x16x32_bf16 v[200:203], v[20:23], a[92:95], v[200:203]
    ds_write_b128 v228, a[8:11] offset:0
    v_mfma_f32_16x16x32_bf16 v[204:207], v[24:27], a[92:95], v[204:207]
    ds_write_b128 v228, a[24:27] offset:1024
    v_mfma_f32_16x16x32_bf16 v[208:211], v[28:31], a[92:95], v[208:211]
    ds_write_b128 v228, a[40:43] offset:2048
    v_mfma_f32_16x16x32_bf16 v[212:215], v[32:35], a[92:95], v[212:215]
    ds_write_b128 v228, a[56:59] offset:3072
    s_waitcnt lgkmcnt(0)
    s_barrier
    ds_read_b128 v[100:103], v229 offset:0
    ds_read_b128 v[104:107], v229 offset:1024
    ds_read_b128 v[108:111], v229 offset:2048
    ds_read_b128 v[112:115], v229 offset:3072
    s_mov_b32 s79, 32768
    buffer_load_dwordx4 a[160:163], v231, s[32:35], s79 offen offset:2048 sc1
    ds_read_b128 v[116:119], v229 offset:4096
    ds_read_b128 v[120:123], v229 offset:5120
    ds_read_b128 v[124:127], v229 offset:6144
    ds_read_b128 v[128:131], v229 offset:7168
    s_mov_b32 s79, 0
    buffer_load_dwordx4 a[164:167], v231, s[32:35], s79 offen offset:3072 sc1
    ds_read_b128 v[36:39], v229 offset:8192
    ds_read_b128 v[40:43], v229 offset:9216
    ds_read_b128 v[44:47], v229 offset:10240
    ds_read_b128 v[48:51], v229 offset:11264
    s_mov_b32 s79, 16384
    buffer_load_dwordx4 a[168:171], v231, s[32:35], s79 offen offset:3072 sc1
    s_waitcnt lgkmcnt(8)
    v_pk_add_f32 v[200:201], v[200:201], v[100:101]
    v_pk_add_f32 v[202:203], v[202:203], v[102:103]
    v_pk_add_f32 v[204:205], v[204:205], v[104:105]
    v_pk_add_f32 v[206:207], v[206:207], v[106:107]
    v_pk_add_f32 v[208:209], v[208:209], v[108:109]
    v_pk_add_f32 v[210:211], v[210:211], v[110:111]
    v_pk_add_f32 v[212:213], v[212:213], v[112:113]
    v_pk_add_f32 v[214:215], v[214:215], v[114:115]
    s_mov_b32 s79, 32768
    buffer_load_dwordx4 a[172:175], v231, s[32:35], s79 offen offset:3072 sc1
    s_waitcnt lgkmcnt(4)
    v_pk_add_f32 v[200:201], v[200:201], v[116:117]
    v_pk_add_f32 v[202:203], v[202:203], v[118:119]
    v_pk_add_f32 v[204:205], v[204:205], v[120:121]
    v_pk_add_f32 v[206:207], v[206:207], v[122:123]
    v_pk_add_f32 v[208:209], v[208:209], v[124:125]
    v_pk_add_f32 v[210:211], v[210:211], v[126:127]
    v_pk_add_f32 v[212:213], v[212:213], v[128:129]
    v_pk_add_f32 v[214:215], v[214:215], v[130:131]
    s_mov_b32 s79, 4096
    buffer_load_dwordx4 a[176:179], v231, s[32:35], s79 offen offset:0 sc1
    s_waitcnt lgkmcnt(0)
    v_pk_add_f32 v[200:201], v[200:201], v[36:37]
    v_pk_add_f32 v[202:203], v[202:203], v[38:39]
    v_pk_add_f32 v[204:205], v[204:205], v[40:41]
    v_pk_add_f32 v[206:207], v[206:207], v[42:43]
    v_pk_add_f32 v[208:209], v[208:209], v[44:45]
    v_pk_add_f32 v[210:211], v[210:211], v[46:47]
    v_pk_add_f32 v[212:213], v[212:213], v[48:49]
    v_pk_add_f32 v[214:215], v[214:215], v[50:51]
    s_mov_b32 s79, 20480
    buffer_load_dwordx4 a[180:183], v231, s[32:35], s79 offen offset:0 sc1
    v_pk_fma_f32 v[52:53], v[68:69], v[200:201], v[52:53]
    v_pk_fma_f32 v[54:55], v[70:71], v[202:203], v[54:55]
    v_pk_fma_f32 v[56:57], v[72:73], v[204:205], v[56:57]
    v_pk_fma_f32 v[58:59], v[74:75], v[206:207], v[58:59]
    v_pk_fma_f32 v[60:61], v[76:77], v[208:209], v[60:61]
    v_pk_fma_f32 v[62:63], v[78:79], v[210:211], v[62:63]
    v_pk_fma_f32 v[64:65], v[80:81], v[212:213], v[64:65]
    v_pk_fma_f32 v[66:67], v[82:83], v[214:215], v[66:67]
    s_mov_b32 s79, 36864
    buffer_load_dwordx4 a[184:187], v231, s[32:35], s79 offen offset:0 sc1
    v_cvt_pk_bf16_f32 v248, v52, v53
    v_cvt_pk_bf16_f32 v249, v54, v55
    v_cvt_pk_bf16_f32 v250, v56, v57
    v_cvt_pk_bf16_f32 v251, v58, v59
    v_cvt_pk_bf16_f32 v252, v60, v61
    v_cvt_pk_bf16_f32 v253, v62, v63
    v_cvt_pk_bf16_f32 v254, v64, v65
    v_cvt_pk_bf16_f32 v255, v66, v67
    v_lshlrev_b32 v52, 16, v248
    v_and_b32 v53, 0xffff0000, v248
    v_lshlrev_b32 v54, 16, v249
    v_and_b32 v55, 0xffff0000, v249
    v_lshlrev_b32 v56, 16, v250
    v_and_b32 v57, 0xffff0000, v250
    v_lshlrev_b32 v58, 16, v251
    v_and_b32 v59, 0xffff0000, v251
    v_lshlrev_b32 v60, 16, v252
    v_and_b32 v61, 0xffff0000, v252
    v_lshlrev_b32 v62, 16, v253
    v_and_b32 v63, 0xffff0000, v253
    v_lshlrev_b32 v64, 16, v254
    v_and_b32 v65, 0xffff0000, v254
    v_lshlrev_b32 v66, 16, v255
    v_and_b32 v67, 0xffff0000, v255
    v_pk_mul_f32 v[4:5], v[52:53], v[84:85]
    v_pk_mul_f32 v[6:7], v[54:55], v[86:87]
    v_pk_mul_f32 v[8:9], v[56:57], v[88:89]
    v_pk_mul_f32 v[10:11], v[58:59], v[90:91]
    v_pk_mul_f32 v[12:13], v[60:61], v[92:93]
    v_pk_mul_f32 v[14:15], v[62:63], v[94:95]
    v_pk_mul_f32 v[16:17], v[64:65], v[96:97]
    v_pk_mul_f32 v[18:19], v[66:67], v[98:99]
    v_cvt_pk_bf16_f32 v20, v4, v5
    v_cvt_pk_bf16_f32 v21, v6, v7
    v_cvt_pk_bf16_f32 v22, v8, v9
    v_cvt_pk_bf16_f32 v23, v10, v11
    v_cvt_pk_bf16_f32 v24, v12, v13
    v_cvt_pk_bf16_f32 v25, v14, v15
    v_cvt_pk_bf16_f32 v26, v16, v17
    v_cvt_pk_bf16_f32 v27, v18, v19
    s_lshl_b32 s67, s64, 14
    s_lshl_b32 s68, s78, 11
    s_add_u32 s67, s67, s68
    buffer_store_dwordx4 v[20:23], v231, s[12:15], s67 offen offset:0 sc1
    buffer_store_dwordx4 v[24:27], v231, s[12:15], s67 offen offset:1024 sc1
    v_pk_add_f32 v[40:41], v[52:53], v[60:61]
    v_pk_add_f32 v[42:43], v[54:55], v[62:63]
    v_pk_add_f32 v[44:45], v[56:57], v[64:65]
    v_pk_add_f32 v[46:47], v[58:59], v[66:67]
    v_pk_add_f32 v[40:41], v[40:41], v[44:45]
    v_pk_add_f32 v[42:43], v[42:43], v[46:47]
    v_pk_add_f32 v[40:41], v[40:41], v[42:43]
    v_add_f32 v36, v40, v41
    v_mov_b32 v219, v36
    s_nop 1
    v_permlane32_swap_b32 v219, v36
    v_add_f32 v36, v219, v36
    v_mov_b32 v219, v36
    s_nop 1
    v_permlane16_swap_b32 v219, v36
    v_add_f32 v36, v219, v36
    v_mul_f32 v38, 0xbc800000, v36
    v_pk_add_f32 v[52:53], v[52:53], v[38:39] op_sel_hi:[1,0]
    v_pk_add_f32 v[54:55], v[54:55], v[38:39] op_sel_hi:[1,0]
    v_pk_add_f32 v[56:57], v[56:57], v[38:39] op_sel_hi:[1,0]
    v_pk_add_f32 v[58:59], v[58:59], v[38:39] op_sel_hi:[1,0]
    v_pk_add_f32 v[60:61], v[60:61], v[38:39] op_sel_hi:[1,0]
    v_pk_add_f32 v[62:63], v[62:63], v[38:39] op_sel_hi:[1,0]
    v_pk_add_f32 v[64:65], v[64:65], v[38:39] op_sel_hi:[1,0]
    v_pk_add_f32 v[66:67], v[66:67], v[38:39] op_sel_hi:[1,0]
    v_pk_mul_f32 v[60:61], v[60:61], v[60:61]
    v_pk_mul_f32 v[62:63], v[62:63], v[62:63]
    v_pk_mul_f32 v[64:65], v[64:65], v[64:65]
    v_pk_mul_f32 v[66:67], v[66:67], v[66:67]
    v_pk_fma_f32 v[40:41], v[52:53], v[52:53], v[60:61]
    v_pk_fma_f32 v[42:43], v[54:55], v[54:55], v[62:63]
    v_pk_fma_f32 v[44:45], v[56:57], v[56:57], v[64:65]
    v_pk_fma_f32 v[46:47], v[58:59], v[58:59], v[66:67]
    v_pk_add_f32 v[40:41], v[40:41], v[44:45]
    v_pk_add_f32 v[42:43], v[42:43], v[46:47]
    v_pk_add_f32 v[40:41], v[40:41], v[42:43]
    v_add_f32 v37, v40, v41
    v_mov_b32 v219, v37
    s_nop 1
    v_permlane32_swap_b32 v219, v37
    v_add_f32 v37, v219, v37
    v_mov_b32 v219, v37
    s_nop 1
    v_permlane16_swap_b32 v219, v37
    v_add_f32 v37, v219, v37
    v_lshrrev_b32 v220, 4, v218
    v_lshlrev_b32 v220, 20, v220
    v_lshl_add_u32 v220, v218, 3, v220
    s_lshl_b32 s67, s78, 9
    s_lshl_b32 s68, s64, 7
    s_add_u32 s67, s67, s68
    buffer_store_dwordx2 v[36:37], v220, s[16:19], s67 offen sc1
    s_mov_b32 s79, 4096
    buffer_load_dwordx4 a[188:191], v231, s[32:35], s79 offen offset:1024 sc1
    s_mov_b32 s79, 20480
    buffer_load_dwordx4 a[192:195], v231, s[32:35], s79 offen offset:1024 sc1
    s_mov_b32 s79, 36864
    buffer_load_dwordx4 a[196:199], v231, s[32:35], s79 offen offset:1024 sc1
    s_mov_b32 s79, 4096
    buffer_load_dwordx4 a[200:203], v231, s[32:35], s79 offen offset:2048 sc1
    s_mov_b32 s79, 20480
    buffer_load_dwordx4 a[204:207], v231, s[32:35], s79 offen offset:2048 sc1
    s_lshl_b32 s67, s77, 10
    s_lshl_b32 s68, s78, 7
    s_add_u32 s67, s67, s68
    s_add_u32 s67, s67, 131072
    s_waitcnt vmcnt(5)
    s_barrier
    buffer_store_dword v197, v198, s[40:43], s67 offen sc1
    s_lshl_b32 s68, s77, 10
    s_add_u32 s68, s68, 131072
    s_cmp_eq_u32 s64, 1
    s_cselect_b32 s68, s68, 0x100000
    v_and_b32 v199, 7, v218
    v_lshlrev_b32 v199, 7, v199
    v_add_u32 v199, s68, v199
    s_mov_b32 s79, 36864
    buffer_load_dwordx4 a[208:211], v231, s[32:35], s79 offen offset:2048 sc1
    s_mov_b32 s79, 4096
    buffer_load_dwordx4 a[212:215], v231, s[32:35], s79 offen offset:3072 sc1
    s_mov_b32 s79, 20480
    buffer_load_dwordx4 a[216:219], v231, s[32:35], s79 offen offset:3072 sc1
    s_mov_b32 s79, 36864
    buffer_load_dwordx4 a[220:223], v231, s[32:35], s79 offen offset:3072 sc1
    s_mov_b32 s79, 8192
    buffer_load_dwordx4 a[224:227], v231, s[32:35], s79 offen offset:0 sc1
    s_mov_b32 s79, 24576
    buffer_load_dwordx4 a[228:231], v231, s[32:35], s79 offen offset:0 sc1
    s_mov_b32 s79, 40960
    buffer_load_dwordx4 a[232:235], v231, s[32:35], s79 offen offset:0 sc1
    s_mov_b32 s79, 8192
    buffer_load_dwordx4 a[236:239], v231, s[32:35], s79 offen offset:1024 sc1
    s_mov_b32 s79, 24576
    buffer_load_dwordx4 a[240:243], v231, s[32:35], s79 offen offset:1024 sc1
    buffer_load_dword v230, v199, s[40:43], 0 offen sc1
    s_mov_b32 s79, 40960
    buffer_load_dwordx4 a[244:247], v231, s[32:35], s79 offen offset:1024 sc1
    s_mov_b32 s79, 8192
    buffer_load_dwordx4 a[248:251], v231, s[32:35], s79 offen offset:2048 sc1
    s_mov_b32 s79, 24576
    buffer_load_dwordx4 a[252:255], v231, s[32:35], s79 offen offset:2048 sc1
    s_mov_b32 s79, 40960
    buffer_load_dwordx4 v[132:135], v231, s[32:35], s79 offen offset:2048 sc1
    s_mul_i32 s80, s64, 11
    s_min_u32 s80, s80, 32
    s_mul_i32 s67, s64, 3
    s_add_u32 s67, s67, 0
    s_and_b32 s68, s67, 1
    s_lshr_b32 s67, s67, 1
    s_lshl_b32 s67, s67, 12
    s_lshl_b32 s68, s68, 3
    s_add_u32 s67, s67, s68
    s_add_u32 s67, s67, 65536
    v_add_u32 v124, s67, v231
    s_mul_i32 s67, s64, 3
    s_add_u32 s67, s67, 1
    s_and_b32 s68, s67, 1
    s_lshr_b32 s67, s67, 1
    s_lshl_b32 s67, s67, 12
    s_lshl_b32 s68, s68, 3
    s_add_u32 s67, s67, s68
    s_add_u32 s67, s67, 65536
    v_add_u32 v125, s67, v231
    s_mul_i32 s67, s64, 3
    s_add_u32 s67, s67, 2
    s_and_b32 s68, s67, 1
    s_lshr_b32 s67, s67, 1
    s_lshl_b32 s67, s67, 12
    s_lshl_b32 s68, s68, 3
    s_add_u32 s67, s67, s68
    s_add_u32 s67, s67, 65536
    v_add_u32 v126, s67, v231
    v_lshrrev_b32 v220, 4, v218
    v_and_b32 v219, 1, v218
    v_lshlrev_b32 v219, 10, v219
    v_lshl_add_u32 v217, v220, 4, v219
    v_add_u32 v217, 122880, v217
    v_and_b32 v219, 15, v218
    v_lshlrev_b32 v219, 3, v219
    v_add_u32 v110, 127232, v219
    v_lshl_add_u32 v219, v220, 10, v219
    s_lshl_b32 s81, s64, 7
    s_mul_i32 s67, s77, 176128
    s_add_u32 s67, s67, 23068672
    s_add_u32 s4, s54, s67
    s_addc_u32 s5, s55, 0
    s_mov_b32 s6, 0x2b000
    s_mov_b32 s7, 0x20000
    s_lshl_b32 s67, s64, 12
    s_add_u32 s67, s67, 65536
    v_add_u32 v111, s67, v231
    s_lshl_b32 s69, s74, 9
    s_lshl_b32 s67, s64, 10
    s_add_u32 s69, s69, s67
    s_add_u32 s70, s69, 4096
    s_cmp_lt_u32 s64, 2
    s_cselect_b32 s70, s70, 0x100000
    v_mov_b32 v127, 0xbfb8aa3b
    s_lshr_b32 s76, s64, 1
    s_lshl_b32 s76, s76, 14
    s_and_b32 s67, s64, 1
    s_lshl_b32 s67, s67, 12
    s_add_u32 s76, s76, s67
    ds_read_b128 v[64:67], v217 offset:0
    ds_read_b128 v[68:71], v217 offset:64
    ds_read_b128 v[72:75], v217 offset:128
    ds_read_b128 v[76:79], v217 offset:192
    ds_read_b128 v[80:83], v217 offset:256
    s_cmp_lg_u32 s64, 1
    s_cbranch_scc1 L_h2_ok
    buffer_load_dword v1, v199, s[40:43], 0 offen sc1
    s_waitcnt vmcnt(5)
    v_xor_b32 v230, s82, v230
    v_cmp_ne_u32 vcc, 0, v230
    s_nop 0
    s_and_b32 s67, vcc_lo, 0xff
    s_cmp_eq_u32 s67, 0
    s_cbranch_scc1 L_h2_ok
    s_waitcnt vmcnt(0)
    s_mov_b32 s72, 0
    s_branch L_h2_chk
L_h2_spin:
    buffer_load_dword v1, v199, s[40:43], 0 offen offset:0 sc1
    s_waitcnt vmcnt(0)
L_h2_chk:
    v_xor_b32 v1, s82, v1
    v_cmp_ne_u32 vcc, 0, v1
    s_add_u32 s72, s72, 1
    s_and_b32 s67, vcc_lo, 0xff
    s_cmp_eq_u32 s67, 0
    s_cbranch_scc1 L_h2_ok
    s_sleep 2
    s_cmp_lt_u32 s72, 400000
    s_cbranch_scc1 L_h2_spin
L_h2_ok:
    s_barrier
    s_add_u32 s67, s76, 0
    s_mov_b32 m0, s67
    s_nop 0
    buffer_load_dwordx4 v231, s[12:15], s67 offen offset:0 sc1 lds
    buffer_load_dwordx4 v231, s[12:15], s67 offen offset:1024 sc1 lds
    buffer_load_dwordx4 v231, s[12:15], s67 offen offset:2048 sc1 lds
    buffer_load_dwordx4 v231, s[12:15], s67 offen offset:3072 sc1 lds
    buffer_load_dwordx2 v[96:97], v219, s[16:19], s81 offen offset:0 sc1
    buffer_load_dwordx2 v[98:99], v219, s[16:19], s81 offen offset:512 sc1
    s_add_u32 s67, s76, 32768
    s_mov_b32 m0, s67
    s_nop 0
    buffer_load_dwordx4 v231, s[12:15], s67 offen offset:0 sc1 lds
    buffer_load_dwordx4 v231, s[12:15], s67 offen offset:1024 sc1 lds
    buffer_load_dwordx4 v231, s[12:15], s67 offen offset:2048 sc1 lds
    buffer_load_dwordx4 v231, s[12:15], s67 offen offset:3072 sc1 lds
    s_add_u32 s67, s76, 8192
    s_mov_b32 m0, s67
    s_nop 0
    buffer_load_dwordx4 v231, s[12:15], s67 offen offset:0 sc1 lds
    buffer_load_dwordx4 v231, s[12:15], s67 offen offset:1024 sc1 lds
    buffer_load_dwordx4 v231, s[12:15], s67 offen offset:2048 sc1 lds
    buffer_load_dwordx4 v231, s[12:15], s67 offen offset:3072 sc1 lds
    s_add_u32 s67, s76, 40960
    s_mov_b32 m0, s67
    s_nop 0
    buffer_load_dwordx4 v231, s[12:15], s67 offen offset:0 sc1 lds
    buffer_load_dwordx4 v231, s[12:15], s67 offen offset:1024 sc1 lds
    buffer_load_dwordx4 v231, s[12:15], s67 offen offset:2048 sc1 lds
    buffer_load_dwordx4 v231, s[12:15], s67 offen offset:3072 sc1 lds
    s_waitcnt vmcnt(28)
    s_waitcnt lgkmcnt(3)
    v_mfma_f32_16x16x32_bf16 v[52:55], a[128:131], v[64:67], 0
    ds_read_b128 v[84:87], v217 offset:320
    v_mfma_f32_16x16x32_bf16 v[56:59], a[132:135], v[64:67], 0
    v_mfma_f32_16x16x32_bf16 v[60:63], a[136:139], v[64:67], 0
    v_mfma_f32_16x16x32_bf16 v[52:55], a[140:143], v[68:71], v[52:55]
    ds_read_b128 v[88:91], v217 offset:384
    v_mfma_f32_16x16x32_bf16 v[56:59], a[144:147], v[68:71], v[56:59]
    v_mfma_f32_16x16x32_bf16 v[60:63], a[148:151], v[68:71], v[60:63]
    s_waitcnt lgkmcnt(3)
    v_mfma_f32_16x16x32_bf16 v[52:55], a[152:155], v[72:75], v[52:55]
    ds_read_b128 v[92:95], v217 offset:448
    v_mfma_f32_16x16x32_bf16 v[56:59], a[156:159], v[72:75], v[56:59]
    v_mfma_f32_16x16x32_bf16 v[60:63], a[160:163], v[72:75], v[60:63]
    v_mfma_f32_16x16x32_bf16 v[52:55], a[164:167], v[76:79], v[52:55]
    s_waitcnt vmcnt(14)
    s_barrier
    ds_read_b128 v[64:67], v231 offset:0
    v_mfma_f32_16x16x32_bf16 v[56:59], a[168:171], v[76:79], v[56:59]
    v_mfma_f32_16x16x32_bf16 v[60:63], a[172:175], v[76:79], v[60:63]
    s_waitcnt lgkmcnt(3)
    v_mfma_f32_16x16x32_bf16 v[52:55], a[176:179], v[80:83], v[52:55]
    ds_read_b128 v[68:71], v231 offset:1024
    v_mfma_f32_16x16x32_bf16 v[56:59], a[180:183], v[80:83], v[56:59]
    v_mfma_f32_16x16x32_bf16 v[60:63], a[184:187], v[80:83], v[60:63]
    v_mfma_f32_16x16x32_bf16 v[52:55], a[188:191], v[84:87], v[52:55]
    ds_read_b128 v[72:75], v231 offset:2048
    v_mfma_f32_16x16x32_bf16 v[56:59], a[192:195], v[84:87], v[56:59]
    v_mfma_f32_16x16x32_bf16 v[60:63], a[196:199], v[84:87], v[60:63]
    s_waitcnt lgkmcnt(3)
    v_mfma_f32_16x16x32_bf16 v[52:55], a[200:203], v[88:91], v[52:55]
    ds_read_b128 v[76:79], v231 offset:3072
    v_mfma_f32_16x16x32_bf16 v[56:59], a[204:207], v[88:91], v[56:59]
    v_mfma_f32_16x16x32_bf16 v[60:63], a[208:211], v[88:91], v[60:63]
    v_mfma_f32_16x16x32_bf16 v[52:55], a[212:215], v[92:95], v[52:55]
    ds_read_b128 v[80:83], v231 offset:4096
    v_mfma_f32_16x16x32_bf16 v[56:59], a[216:219], v[92:95], v[56:59]
    v_mfma_f32_16x16x32_bf16 v[60:63], a[220:223], v[92:95], v[60:63]
    s_waitcnt lgkmcnt(3)
    v_mfma_f32_16x16x32_bf16 v[4:7], a[128:131], v[64:67], 0
    ds_read_b128 v[84:87], v231 offset:5120
    v_mfma_f32_16x16x32_bf16 v[8:11], a[132:135], v[64:67], 0
    s_mov_b32 s79, 8192
    buffer_load_dwordx4 v[136:139], v231, s[32:35], s79 offen offset:3072 sc1
    v_mfma_f32_16x16x32_bf16 v[12:15], a[136:139], v[64:67], 0
    s_waitcnt vmcnt(13)
    v_mfma_f32_16x16x32_bf16 v[4:7], a[140:143], v[68:71], v[4:7]
    ds_read_b128 v[88:91], v231 offset:6144
    v_add_f32 v108, v96, v98
    v_mfma_f32_16x16x32_bf16 v[8:11], a[144:147], v[68:71], v[8:11]
    s_mov_b32 s79, 24576
    buffer_load_dwordx4 v[140:143], v231, s[32:35], s79 offen offset:3072 sc1
    v_mov_b32 v232, v108
    v_mfma_f32_16x16x32_bf16 v[12:15], a[148:151], v[68:71], v[12:15]
    s_nop 0
    v_permlane32_swap_b32 v232, v108
    s_waitcnt lgkmcnt(3)
    v_mfma_f32_16x16x32_bf16 v[4:7], a[152:155], v[72:75], v[4:7]
    ds_read_b128 v[92:95], v231 offset:7168
    v_add_f32 v108, v232, v108
    v_mfma_f32_16x16x32_bf16 v[8:11], a[156:159], v[72:75], v[8:11]
    v_mov_b32 v232, v108
    s_nop 1
    v_permlane16_swap_b32 v232, v108
    v_mfma_f32_16x16x32_bf16 v[12:15], a[160:163], v[72:75], v[12:15]
    v_add_f32 v108, v232, v108
    v_mul_f32 v108, 0x3b000000, v108
    v_mfma_f32_16x16x32_bf16 v[4:7], a[164:167], v[76:79], v[4:7]
    ds_read_b128 v[64:67], v231 offset:16384
    v_add_f32 v109, v97, v99
    v_mfma_f32_16x16x32_bf16 v[8:11], a[168:171], v[76:79], v[8:11]
    s_mov_b32 s79, 40960
    buffer_load_dwordx4 v[144:147], v231, s[32:35], s79 offen offset:3072 sc1
    v_mul_f32 v96, 0x3c800000, v96
    v_mfma_f32_16x16x32_bf16 v[12:15], a[172:175], v[76:79], v[12:15]
    v_sub_f32 v96, v96, v108
    s_waitcnt lgkmcnt(3)
    v_mfma_f32_16x16x32_bf16 v[4:7], a[176:179], v[80:83], v[4:7]
    ds_read_b128 v[68:71], v231 offset:17408
    v_mul_f32 v96, v96, v96
    v_mfma_f32_16x16x32_bf16 v[8:11], a[180:183], v[80:83], v[8:11]
    v_fmac_f32 v109, 0x42800000, v96
    v_mul_f32 v98, 0x3c800000, v98
    v_mfma_f32_16x16x32_bf16 v[12:15], a[184:187], v[80:83], v[12:15]
    v_sub_f32 v98, v98, v108
    v_mul_f32 v98, v98, v98
    v_mfma_f32_16x16x32_bf16 v[4:7], a[188:191], v[84:87], v[4:7]
    ds_read_b128 v[72:75], v231 offset:18432
    v_fmac_f32 v109, 0x42800000, v98
    v_mfma_f32_16x16x32_bf16 v[8:11], a[192:195], v[84:87], v[8:11]
    s_mov_b32 s79, 12288
    buffer_load_dwordx4 v[148:151], v231, s[32:35], s79 offen offset:0 sc1
    v_mov_b32 v232, v109
    v_mfma_f32_16x16x32_bf16 v[12:15], a[196:199], v[84:87], v[12:15]
    s_nop 0
    v_permlane32_swap_b32 v232, v109
    s_waitcnt lgkmcnt(3)
    v_mfma_f32_16x16x32_bf16 v[4:7], a[200:203], v[88:91], v[4:7]
    ds_read_b128 v[76:79], v231 offset:19456
    v_add_f32 v109, v232, v109
    v_mfma_f32_16x16x32_bf16 v[8:11], a[204:207], v[88:91], v[8:11]
    s_mov_b32 s79, 28672
    buffer_load_dwordx4 v[152:155], v231, s[32:35], s79 offen offset:0 sc1
    v_mfma_f32_16x16x32_bf16 v[12:15], a[208:211], v[88:91], v[12:15]
    v_mfma_f32_16x16x32_bf16 v[4:7], a[212:215], v[92:95], v[4:7]
    ds_read_b128 v[80:83], v231 offset:20480
    v_mfma_f32_16x16x32_bf16 v[8:11], a[216:219], v[92:95], v[8:11]
    v_mfma_f32_16x16x32_bf16 v[12:15], a[220:223], v[92:95], v[12:15]
    s_waitcnt lgkmcnt(3)
    v_mfma_f32_16x16x32_bf16 v[16:19], a[128:131], v[64:67], 0
    ds_read_b128 v[84:87], v231 offset:21504
    v_mov_b32 v232, v109
    v_mfma_f32_16x16x32_bf16 v[20:23], a[132:135], v[64:67], 0
    s_mov_b32 s79, 45056
    buffer_load_dwordx4 v[156:159], v231, s[32:35], s79 offen offset:0 sc1
    v_permlane16_swap_b32 v232, v109
    v_mfma_f32_16x16x32_bf16 v[24:27], a[136:139], v[64:67], 0
    v_add_f32 v109, v232, v109
    v_mul_f32 v109, 0x3b000000, v109
    v_mfma_f32_16x16x32_bf16 v[16:19], a[140:143], v[68:71], v[16:19]
    ds_read_b128 v[88:91], v231 offset:22528
    v_cvt_pk_bf16_f32 v108, v108, v108
    v_mfma_f32_16x16x32_bf16 v[20:23], a[144:147], v[68:71], v[20:23]
    v_and_b32 v108, 0xffff0000, v108
    v_max_f32 v109, 0, v109
    v_mfma_f32_16x16x32_bf16 v[24:27], a[148:151], v[68:71], v[24:27]
    v_cvt_pk_bf16_f32 v109, v109, v109
    s_waitcnt lgkmcnt(3)
    v_mfma_f32_16x16x32_bf16 v[16:19], a[152:155], v[72:75], v[16:19]
    ds_read_b128 v[92:95], v231 offset:23552
    v_and_b32 v109, 0xffff0000, v109
    v_mfma_f32_16x16x32_bf16 v[20:23], a[156:159], v[72:75], v[20:23]
    s_mov_b32 s79, 12288
    buffer_load_dwordx4 v[160:163], v231, s[32:35], s79 offen offset:1024 sc1
    v_add_f32 v109, 0x3727c5ac, v109
    v_mfma_f32_16x16x32_bf16 v[24:27], a[160:163], v[72:75], v[24:27]
    v_cvt_pk_bf16_f32 v109, v109, v109
    v_and_b32 v109, 0xffff0000, v109
    v_mfma_f32_16x16x32_bf16 v[16:19], a[164:167], v[76:79], v[16:19]
    s_waitcnt vmcnt(15)
    s_barrier
    ds_read_b128 v[64:67], v231 offset:32768
    v_mfma_f32_16x16x32_bf16 v[20:23], a[168:171], v[76:79], v[20:23]
    v_sqrt_f32 v109, v109
    v_mfma_f32_16x16x32_bf16 v[24:27], a[172:175], v[76:79], v[24:27]
    v_cvt_pk_bf16_f32 v109, v109, v109
    s_waitcnt lgkmcnt(3)
    v_mfma_f32_16x16x32_bf16 v[16:19], a[176:179], v[80:83], v[16:19]
    ds_read_b128 v[68:71], v231 offset:33792
    v_and_b32 v109, 0xffff0000, v109
    v_mfma_f32_16x16x32_bf16 v[20:23], a[180:183], v[80:83], v[20:23]
    s_mov_b32 s79, 28672
    buffer_load_dwordx4 v[164:167], v231, s[32:35], s79 offen offset:1024 sc1
    v_mfma_f32_16x16x32_bf16 v[24:27], a[184:187], v[80:83], v[24:27]
    v_rcp_f32 v109, v109
    v_mfma_f32_16x16x32_bf16 v[16:19], a[188:191], v[84:87], v[16:19]
    ds_read_b128 v[72:75], v231 offset:34816
    v_sub_f32 v108, 0, v108
    v_mfma_f32_16x16x32_bf16 v[20:23], a[192:195], v[84:87], v[20:23]
    s_mov_b32 s79, 45056
    buffer_load_dwordx4 v[168:171], v231, s[32:35], s79 offen offset:1024 sc1
    v_mul_f32 v109, v127, v109
    v_mfma_f32_16x16x32_bf16 v[24:27], a[196:199], v[84:87], v[24:27]
    v_add_u32 v219, s81, v110
    s_waitcnt lgkmcnt(3)
    v_mfma_f32_16x16x32_bf16 v[16:19], a[200:203], v[88:91], v[16:19]
    ds_read_b128 v[76:79], v231 offset:35840
    v_mfma_f32_16x16x32_bf16 v[20:23], a[204:207], v[88:91], v[20:23]
    v_mfma_f32_16x16x32_bf16 v[24:27], a[208:211], v[88:91], v[24:27]
    v_mfma_f32_16x16x32_bf16 v[16:19], a[212:215], v[92:95], v[16:19]
    ds_read_b128 v[80:83], v231 offset:36864
    v_mfma_f32_16x16x32_bf16 v[20:23], a[216:219], v[92:95], v[20:23]
    s_mov_b32 s79, 12288
    buffer_load_dwordx4 v[172:175], v231, s[32:35], s79 offen offset:2048 sc1
    v_mfma_f32_16x16x32_bf16 v[24:27], a[220:223], v[92:95], v[24:27]
    s_waitcnt lgkmcnt(3)
    v_mfma_f32_16x16x32_bf16 v[28:31], a[128:131], v[64:67], 0
    ds_read_b128 v[84:87], v231 offset:37888
    v_mfma_f32_16x16x32_bf16 v[32:35], a[132:135], v[64:67], 0
    v_mfma_f32_16x16x32_bf16 v[36:39], a[136:139], v[64:67], 0
    v_mfma_f32_16x16x32_bf16 v[28:31], a[140:143], v[68:71], v[28:31]
    ds_read_b128 v[88:91], v231 offset:38912
    v_mfma_f32_16x16x32_bf16 v[32:35], a[144:147], v[68:71], v[32:35]
    s_mov_b32 s79, 28672
    buffer_load_dwordx4 v[176:179], v231, s[32:35], s79 offen offset:2048 sc1
    v_mfma_f32_16x16x32_bf16 v[36:39], a[148:151], v[68:71], v[36:39]
    s_waitcnt lgkmcnt(3)
    v_mfma_f32_16x16x32_bf16 v[28:31], a[152:155], v[72:75], v[28:31]
    ds_read_b128 v[92:95], v231 offset:39936
    v_mfma_f32_16x16x32_bf16 v[32:35], a[156:159], v[72:75], v[32:35]
    v_mfma_f32_16x16x32_bf16 v[36:39], a[160:163], v[72:75], v[36:39]
    v_mfma_f32_16x16x32_bf16 v[28:31], a[164:167], v[76:79], v[28:31]
    ds_read_b128 v[64:67], v231 offset:49152
    v_mfma_f32_16x16x32_bf16 v[32:35], a[168:171], v[76:79], v[32:35]
    s_mov_b32 s79, 45056
    buffer_load_dwordx4 v[180:183], v231, s[32:35], s79 offen offset:2048 sc1
    v_mfma_f32_16x16x32_bf16 v[36:39], a[172:175], v[76:79], v[36:39]
    s_waitcnt lgkmcnt(3)
    v_mfma_f32_16x16x32_bf16 v[28:31], a[176:179], v[80:83], v[28:31]
    ds_read_b128 v[68:71], v231 offset:50176
    v_mfma_f32_16x16x32_bf16 v[32:35], a[180:183], v[80:83], v[32:35]
    s_mov_b32 s79, 12288
    buffer_load_dwordx4 v[184:187], v231, s[32:35], s79 offen offset:3072 sc1
    v_mfma_f32_16x16x32_bf16 v[36:39], a[184:187], v[80:83], v[36:39]
    v_mfma_f32_16x16x32_bf16 v[28:31], a[188:191], v[84:87], v[28:31]
    ds_read_b128 v[72:75], v231 offset:51200
    v_mfma_f32_16x16x32_bf16 v[32:35], a[192:195], v[84:87], v[32:35]
    v_mfma_f32_16x16x32_bf16 v[36:39], a[196:199], v[84:87], v[36:39]
    s_waitcnt lgkmcnt(3)
    v_mfma_f32_16x16x32_bf16 v[28:31], a[200:203], v[88:91], v[28:31]
    ds_read_b128 v[76:79], v231 offset:52224
    v_mfma_f32_16x16x32_bf16 v[32:35], a[204:207], v[88:91], v[32:35]
    s_mov_b32 s79, 28672
    buffer_load_dwordx4 v[188:191], v231, s[32:35], s79 offen offset:3072 sc1
    v_mfma_f32_16x16x32_bf16 v[36:39], a[208:211], v[88:91], v[36:39]
    v_mfma_f32_16x16x32_bf16 v[28:31], a[212:215], v[92:95], v[28:31]
    ds_read_b128 v[80:83], v231 offset:53248
    v_mfma_f32_16x16x32_bf16 v[32:35], a[216:219], v[92:95], v[32:35]
    v_mfma_f32_16x16x32_bf16 v[36:39], a[220:223], v[92:95], v[36:39]
    s_waitcnt lgkmcnt(3)
    v_mfma_f32_16x16x32_bf16 v[40:43], a[128:131], v[64:67], 0
    ds_read_b128 v[84:87], v231 offset:54272
    v_mfma_f32_16x16x32_bf16 v[44:47], a[132:135], v[64:67], 0
    s_mov_b32 s79, 45056
    buffer_load_dwordx4 v[192:195], v231, s[32:35], s79 offen offset:3072 sc1
    v_mfma_f32_16x16x32_bf16 v[48:51], a[136:139], v[64:67], 0
    v_mfma_f32_16x16x32_bf16 v[40:43], a[140:143], v[68:71], v[40:43]
    ds_read_b128 v[88:91], v231 offset:55296
    v_mfma_f32_16x16x32_bf16 v[44:47], a[144:147], v[68:71], v[44:47]
    v_mfma_f32_16x16x32_bf16 v[48:51], a[148:151], v[68:71], v[48:51]
    s_waitcnt lgkmcnt(3)
    v_mfma_f32_16x16x32_bf16 v[40:43], a[152:155], v[72:75], v[40:43]
    ds_read_b128 v[92:95], v231 offset:56320
    v_mfma_f32_16x16x32_bf16 v[44:47], a[156:159], v[72:75], v[44:47]
    s_add_u32 s79, s80, 0
    s_lshl_b32 s79, s79, 12
    s_cmp_eq_u32 s64, 3
    s_cselect_b32 s79, 0x100000, s79
    buffer_load_dwordx4 a[0:3], v231, s[36:39], s79 offen offset:0 sc1
    v_mfma_f32_16x16x32_bf16 v[48:51], a[160:163], v[72:75], v[48:51]
    v_mfma_f32_16x16x32_bf16 v[40:43], a[164:167], v[76:79], v[40:43]
    ds_write_b64 v219, v[108:109]
    ds_read_b128 v[64:67], v217 offset:512
    v_mfma_f32_16x16x32_bf16 v[44:47], a[168:171], v[76:79], v[44:47]
    buffer_load_dwordx4 a[4:7], v231, s[36:39], s79 offen offset:1024 sc1
    v_mfma_f32_16x16x32_bf16 v[48:51], a[172:175], v[76:79], v[48:51]
    s_waitcnt lgkmcnt(4)
    v_mfma_f32_16x16x32_bf16 v[40:43], a[176:179], v[80:83], v[40:43]
    ds_read_b128 v[68:71], v217 offset:576
    v_mfma_f32_16x16x32_bf16 v[44:47], a[180:183], v[80:83], v[44:47]
    v_mfma_f32_16x16x32_bf16 v[48:51], a[184:187], v[80:83], v[48:51]
    v_mfma_f32_16x16x32_bf16 v[40:43], a[188:191], v[84:87], v[40:43]
    ds_read_b128 v[72:75], v217 offset:640
    v_mfma_f32_16x16x32_bf16 v[44:47], a[192:195], v[84:87], v[44:47]
    buffer_load_dwordx4 a[8:11], v231, s[36:39], s79 offen offset:2048 sc1
    v_mfma_f32_16x16x32_bf16 v[48:51], a[196:199], v[84:87], v[48:51]
    s_waitcnt lgkmcnt(4)
    v_mfma_f32_16x16x32_bf16 v[40:43], a[200:203], v[88:91], v[40:43]
    ds_read_b128 v[76:79], v217 offset:704
    v_mfma_f32_16x16x32_bf16 v[44:47], a[204:207], v[88:91], v[44:47]
    v_mfma_f32_16x16x32_bf16 v[48:51], a[208:211], v[88:91], v[48:51]
    v_mfma_f32_16x16x32_bf16 v[40:43], a[212:215], v[92:95], v[40:43]
    ds_read_b128 v[80:83], v217 offset:768
    v_mfma_f32_16x16x32_bf16 v[44:47], a[216:219], v[92:95], v[44:47]
    buffer_load_dwordx4 a[12:15], v231, s[36:39], s79 offen offset:3072 sc1
    v_mfma_f32_16x16x32_bf16 v[48:51], a[220:223], v[92:95], v[48:51]
    s_waitcnt lgkmcnt(3)
    s_waitcnt vmcnt(40)
    v_mfma_f32_16x16x32_bf16 v[52:55], a[224:227], v[64:67], v[52:55]
    ds_read_b128 v[84:87], v217 offset:832
    v_mfma_f32_16x16x32_bf16 v[56:59], a[228:231], v[64:67], v[56:59]
    v_mfma_f32_16x16x32_bf16 v[60:63], a[232:235], v[64:67], v[60:63]
    v_mfma_f32_16x16x32_bf16 v[52:55], a[236:239], v[68:71], v[52:55]
    ds_read_b128 v[88:91], v217 offset:896
    v_mfma_f32_16x16x32_bf16 v[56:59], a[240:243], v[68:71], v[56:59]
    s_add_u32 s79, s80, 1
    s_lshl_b32 s79, s79, 12
    buffer_load_dwordx4 a[16:19], v231, s[36:39], s79 offen offset:0 sc1
    v_mfma_f32_16x16x32_bf16 v[60:63], a[244:247], v[68:71], v[60:63]
    s_waitcnt lgkmcnt(3)
    s_waitcnt vmcnt(17)
    v_mfma_f32_16x16x32_bf16 v[52:55], a[248:251], v[72:75], v[52:55]
    ds_read_b128 v[92:95], v217 offset:960
    v_mfma_f32_16x16x32_bf16 v[56:59], a[252:255], v[72:75], v[56:59]
    v_mfma_f32_16x16x32_bf16 v[60:63], v[132:135], v[72:75], v[60:63]
    v_mfma_f32_16x16x32_bf16 v[52:55], v[136:139], v[76:79], v[52:55]
    s_waitcnt vmcnt(20) lgkmcnt(4)
    s_barrier
    ds_read_b64 v[100:101], v110 offset:0
    ds_read_b64 v[102:103], v110 offset:128
    ds_read_b64 v[104:105], v110 offset:256
    ds_read_b64 v[106:107], v110 offset:384
    ds_read_b128 v[64:67], v231 offset:8192
    v_mfma_f32_16x16x32_bf16 v[56:59], v[140:143], v[76:79], v[56:59]
    buffer_load_dwordx4 a[20:23], v231, s[36:39], s79 offen offset:1024 sc1
    v_mfma_f32_16x16x32_bf16 v[60:63], v[144:147], v[76:79], v[60:63]
    s_waitcnt lgkmcnt(7)
    s_waitcnt vmcnt(12)
    v_mfma_f32_16x16x32_bf16 v[52:55], v[148:151], v[80:83], v[52:55]
    ds_read_b128 v[68:71], v231 offset:9216
    v_mfma_f32_16x16x32_bf16 v[56:59], v[152:155], v[80:83], v[56:59]
    v_mfma_f32_16x16x32_bf16 v[60:63], v[156:159], v[80:83], v[60:63]
    v_mfma_f32_16x16x32_bf16 v[52:55], v[160:163], v[84:87], v[52:55]
    ds_read_b128 v[72:75], v231 offset:10240
    v_mfma_f32_16x16x32_bf16 v[56:59], v[164:167], v[84:87], v[56:59]
    buffer_load_dwordx4 a[24:27], v231, s[36:39], s79 offen offset:2048 sc1
    v_mfma_f32_16x16x32_bf16 v[60:63], v[168:171], v[84:87], v[60:63]
    s_waitcnt lgkmcnt(7)
    s_waitcnt vmcnt(7)
    v_mfma_f32_16x16x32_bf16 v[52:55], v[172:175], v[88:91], v[52:55]
    ds_read_b128 v[76:79], v231 offset:11264
    v_mfma_f32_16x16x32_bf16 v[56:59], v[176:179], v[88:91], v[56:59]
    v_mfma_f32_16x16x32_bf16 v[60:63], v[180:183], v[88:91], v[60:63]
    v_mfma_f32_16x16x32_bf16 v[52:55], v[184:187], v[92:95], v[52:55]
    ds_read_b128 v[80:83], v231 offset:12288
    v_mfma_f32_16x16x32_bf16 v[56:59], v[188:191], v[92:95], v[56:59]
    buffer_load_dwordx4 a[28:31], v231, s[36:39], s79 offen offset:3072 sc1
    v_mfma_f32_16x16x32_bf16 v[60:63], v[192:195], v[92:95], v[60:63]
    s_waitcnt lgkmcnt(3)
    v_mfma_f32_16x16x32_bf16 v[4:7], a[224:227], v[64:67], v[4:7]
    ds_read_b128 v[84:87], v231 offset:13312
    v_mfma_f32_16x16x32_bf16 v[8:11], a[228:231], v[64:67], v[8:11]
    v_mfma_f32_16x16x32_bf16 v[12:15], a[232:235], v[64:67], v[12:15]
    v_mfma_f32_16x16x32_bf16 v[4:7], a[236:239], v[68:71], v[4:7]
    ds_read_b128 v[88:91], v231 offset:14336
    v_mov_b32_dpp v112, v52 row_newbcast:0 row_mask:0xf bank_mask:0xf bound_ctrl:0
    v_mfma_f32_16x16x32_bf16 v[8:11], a[240:243], v[68:71], v[8:11]
    s_add_u32 s79, s80, 2
    s_lshl_b32 s79, s79, 12
    buffer_load_dwordx4 a[32:35], v231, s[36:39], s79 offen offset:0 sc1
    v_mul_f32_dpp v200, v52, v127 row_newbcast:1 row_mask:0xf bank_mask:0xf bound_ctrl:0
    v_mfma_f32_16x16x32_bf16 v[12:15], a[244:247], v[68:71], v[12:15]
    v_mov_b32_dpp v113, v53 row_newbcast:0 row_mask:0xf bank_mask:0xf bound_ctrl:0
    s_waitcnt lgkmcnt(3)
    v_mfma_f32_16x16x32_bf16 v[4:7], a[248:251], v[72:75], v[4:7]
    ds_read_b128 v[92:95], v231 offset:15360
    v_mul_f32_dpp v201, v53, v127 row_newbcast:1 row_mask:0xf bank_mask:0xf bound_ctrl:0
    v_mfma_f32_16x16x32_bf16 v[8:11], a[252:255], v[72:75], v[8:11]
    v_mov_b32_dpp v114, v54 row_newbcast:0 row_mask:0xf bank_mask:0xf bound_ctrl:0
    v_mul_f32_dpp v202, v54, v127 row_newbcast:1 row_mask:0xf bank_mask:0xf bound_ctrl:0
    v_mfma_f32_16x16x32_bf16 v[12:15], v[132:135], v[72:75], v[12:15]
    v_mov_b32_dpp v115, v55 row_newbcast:0 row_mask:0xf bank_mask:0xf bound_ctrl:0
    v_mul_f32_dpp v203, v55, v127 row_newbcast:1 row_mask:0xf bank_mask:0xf bound_ctrl:0
    v_mfma_f32_16x16x32_bf16 v[4:7], v[136:139], v[76:79], v[4:7]
    ds_read_b128 v[64:67], v231 offset:24576
    v_mov_b32_dpp v116, v56 row_newbcast:0 row_mask:0xf bank_mask:0xf bound_ctrl:0
    v_mfma_f32_16x16x32_bf16 v[8:11], v[140:143], v[76:79], v[8:11]
    buffer_load_dwordx4 a[36:39], v231, s[36:39], s79 offen offset:1024 sc1
    v_mul_f32_dpp v204, v56, v127 row_newbcast:1 row_mask:0xf bank_mask:0xf bound_ctrl:0
    v_mfma_f32_16x16x32_bf16 v[12:15], v[144:147], v[76:79], v[12:15]
    v_mov_b32_dpp v117, v57 row_newbcast:0 row_mask:0xf bank_mask:0xf bound_ctrl:0
    s_waitcnt lgkmcnt(3)
    v_mfma_f32_16x16x32_bf16 v[4:7], v[148:151], v[80:83], v[4:7]
    ds_read_b128 v[68:71], v231 offset:25600
    v_mul_f32_dpp v205, v57, v127 row_newbcast:1 row_mask:0xf bank_mask:0xf bound_ctrl:0
    v_mfma_f32_16x16x32_bf16 v[8:11], v[152:155], v[80:83], v[8:11]
    v_mov_b32_dpp v118, v58 row_newbcast:0 row_mask:0xf bank_mask:0xf bound_ctrl:0
    v_mul_f32_dpp v206, v58, v127 row_newbcast:1 row_mask:0xf bank_mask:0xf bound_ctrl:0
    v_mfma_f32_16x16x32_bf16 v[12:15], v[156:159], v[80:83], v[12:15]
    v_mov_b32_dpp v119, v59 row_newbcast:0 row_mask:0xf bank_mask:0xf bound_ctrl:0
    v_mul_f32_dpp v207, v59, v127 row_newbcast:1 row_mask:0xf bank_mask:0xf bound_ctrl:0
    v_mfma_f32_16x16x32_bf16 v[4:7], v[160:163], v[84:87], v[4:7]
    ds_read_b128 v[72:75], v231 offset:26624
    v_mov_b32_dpp v120, v60 row_newbcast:0 row_mask:0xf bank_mask:0xf bound_ctrl:0
    v_mfma_f32_16x16x32_bf16 v[8:11], v[164:167], v[84:87], v[8:11]
    buffer_load_dwordx4 a[40:43], v231, s[36:39], s79 offen offset:2048 sc1
    v_mul_f32_dpp v208, v60, v127 row_newbcast:1 row_mask:0xf bank_mask:0xf bound_ctrl:0
    v_mfma_f32_16x16x32_bf16 v[12:15], v[168:171], v[84:87], v[12:15]
    v_mov_b32_dpp v121, v61 row_newbcast:0 row_mask:0xf bank_mask:0xf bound_ctrl:0
    s_waitcnt lgkmcnt(3)
    v_mfma_f32_16x16x32_bf16 v[4:7], v[172:175], v[88:91], v[4:7]
    ds_read_b128 v[76:79], v231 offset:27648
    v_mul_f32_dpp v209, v61, v127 row_newbcast:1 row_mask:0xf bank_mask:0xf bound_ctrl:0
    v_mfma_f32_16x16x32_bf16 v[8:11], v[176:179], v[88:91], v[8:11]
    v_mov_b32_dpp v122, v62 row_newbcast:0 row_mask:0xf bank_mask:0xf bound_ctrl:0
    v_mul_f32_dpp v210, v62, v127 row_newbcast:1 row_mask:0xf bank_mask:0xf bound_ctrl:0
    v_mfma_f32_16x16x32_bf16 v[12:15], v[180:183], v[88:91], v[12:15]
    v_mov_b32_dpp v123, v63 row_newbcast:0 row_mask:0xf bank_mask:0xf bound_ctrl:0
    v_mul_f32_dpp v211, v63, v127 row_newbcast:1 row_mask:0xf bank_mask:0xf bound_ctrl:0
    v_mfma_f32_16x16x32_bf16 v[4:7], v[184:187], v[92:95], v[4:7]
    ds_read_b128 v[80:83], v231 offset:28672
    v_mfma_f32_16x16x32_bf16 v[8:11], v[188:191], v[92:95], v[8:11]
    buffer_load_dwordx4 a[44:47], v231, s[36:39], s79 offen offset:3072 sc1
    v_mfma_f32_16x16x32_bf16 v[12:15], v[192:195], v[92:95], v[12:15]
    s_waitcnt lgkmcnt(3)
    v_mfma_f32_16x16x32_bf16 v[16:19], a[224:227], v[64:67], v[16:19]
    ds_read_b128 v[84:87], v231 offset:29696
    v_mfma_f32_16x16x32_bf16 v[20:23], a[228:231], v[64:67], v[20:23]
    v_mfma_f32_16x16x32_bf16 v[24:27], a[232:235], v[64:67], v[24:27]
    v_fmac_f32 v4, v100, v112
    v_fmac_f32 v5, v100, v113
    v_fmac_f32 v6, v100, v114
    v_fmac_f32 v7, v100, v115
    v_fmac_f32 v8, v100, v116
    v_mfma_f32_16x16x32_bf16 v[16:19], a[236:239], v[68:71], v[16:19]
    ds_read_b128 v[88:91], v231 offset:30720
    v_fmac_f32 v9, v100, v117
    v_fmac_f32 v10, v100, v118
    v_fmac_f32 v11, v100, v119
    v_fmac_f32 v12, v100, v120
    v_fmac_f32 v13, v100, v121
    v_mfma_f32_16x16x32_bf16 v[20:23], a[240:243], v[68:71], v[20:23]
    s_add_u32 s79, s80, 3
    s_lshl_b32 s79, s79, 12
    buffer_load_dwordx4 a[48:51], v231, s[36:39], s79 offen offset:0 sc1
    v_fmac_f32 v14, v100, v122
    v_fmac_f32 v15, v100, v123
    v_fma_f32 v4, v101, v4, v200
    v_fma_f32 v5, v101, v5, v201
    v_mfma_f32_16x16x32_bf16 v[24:27], a[244:247], v[68:71], v[24:27]
    v_fma_f32 v6, v101, v6, v202
    v_fma_f32 v7, v101, v7, v203
    v_fma_f32 v8, v101, v8, v204
    v_fma_f32 v9, v101, v9, v205
    v_fma_f32 v10, v101, v10, v206
    s_waitcnt lgkmcnt(3)
    v_mfma_f32_16x16x32_bf16 v[16:19], a[248:251], v[72:75], v[16:19]
    ds_read_b128 v[92:95], v231 offset:31744
    v_fma_f32 v11, v101, v11, v207
    v_fma_f32 v12, v101, v12, v208
    v_fma_f32 v13, v101, v13, v209
    v_fma_f32 v14, v101, v14, v210
    v_fma_f32 v15, v101, v15, v211
    v_mfma_f32_16x16x32_bf16 v[20:23], a[252:255], v[72:75], v[20:23]
    buffer_load_dwordx4 a[52:55], v231, s[36:39], s79 offen offset:1024 sc1
    v_exp_f32 v232, v4
    v_exp_f32 v233, v5
    v_mfma_f32_16x16x32_bf16 v[24:27], v[132:135], v[72:75], v[24:27]
    v_exp_f32 v234, v6
    v_exp_f32 v235, v7
    v_exp_f32 v236, v8
    v_mfma_f32_16x16x32_bf16 v[16:19], v[136:139], v[76:79], v[16:19]
    ds_read_b128 v[64:67], v231 offset:40960
    v_exp_f32 v237, v9
    v_exp_f32 v238, v10
    v_mfma_f32_16x16x32_bf16 v[20:23], v[140:143], v[76:79], v[20:23]
    v_exp_f32 v239, v11
    v_exp_f32 v240, v12
    v_mfma_f32_16x16x32_bf16 v[24:27], v[144:147], v[76:79], v[24:27]
    v_exp_f32 v241, v13
    v_exp_f32 v242, v14
    v_exp_f32 v243, v15
    s_waitcnt lgkmcnt(3)
    v_mfma_f32_16x16x32_bf16 v[16:19], v[148:151], v[80:83], v[16:19]
    ds_read_b128 v[68:71], v231 offset:41984
    v_add_f32 v232, 1.0, v232
    v_add_f32 v233, 1.0, v233
    v_add_f32 v234, 1.0, v234
    v_mfma_f32_16x16x32_bf16 v[20:23], v[152:155], v[80:83], v[20:23]
    buffer_load_dwordx4 a[56:59], v231, s[36:39], s79 offen offset:2048 sc1
    v_add_f32 v235, 1.0, v235
    v_add_f32 v236, 1.0, v236
    v_add_f32 v237, 1.0, v237
    v_add_f32 v238, 1.0, v238
    v_add_f32 v239, 1.0, v239
    v_mfma_f32_16x16x32_bf16 v[24:27], v[156:159], v[80:83], v[24:27]
    v_add_f32 v240, 1.0, v240
    v_add_f32 v241, 1.0, v241
    v_add_f32 v242, 1.0, v242
    v_add_f32 v243, 1.0, v243
    v_rcp_f32 v232, v232
    v_mfma_f32_16x16x32_bf16 v[16:19], v[160:163], v[84:87], v[16:19]
    ds_read_b128 v[72:75], v231 offset:43008
    v_rcp_f32 v233, v233
    v_rcp_f32 v234, v234
    v_mfma_f32_16x16x32_bf16 v[20:23], v[164:167], v[84:87], v[20:23]
    v_rcp_f32 v235, v235
    v_rcp_f32 v236, v236
    v_mfma_f32_16x16x32_bf16 v[24:27], v[168:171], v[84:87], v[24:27]
    v_rcp_f32 v237, v237
    v_rcp_f32 v238, v238
    v_rcp_f32 v239, v239
    s_waitcnt lgkmcnt(3)
    v_mfma_f32_16x16x32_bf16 v[16:19], v[172:175], v[88:91], v[16:19]
    ds_read_b128 v[76:79], v231 offset:44032
    v_rcp_f32 v240, v240
    v_rcp_f32 v241, v241
    v_mfma_f32_16x16x32_bf16 v[20:23], v[176:179], v[88:91], v[20:23]
    buffer_load_dwordx4 a[60:63], v231, s[36:39], s79 offen offset:3072 sc1
    v_rcp_f32 v242, v242
    v_rcp_f32 v243, v243
    v_mfma_f32_16x16x32_bf16 v[24:27], v[180:183], v[88:91], v[24:27]
    v_mul_f32 v4, v4, v232
    v_mul_f32 v5, v5, v233
    v_mul_f32 v6, v6, v234
    v_mul_f32 v7, v7, v235
    v_mul_f32 v8, v8, v236
    v_mfma_f32_16x16x32_bf16 v[16:19], v[184:187], v[92:95], v[16:19]
    ds_read_b128 v[80:83], v231 offset:45056
    v_mul_f32 v9, v9, v237
    v_mul_f32 v10, v10, v238
    v_mul_f32 v11, v11, v239
    v_mul_f32 v12, v12, v240
    v_mfma_f32_16x16x32_bf16 v[20:23], v[188:191], v[92:95], v[20:23]
    v_mul_f32 v13, v13, v241
    v_mul_f32 v14, v14, v242
    v_mul_f32 v15, v15, v243
    v_cvt_pk_bf16_f32 v4, v4, v5
    v_cvt_pk_bf16_f32 v5, v6, v7
    v_mfma_f32_16x16x32_bf16 v[24:27], v[192:195], v[92:95], v[24:27]
    v_cvt_pk_bf16_f32 v8, v8, v9
    v_cvt_pk_bf16_f32 v9, v10, v11
    v_cvt_pk_bf16_f32 v12, v12, v13
    v_cvt_pk_bf16_f32 v13, v14, v15
    ds_write_b64 v124, v[4:5] offset:0
    ds_write_b64 v125, v[8:9] offset:0
    ds_write_b64 v126, v[12:13] offset:0
    s_waitcnt lgkmcnt(6)
    v_mfma_f32_16x16x32_bf16 v[28:31], a[224:227], v[64:67], v[28:31]
    ds_read_b128 v[84:87], v231 offset:46080
    v_mfma_f32_16x16x32_bf16 v[32:35], a[228:231], v[64:67], v[32:35]
    s_add_u32 s79, s80, 4
    s_lshl_b32 s79, s79, 12
    buffer_load_dwordx4 a[64:67], v231, s[36:39], s79 offen offset:0 sc1
    v_mfma_f32_16x16x32_bf16 v[36:39], a[232:235], v[64:67], v[36:39]
    s_waitcnt lgkmcnt(1)
    s_barrier
    v_fmac_f32 v16, v102, v112
    v_fmac_f32 v17, v102, v113
    v_fmac_f32 v18, v102, v114
    v_fmac_f32 v19, v102, v115
    v_fmac_f32 v20, v102, v116
    v_mfma_f32_16x16x32_bf16 v[28:31], a[236:239], v[68:71], v[28:31]
    ds_read_b128 v[88:91], v231 offset:47104
    v_fmac_f32 v21, v102, v117
    v_fmac_f32 v22, v102, v118
    v_fmac_f32 v23, v102, v119
    v_fmac_f32 v24, v102, v120
    v_fmac_f32 v25, v102, v121
    v_mfma_f32_16x16x32_bf16 v[32:35], a[240:243], v[68:71], v[32:35]
    v_fmac_f32 v26, v102, v122
    v_fmac_f32 v27, v102, v123
    v_fma_f32 v16, v103, v16, v200
    v_fma_f32 v17, v103, v17, v201
    v_mfma_f32_16x16x32_bf16 v[36:39], a[244:247], v[68:71], v[36:39]
    ds_read_b128 v[212:215], v111 offset:0
    v_fma_f32 v18, v103, v18, v202
    v_fma_f32 v19, v103, v19, v203
    v_fma_f32 v20, v103, v20, v204
    v_fma_f32 v21, v103, v21, v205
    v_fma_f32 v22, v103, v22, v206
    v_mfma_f32_16x16x32_bf16 v[28:31], a[248:251], v[72:75], v[28:31]
    ds_read_b128 v[92:95], v231 offset:48128
    v_fma_f32 v23, v103, v23, v207
    v_fma_f32 v24, v103, v24, v208
    v_fma_f32 v25, v103, v25, v209
    v_fma_f32 v26, v103, v26, v210
    v_fma_f32 v27, v103, v27, v211
    v_mfma_f32_16x16x32_bf16 v[32:35], a[252:255], v[72:75], v[32:35]
    buffer_load_dwordx4 a[68:71], v231, s[36:39], s79 offen offset:1024 sc1
    v_exp_f32 v232, v16
    v_exp_f32 v233, v17
    v_mfma_f32_16x16x32_bf16 v[36:39], v[132:135], v[72:75], v[36:39]
    ds_read_b128 v[244:247], v111 offset:16384
    v_exp_f32 v234, v18
    v_exp_f32 v235, v19
    v_exp_f32 v236, v20
    v_mfma_f32_16x16x32_bf16 v[28:31], v[136:139], v[76:79], v[28:31]
    ds_read_b128 v[64:67], v231 offset:57344
    v_exp_f32 v237, v21
    v_exp_f32 v238, v22
    v_mfma_f32_16x16x32_bf16 v[32:35], v[140:143], v[76:79], v[32:35]
    v_exp_f32 v239, v23
    v_exp_f32 v240, v24
    v_mfma_f32_16x16x32_bf16 v[36:39], v[144:147], v[76:79], v[36:39]
    v_exp_f32 v241, v25
    v_exp_f32 v242, v26
    v_exp_f32 v243, v27
    s_waitcnt lgkmcnt(5)
    v_mfma_f32_16x16x32_bf16 v[28:31], v[148:151], v[80:83], v[28:31]
    ds_read_b128 v[68:71], v231 offset:58368
    v_add_f32 v232, 1.0, v232
    v_add_f32 v233, 1.0, v233
    v_add_f32 v234, 1.0, v234
    v_mfma_f32_16x16x32_bf16 v[32:35], v[152:155], v[80:83], v[32:35]
    buffer_load_dwordx4 a[72:75], v231, s[36:39], s79 offen offset:2048 sc1
    v_add_f32 v235, 1.0, v235
    v_add_f32 v236, 1.0, v236
    v_add_f32 v237, 1.0, v237
    v_add_f32 v238, 1.0, v238
    v_add_f32 v239, 1.0, v239
    v_mfma_f32_16x16x32_bf16 v[36:39], v[156:159], v[80:83], v[36:39]
    s_waitcnt lgkmcnt(2)
    s_add_u32 s67, s69, 0
    buffer_store_dwordx4 v[212:215], v231, s[4:7], s67 offen sc1
    v_add_f32 v240, 1.0, v240
    v_add_f32 v241, 1.0, v241
    v_add_f32 v242, 1.0, v242
    v_add_f32 v243, 1.0, v243
    v_rcp_f32 v232, v232
    v_mfma_f32_16x16x32_bf16 v[28:31], v[160:163], v[84:87], v[28:31]
    ds_read_b128 v[72:75], v231 offset:59392
    v_rcp_f32 v233, v233
    v_rcp_f32 v234, v234
    v_mfma_f32_16x16x32_bf16 v[32:35], v[164:167], v[84:87], v[32:35]
    v_rcp_f32 v235, v235
    v_rcp_f32 v236, v236
    v_mfma_f32_16x16x32_bf16 v[36:39], v[168:171], v[84:87], v[36:39]
    v_rcp_f32 v237, v237
    v_rcp_f32 v238, v238
    v_rcp_f32 v239, v239
    v_mfma_f32_16x16x32_bf16 v[28:31], v[172:175], v[88:91], v[28:31]
    ds_read_b128 v[76:79], v231 offset:60416
    v_rcp_f32 v240, v240
    v_rcp_f32 v241, v241
    v_mfma_f32_16x16x32_bf16 v[32:35], v[176:179], v[88:91], v[32:35]
    buffer_load_dwordx4 a[76:79], v231, s[36:39], s79 offen offset:3072 sc1
    v_rcp_f32 v242, v242
    v_rcp_f32 v243, v243
    v_mfma_f32_16x16x32_bf16 v[36:39], v[180:183], v[88:91], v[36:39]
    s_add_u32 s67, s70, 0
    buffer_store_dwordx4 v[244:247], v231, s[4:7], s67 offen sc1
    v_mul_f32 v16, v16, v232
    v_mul_f32 v17, v17, v233
    v_mul_f32 v18, v18, v234
    v_mul_f32 v19, v19, v235
    v_mul_f32 v20, v20, v236
    v_mfma_f32_16x16x32_bf16 v[28:31], v[184:187], v[92:95], v[28:31]
    ds_read_b128 v[80:83], v231 offset:61440
    v_mul_f32 v21, v21, v237
    v_mul_f32 v22, v22, v238
    v_mul_f32 v23, v23, v239
    v_mul_f32 v24, v24, v240
    v_mfma_f32_16x16x32_bf16 v[32:35], v[188:191], v[92:95], v[32:35]
    v_mul_f32 v25, v25, v241
    v_mul_f32 v26, v26, v242
    v_mul_f32 v27, v27, v243
    v_cvt_pk_bf16_f32 v16, v16, v17
    v_cvt_pk_bf16_f32 v17, v18, v19
    v_mfma_f32_16x16x32_bf16 v[36:39], v[192:195], v[92:95], v[36:39]
    v_cvt_pk_bf16_f32 v20, v20, v21
    v_cvt_pk_bf16_f32 v21, v22, v23
    v_cvt_pk_bf16_f32 v24, v24, v25
    v_cvt_pk_bf16_f32 v25, v26, v27
    ds_write_b64 v124, v[16:17] offset:1024
    ds_write_b64 v125, v[20:21] offset:1024
    ds_write_b64 v126, v[24:25] offset:1024
    s_waitcnt lgkmcnt(6)
    v_mfma_f32_16x16x32_bf16 v[40:43], a[224:227], v[64:67], v[40:43]
    ds_read_b128 v[84:87], v231 offset:62464
    v_mfma_f32_16x16x32_bf16 v[44:47], a[228:231], v[64:67], v[44:47]
    s_add_u32 s79, s80, 5
    s_lshl_b32 s79, s79, 12
    buffer_load_dwordx4 a[80:83], v231, s[36:39], s79 offen offset:0 sc1
    v_mfma_f32_16x16x32_bf16 v[48:51], a[232:235], v[64:67], v[48:51]
    s_waitcnt lgkmcnt(1)
    s_barrier
    v_fmac_f32 v28, v104, v112
    v_fmac_f32 v29, v104, v113
    v_fmac_f32 v30, v104, v114
    v_fmac_f32 v31, v104, v115
    v_fmac_f32 v32, v104, v116
    v_mfma_f32_16x16x32_bf16 v[40:43], a[236:239], v[68:71], v[40:43]
    ds_read_b128 v[88:91], v231 offset:63488
    v_fmac_f32 v33, v104, v117
    v_fmac_f32 v34, v104, v118
    v_fmac_f32 v35, v104, v119
    v_fmac_f32 v36, v104, v120
    v_fmac_f32 v37, v104, v121
    v_mfma_f32_16x16x32_bf16 v[44:47], a[240:243], v[68:71], v[44:47]
    v_fmac_f32 v38, v104, v122
    v_fmac_f32 v39, v104, v123
    v_fma_f32 v28, v105, v28, v200
    v_fma_f32 v29, v105, v29, v201
    v_mfma_f32_16x16x32_bf16 v[48:51], a[244:247], v[68:71], v[48:51]
    ds_read_b128 v[212:215], v111 offset:1024
    v_fma_f32 v30, v105, v30, v202
    v_fma_f32 v31, v105, v31, v203
    v_fma_f32 v32, v105, v32, v204
    v_fma_f32 v33, v105, v33, v205
    v_fma_f32 v34, v105, v34, v206
    v_mfma_f32_16x16x32_bf16 v[40:43], a[248:251], v[72:75], v[40:43]
    ds_read_b128 v[92:95], v231 offset:64512
    v_fma_f32 v35, v105, v35, v207
    v_fma_f32 v36, v105, v36, v208
    v_fma_f32 v37, v105, v37, v209
    v_fma_f32 v38, v105, v38, v210
    v_fma_f32 v39, v105, v39, v211
    v_mfma_f32_16x16x32_bf16 v[44:47], a[252:255], v[72:75], v[44:47]
    buffer_load_dwordx4 a[84:87], v231, s[36:39], s79 offen offset:1024 sc1
    v_exp_f32 v232, v28
    v_exp_f32 v233, v29
    v_mfma_f32_16x16x32_bf16 v[48:51], v[132:135], v[72:75], v[48:51]
    ds_read_b128 v[244:247], v111 offset:17408
    v_exp_f32 v234, v30
    v_exp_f32 v235, v31
    v_exp_f32 v236, v32
    v_mfma_f32_16x16x32_bf16 v[40:43], v[136:139], v[76:79], v[40:43]
    v_exp_f32 v237, v33
    v_exp_f32 v238, v34
    v_mfma_f32_16x16x32_bf16 v[44:47], v[140:143], v[76:79], v[44:47]
    v_exp_f32 v239, v35
    v_exp_f32 v240, v36
    v_mfma_f32_16x16x32_bf16 v[48:51], v[144:147], v[76:79], v[48:51]
    v_exp_f32 v241, v37
    v_exp_f32 v242, v38
    v_exp_f32 v243, v39
    s_waitcnt lgkmcnt(4)
    v_mfma_f32_16x16x32_bf16 v[40:43], v[148:151], v[80:83], v[40:43]
    v_add_f32 v232, 1.0, v232
    v_add_f32 v233, 1.0, v233
    v_add_f32 v234, 1.0, v234
    v_mfma_f32_16x16x32_bf16 v[44:47], v[152:155], v[80:83], v[44:47]
    buffer_load_dwordx4 a[88:91], v231, s[36:39], s79 offen offset:2048 sc1
    v_add_f32 v235, 1.0, v235
    v_add_f32 v236, 1.0, v236
    v_add_f32 v237, 1.0, v237
    v_add_f32 v238, 1.0, v238
    v_add_f32 v239, 1.0, v239
    v_mfma_f32_16x16x32_bf16 v[48:51], v[156:159], v[80:83], v[48:51]
    s_waitcnt lgkmcnt(0)
    s_add_u32 s67, s69, 44032
    buffer_store_dwordx4 v[212:215], v231, s[4:7], s67 offen sc1
    v_add_f32 v240, 1.0, v240
    v_add_f32 v241, 1.0, v241
    v_add_f32 v242, 1.0, v242
    v_add_f32 v243, 1.0, v243
    v_rcp_f32 v232, v232
    v_mfma_f32_16x16x32_bf16 v[40:43], v[160:163], v[84:87], v[40:43]
    v_rcp_f32 v233, v233
    v_rcp_f32 v234, v234
    v_mfma_f32_16x16x32_bf16 v[44:47], v[164:167], v[84:87], v[44:47]
    v_rcp_f32 v235, v235
    v_rcp_f32 v236, v236
    v_mfma_f32_16x16x32_bf16 v[48:51], v[168:171], v[84:87], v[48:51]
    v_rcp_f32 v237, v237
    v_rcp_f32 v238, v238
    v_rcp_f32 v239, v239
    v_mfma_f32_16x16x32_bf16 v[40:43], v[172:175], v[88:91], v[40:43]
    v_rcp_f32 v240, v240
    v_rcp_f32 v241, v241
    v_mfma_f32_16x16x32_bf16 v[44:47], v[176:179], v[88:91], v[44:47]
    buffer_load_dwordx4 a[92:95], v231, s[36:39], s79 offen offset:3072 sc1
    v_rcp_f32 v242, v242
    v_rcp_f32 v243, v243
    v_mfma_f32_16x16x32_bf16 v[48:51], v[180:183], v[88:91], v[48:51]
    s_add_u32 s67, s70, 44032
    buffer_store_dwordx4 v[244:247], v231, s[4:7], s67 offen sc1
    v_mul_f32 v28, v28, v232
    v_mul_f32 v29, v29, v233
    v_mul_f32 v30, v30, v234
    v_mul_f32 v31, v31, v235
    v_mul_f32 v32, v32, v236
    v_mfma_f32_16x16x32_bf16 v[40:43], v[184:187], v[92:95], v[40:43]
    v_mul_f32 v33, v33, v237
    v_mul_f32 v34, v34, v238
    v_mul_f32 v35, v35, v239
    v_mul_f32 v36, v36, v240
    v_mfma_f32_16x16x32_bf16 v[44:47], v[188:191], v[92:95], v[44:47]
    v_mul_f32 v37, v37, v241
    v_mul_f32 v38, v38, v242
    v_mul_f32 v39, v39, v243
    v_cvt_pk_bf16_f32 v28, v28, v29
    v_cvt_pk_bf16_f32 v29, v30, v31
    v_mfma_f32_16x16x32_bf16 v[48:51], v[192:195], v[92:95], v[48:51]
    v_cvt_pk_bf16_f32 v32, v32, v33
    v_cvt_pk_bf16_f32 v33, v34, v35
    v_cvt_pk_bf16_f32 v36, v36, v37
    v_cvt_pk_bf16_f32 v37, v38, v39
    ds_write_b64 v124, v[28:29] offset:2048
    ds_write_b64 v125, v[32:33] offset:2048
    ds_write_b64 v126, v[36:37] offset:2048
    s_waitcnt lgkmcnt(0)
    s_barrier
    ds_read_b128 v[212:215], v111 offset:2048
    ds_read_b128 v[244:247], v111 offset:18432
    v_pk_fma_f32 v[40:41], v[106:107], v[112:113], v[40:41] op_sel_hi:[0,1,1]
    v_pk_fma_f32 v[42:43], v[106:107], v[114:115], v[42:43] op_sel_hi:[0,1,1]
    v_pk_fma_f32 v[44:45], v[106:107], v[116:117], v[44:45] op_sel_hi:[0,1,1]
    v_pk_fma_f32 v[46:47], v[106:107], v[118:119], v[46:47] op_sel_hi:[0,1,1]
    v_pk_fma_f32 v[48:49], v[106:107], v[120:121], v[48:49] op_sel_hi:[0,1,1]
    v_pk_fma_f32 v[50:51], v[106:107], v[122:123], v[50:51] op_sel_hi:[0,1,1]
    v_pk_fma_f32 v[40:41], v[106:107], v[40:41], v[200:201] op_sel:[1,0,0] op_sel_hi:[1,1,1]
    v_pk_fma_f32 v[42:43], v[106:107], v[42:43], v[202:203] op_sel:[1,0,0] op_sel_hi:[1,1,1]
    v_pk_fma_f32 v[44:45], v[106:107], v[44:45], v[204:205] op_sel:[1,0,0] op_sel_hi:[1,1,1]
    v_pk_fma_f32 v[46:47], v[106:107], v[46:47], v[206:207] op_sel:[1,0,0] op_sel_hi:[1,1,1]
    v_pk_fma_f32 v[48:49], v[106:107], v[48:49], v[208:209] op_sel:[1,0,0] op_sel_hi:[1,1,1]
    v_pk_fma_f32 v[50:51], v[106:107], v[50:51], v[210:211] op_sel:[1,0,0] op_sel_hi:[1,1,1]
    v_exp_f32 v232, v40
    v_exp_f32 v233, v41
    v_exp_f32 v234, v42
    v_exp_f32 v235, v43
    v_exp_f32 v236, v44
    v_exp_f32 v237, v45
    v_exp_f32 v238, v46
    v_exp_f32 v239, v47
    v_exp_f32 v240, v48
    v_exp_f32 v241, v49
    v_exp_f32 v242, v50
    v_exp_f32 v243, v51
    s_waitcnt lgkmcnt(0)
    s_add_u32 s67, s69, 88064
    buffer_store_dwordx4 v[212:215], v231, s[4:7], s67 offen sc1
    s_add_u32 s67, s70, 88064
    buffer_store_dwordx4 v[244:247], v231, s[4:7], s67 offen sc1
    v_pk_add_f32 v[232:233], v[232:233], 1.0 op_sel_hi:[1,0]
    v_pk_add_f32 v[234:235], v[234:235], 1.0 op_sel_hi:[1,0]
    v_pk_add_f32 v[236:237], v[236:237], 1.0 op_sel_hi:[1,0]
    v_pk_add_f32 v[238:239], v[238:239], 1.0 op_sel_hi:[1,0]
    v_pk_add_f32 v[240:241], v[240:241], 1.0 op_sel_hi:[1,0]
    v_pk_add_f32 v[242:243], v[242:243], 1.0 op_sel_hi:[1,0]
    v_rcp_f32 v232, v232
    v_rcp_f32 v233, v233
    v_rcp_f32 v234, v234
    v_rcp_f32 v235, v235
    v_rcp_f32 v236, v236
    v_rcp_f32 v237, v237
    v_rcp_f32 v238, v238
    v_rcp_f32 v239, v239
    v_rcp_f32 v240, v240
    v_rcp_f32 v241, v241
    v_rcp_f32 v242, v242
    v_rcp_f32 v243, v243
    v_pk_mul_f32 v[40:41], v[40:41], v[232:233]
    v_pk_mul_f32 v[42:43], v[42:43], v[234:235]
    v_pk_mul_f32 v[44:45], v[44:45], v[236:237]
    v_pk_mul_f32 v[46:47], v[46:47], v[238:239]
    v_pk_mul_f32 v[48:49], v[48:49], v[240:241]
    v_pk_mul_f32 v[50:51], v[50:51], v[242:243]
    v_cvt_pk_bf16_f32 v40, v40, v41
    v_cvt_pk_bf16_f32 v41, v42, v43
    v_cvt_pk_bf16_f32 v44, v44, v45
    v_cvt_pk_bf16_f32 v45, v46, v47
    v_cvt_pk_bf16_f32 v48, v48, v49
    v_cvt_pk_bf16_f32 v49, v50, v51
    ds_write_b64 v124, v[40:41] offset:3072
    ds_write_b64 v125, v[44:45] offset:3072
    ds_write_b64 v126, v[48:49] offset:3072
    s_waitcnt lgkmcnt(0)
    s_barrier
    ds_read_b128 v[212:215], v111 offset:3072
    ds_read_b128 v[244:247], v111 offset:19456
    s_waitcnt lgkmcnt(1)
    s_add_u32 s67, s69, 132096
    buffer_store_dwordx4 v[212:215], v231, s[4:7], s67 offen sc1
    s_waitcnt lgkmcnt(0)
    s_add_u32 s67, s70, 132096
    buffer_store_dwordx4 v[244:247], v231, s[4:7], s67 offen sc1
    s_add_u32 s79, s80, 6
    s_lshl_b32 s79, s79, 12
    buffer_load_dwordx4 a[96:99], v231, s[36:39], s79 offen offset:0 sc1
    buffer_load_dwordx4 a[100:103], v231, s[36:39], s79 offen offset:1024 sc1
    buffer_load_dwordx4 a[104:107], v231, s[36:39], s79 offen offset:2048 sc1
    buffer_load_dwordx4 a[108:111], v231, s[36:39], s79 offen offset:3072 sc1
    s_add_u32 s79, s80, 7
    s_lshl_b32 s79, s79, 12
    buffer_load_dwordx4 a[112:115], v231, s[36:39], s79 offen offset:0 sc1
    buffer_load_dwordx4 a[116:119], v231, s[36:39], s79 offen offset:1024 sc1
    buffer_load_dwordx4 a[120:123], v231, s[36:39], s79 offen offset:2048 sc1
    buffer_load_dwordx4 a[124:127], v231, s[36:39], s79 offen offset:3072 sc1
    ds_read_b128 v[232:235], v216 offset:6144
    ds_read_b128 v[236:239], v216 offset:6208
    ds_read_b128 v[240:243], v216 offset:6272
    ds_read_b128 v[244:247], v216 offset:6336
    v_lshlrev_b32 v180, 16, v248
    v_and_b32 v181, 0xffff0000, v248
    v_lshlrev_b32 v182, 16, v249
    v_and_b32 v183, 0xffff0000, v249
    v_lshlrev_b32 v184, 16, v250
    v_and_b32 v185, 0xffff0000, v250
    v_lshlrev_b32 v186, 16, v251
    v_and_b32 v187, 0xffff0000, v251
    v_lshlrev_b32 v188, 16, v252
    v_and_b32 v189, 0xffff0000, v252
    v_lshlrev_b32 v190, 16, v253
    v_and_b32 v191, 0xffff0000, v253
    v_lshlrev_b32 v192, 16, v254
    v_and_b32 v193, 0xffff0000, v254
    v_lshlrev_b32 v194, 16, v255
    v_and_b32 v195, 0xffff0000, v255
    v_bfe_u32 v220, v218, 4, 1
    v_mul_u32_u24 v220, 24, v220
    v_add_u32 v225, v220, v196
    s_waitcnt lgkmcnt(0)
    s_lshl_b32 s67, s80, 10
    s_add_u32 s68, s64, 1
    s_and_b32 s68, s68, 3
    s_mul_i32 s69, s68, 44032
    s_add_u32 s69, s69, s67
    s_add_u32 s68, s64, 2
    s_and_b32 s68, s68, 3
    s_mul_i32 s70, s68, 44032
    s_add_u32 s70, s70, s67
    s_add_u32 s68, s64, 3
    s_and_b32 s68, s68, 3
    s_mul_i32 s75, s68, 44032
    s_add_u32 s75, s75, s67
    s_add_u32 s68, s64, 4
    s_and_b32 s68, s68, 3
    s_mul_i32 s76, s68, 44032
    s_add_u32 s76, s76, s67
    s_lshl_b32 s67, s77, 10
    s_lshl_b32 s68, s78, 7
    s_add_u32 s67, s67, s68
    s_add_u32 s67, s67, 196608
    v_mul_f32 v232, 0xbf317218, v232
    v_mul_f32 v233, 0xbf317218, v233
    v_mul_f32 v234, 0xbf317218, v234
    v_mul_f32 v235, 0xbf317218, v235
    v_mul_f32 v236, 0xbf317218, v236
    v_mul_f32 v237, 0xbf317218, v237
    v_mul_f32 v238, 0xbf317218, v238
    v_mul_f32 v239, 0xbf317218, v239
    v_mul_f32 v240, 0xbf317218, v240
    v_mul_f32 v241, 0xbf317218, v241
    v_mul_f32 v242, 0xbf317218, v242
    v_mul_f32 v243, 0xbf317218, v243
    v_mul_f32 v244, 0xbf317218, v244
    v_mul_f32 v245, 0xbf317218, v245
    v_mul_f32 v246, 0xbf317218, v246
    v_mul_f32 v247, 0xbf317218, v247
    s_waitcnt vmcnt(8)
    s_barrier
    buffer_store_dword v197, v198, s[40:43], s67 offen sc1
    s_lshl_b32 s68, s77, 10
    s_add_u32 s68, s68, 196608
    s_cmp_eq_u32 s64, 1
    s_cselect_b32 s68, s68, 0x100000
    v_and_b32 v199, 7, v218
    v_lshlrev_b32 v199, 7, v199
    v_add_u32 v199, s68, v199
    s_add_u32 s79, s80, 8
    s_lshl_b32 s79, s79, 12
    buffer_load_dwordx4 a[128:131], v231, s[36:39], s79 offen offset:0 sc1
    buffer_load_dwordx4 a[132:135], v231, s[36:39], s79 offen offset:1024 sc1
    buffer_load_dwordx4 a[136:139], v231, s[36:39], s79 offen offset:2048 sc1
    buffer_load_dwordx4 a[140:143], v231, s[36:39], s79 offen offset:3072 sc1
    s_add_u32 s79, s80, 9
    s_lshl_b32 s79, s79, 12
    buffer_load_dwordx4 a[144:147], v231, s[36:39], s79 offen offset:0 sc1
    buffer_load_dwordx4 a[148:151], v231, s[36:39], s79 offen offset:1024 sc1
    buffer_load_dwordx4 a[152:155], v231, s[36:39], s79 offen offset:2048 sc1
    buffer_load_dwordx4 a[156:159], v231, s[36:39], s79 offen offset:3072 sc1
    buffer_load_dword v230, v199, s[40:43], 0 offen sc1
    s_add_u32 s79, s80, 10
    s_lshl_b32 s79, s79, 12
    buffer_load_dwordx4 a[160:163], v231, s[36:39], s79 offen offset:0 sc1
    buffer_load_dwordx4 a[164:167], v231, s[36:39], s79 offen offset:1024 sc1
    buffer_load_dwordx4 a[168:171], v231, s[36:39], s79 offen offset:2048 sc1
    buffer_load_dwordx4 a[172:175], v231, s[36:39], s79 offen offset:3072 sc1
    s_cmp_lg_u32 s64, 1
    s_cbranch_scc1 L_h3_ok
    buffer_load_dword v1, v199, s[40:43], 0 offen sc1
    s_waitcnt vmcnt(5)
    v_xor_b32 v230, s82, v230
    v_cmp_ne_u32 vcc, 0, v230
    s_nop 0
    s_and_b32 s67, vcc_lo, 0xff
    s_cmp_eq_u32 s67, 0
    s_cbranch_scc1 L_h3_ok
    s_waitcnt vmcnt(0)
    s_mov_b32 s72, 0
    s_branch L_h3_chk
L_h3_spin:
    buffer_load_dword v1, v199, s[40:43], 0 offen offset:0 sc1
    s_waitcnt vmcnt(0)
L_h3_chk:
    v_xor_b32 v1, s82, v1
    v_cmp_ne_u32 vcc, 0, v1
    s_add_u32 s72, s72, 1
    s_and_b32 s67, vcc_lo, 0xff
    s_cmp_eq_u32 s67, 0
    s_cbranch_scc1 L_h3_ok
    s_sleep 2
    s_cmp_lt_u32 s72, 400000
    s_cbranch_scc1 L_h3_spin
L_h3_ok:
    s_barrier
    buffer_load_dwordx4 v[4:7], v231, s[4:7], s69 offen offset:0 sc1
    buffer_load_dwordx4 v[8:11], v231, s[4:7], s70 offen offset:0 sc1
    buffer_load_dwordx4 v[12:15], v231, s[4:7], s75 offen offset:0 sc1
    buffer_load_dwordx4 v[16:19], v231, s[4:7], s76 offen offset:0 sc1
    buffer_load_dwordx4 v[20:23], v231, s[4:7], s69 offen offset:1024 sc1
    buffer_load_dwordx4 v[24:27], v231, s[4:7], s70 offen offset:1024 sc1
    buffer_load_dwordx4 v[28:31], v231, s[4:7], s75 offen offset:1024 sc1
    buffer_load_dwordx4 v[32:35], v231, s[4:7], s76 offen offset:1024 sc1
    buffer_load_dwordx4 v[36:39], v231, s[4:7], s69 offen offset:2048 sc1
    buffer_load_dwordx4 v[40:43], v231, s[4:7], s70 offen offset:2048 sc1
    buffer_load_dwordx4 v[44:47], v231, s[4:7], s75 offen offset:2048 sc1
    buffer_load_dwordx4 v[48:51], v231, s[4:7], s76 offen offset:2048 sc1
    s_waitcnt vmcnt(8)
    v_mfma_f32_16x16x32_bf16 v[132:135], a[0:3], v[4:7], 0
    buffer_load_dwordx4 v[52:55], v231, s[4:7], s69 offen offset:3072 sc1
    v_mfma_f32_16x16x32_bf16 v[136:139], a[0:3], v[8:11], 0
    v_mfma_f32_16x16x32_bf16 v[140:143], a[0:3], v[12:15], 0
    v_mfma_f32_16x16x32_bf16 v[200:203], a[0:3], v[16:19], 0
    v_mfma_f32_16x16x32_bf16 v[204:207], a[4:7], v[16:19], 0
    buffer_load_dwordx4 v[56:59], v231, s[4:7], s70 offen offset:3072 sc1
    v_mfma_f32_16x16x32_bf16 v[152:155], a[4:7], v[12:15], 0
    v_mfma_f32_16x16x32_bf16 v[148:151], a[4:7], v[8:11], 0
    v_mfma_f32_16x16x32_bf16 v[144:147], a[4:7], v[4:7], 0
    v_mfma_f32_16x16x32_bf16 v[156:159], a[8:11], v[4:7], 0
    buffer_load_dwordx4 v[60:63], v231, s[4:7], s75 offen offset:3072 sc1
    v_mfma_f32_16x16x32_bf16 v[160:163], a[8:11], v[8:11], 0
    v_mfma_f32_16x16x32_bf16 v[164:167], a[8:11], v[12:15], 0
    v_mfma_f32_16x16x32_bf16 v[208:211], a[8:11], v[16:19], 0
    v_mfma_f32_16x16x32_bf16 v[212:215], a[12:15], v[16:19], 0
    buffer_load_dwordx4 v[64:67], v231, s[4:7], s76 offen offset:3072 sc1
    s_add_u32 s69, s69, 4096
    s_add_u32 s70, s70, 4096
    s_add_u32 s75, s75, 4096
    s_add_u32 s76, s76, 4096
    v_mfma_f32_16x16x32_bf16 v[176:179], a[12:15], v[12:15], 0
    v_mfma_f32_16x16x32_bf16 v[172:175], a[12:15], v[8:11], 0
    v_mfma_f32_16x16x32_bf16 v[168:171], a[12:15], v[4:7], 0
    s_waitcnt vmcnt(8)
    v_mfma_f32_16x16x32_bf16 v[132:135], a[16:19], v[20:23], v[132:135]
    buffer_load_dwordx4 v[68:71], v231, s[4:7], s69 offen offset:0 sc1
    v_mfma_f32_16x16x32_bf16 v[136:139], a[16:19], v[24:27], v[136:139]
    v_mfma_f32_16x16x32_bf16 v[140:143], a[16:19], v[28:31], v[140:143]
    v_mfma_f32_16x16x32_bf16 v[200:203], a[16:19], v[32:35], v[200:203]
    v_mfma_f32_16x16x32_bf16 v[204:207], a[20:23], v[32:35], v[204:207]
    buffer_load_dwordx4 v[72:75], v231, s[4:7], s70 offen offset:0 sc1
    v_mfma_f32_16x16x32_bf16 v[152:155], a[20:23], v[28:31], v[152:155]
    v_mfma_f32_16x16x32_bf16 v[148:151], a[20:23], v[24:27], v[148:151]
    v_mfma_f32_16x16x32_bf16 v[144:147], a[20:23], v[20:23], v[144:147]
    v_mfma_f32_16x16x32_bf16 v[156:159], a[24:27], v[20:23], v[156:159]
    buffer_load_dwordx4 v[76:79], v231, s[4:7], s75 offen offset:0 sc1
    v_mfma_f32_16x16x32_bf16 v[160:163], a[24:27], v[24:27], v[160:163]
    v_mfma_f32_16x16x32_bf16 v[164:167], a[24:27], v[28:31], v[164:167]
    v_mfma_f32_16x16x32_bf16 v[208:211], a[24:27], v[32:35], v[208:211]
    v_mfma_f32_16x16x32_bf16 v[212:215], a[28:31], v[32:35], v[212:215]
    buffer_load_dwordx4 v[80:83], v231, s[4:7], s76 offen offset:0 sc1
    v_mfma_f32_16x16x32_bf16 v[176:179], a[28:31], v[28:31], v[176:179]
    v_mfma_f32_16x16x32_bf16 v[172:175], a[28:31], v[24:27], v[172:175]
    v_mfma_f32_16x16x32_bf16 v[168:171], a[28:31], v[20:23], v[168:171]
    s_waitcnt vmcnt(8)
    v_mfma_f32_16x16x32_bf16 v[132:135], a[32:35], v[36:39], v[132:135]
    buffer_load_dwordx4 v[84:87], v231, s[4:7], s69 offen offset:1024 sc1
    v_mfma_f32_16x16x32_bf16 v[136:139], a[32:35], v[40:43], v[136:139]
    v_mfma_f32_16x16x32_bf16 v[140:143], a[32:35], v[44:47], v[140:143]
    v_mfma_f32_16x16x32_bf16 v[200:203], a[32:35], v[48:51], v[200:203]
    v_mfma_f32_16x16x32_bf16 v[204:207], a[36:39], v[48:51], v[204:207]
    buffer_load_dwordx4 v[88:91], v231, s[4:7], s70 offen offset:1024 sc1
    v_mfma_f32_16x16x32_bf16 v[152:155], a[36:39], v[44:47], v[152:155]
    v_mfma_f32_16x16x32_bf16 v[148:151], a[36:39], v[40:43], v[148:151]
    v_mfma_f32_16x16x32_bf16 v[144:147], a[36:39], v[36:39], v[144:147]
    v_mfma_f32_16x16x32_bf16 v[156:159], a[40:43], v[36:39], v[156:159]
    buffer_load_dwordx4 v[92:95], v231, s[4:7], s75 offen offset:1024 sc1
    v_mfma_f32_16x16x32_bf16 v[160:163], a[40:43], v[40:43], v[160:163]
    v_mfma_f32_16x16x32_bf16 v[164:167], a[40:43], v[44:47], v[164:167]
    v_mfma_f32_16x16x32_bf16 v[208:211], a[40:43], v[48:51], v[208:211]
    v_mfma_f32_16x16x32_bf16 v[212:215], a[44:47], v[48:51], v[212:215]
    buffer_load_dwordx4 v[96:99], v231, s[4:7], s76 offen offset:1024 sc1
    v_mfma_f32_16x16x32_bf16 v[176:179], a[44:47], v[44:47], v[176:179]
    v_mfma_f32_16x16x32_bf16 v[172:175], a[44:47], v[40:43], v[172:175]
    v_mfma_f32_16x16x32_bf16 v[168:171], a[44:47], v[36:39], v[168:171]
    s_waitcnt vmcnt(8)
    v_mfma_f32_16x16x32_bf16 v[132:135], a[48:51], v[52:55], v[132:135]
    buffer_load_dwordx4 a[176:179], v231, s[4:7], s69 offen offset:2048 sc1
    v_mfma_f32_16x16x32_bf16 v[136:139], a[48:51], v[56:59], v[136:139]
    v_mfma_f32_16x16x32_bf16 v[140:143], a[48:51], v[60:63], v[140:143]
    v_mfma_f32_16x16x32_bf16 v[200:203], a[48:51], v[64:67], v[200:203]
    v_mfma_f32_16x16x32_bf16 v[204:207], a[52:55], v[64:67], v[204:207]
    buffer_load_dwordx4 a[180:183], v231, s[4:7], s70 offen offset:2048 sc1
    v_mfma_f32_16x16x32_bf16 v[152:155], a[52:55], v[60:63], v[152:155]
    v_mfma_f32_16x16x32_bf16 v[148:151], a[52:55], v[56:59], v[148:151]
    v_mfma_f32_16x16x32_bf16 v[144:147], a[52:55], v[52:55], v[144:147]
    v_mfma_f32_16x16x32_bf16 v[156:159], a[56:59], v[52:55], v[156:159]
    buffer_load_dwordx4 a[184:187], v231, s[4:7], s75 offen offset:2048 sc1
    v_mfma_f32_16x16x32_bf16 v[160:163], a[56:59], v[56:59], v[160:163]
    v_mfma_f32_16x16x32_bf16 v[164:167], a[56:59], v[60:63], v[164:167]
    v_mfma_f32_16x16x32_bf16 v[208:211], a[56:59], v[64:67], v[208:211]
    v_mfma_f32_16x16x32_bf16 v[212:215], a[60:63], v[64:67], v[212:215]
    buffer_load_dwordx4 a[188:191], v231, s[4:7], s76 offen offset:2048 sc1
    v_mfma_f32_16x16x32_bf16 v[176:179], a[60:63], v[60:63], v[176:179]
    v_mfma_f32_16x16x32_bf16 v[172:175], a[60:63], v[56:59], v[172:175]
    v_mfma_f32_16x16x32_bf16 v[168:171], a[60:63], v[52:55], v[168:171]
    s_waitcnt vmcnt(8)
    v_mfma_f32_16x16x32_bf16 v[132:135], a[64:67], v[68:71], v[132:135]
    buffer_load_dwordx4 a[192:195], v231, s[4:7], s69 offen offset:3072 sc1
    v_mfma_f32_16x16x32_bf16 v[136:139], a[64:67], v[72:75], v[136:139]
    v_mfma_f32_16x16x32_bf16 v[140:143], a[64:67], v[76:79], v[140:143]
    v_mfma_f32_16x16x32_bf16 v[200:203], a[64:67], v[80:83], v[200:203]
    v_mfma_f32_16x16x32_bf16 v[204:207], a[68:71], v[80:83], v[204:207]
    buffer_load_dwordx4 a[196:199], v231, s[4:7], s70 offen offset:3072 sc1
    v_mfma_f32_16x16x32_bf16 v[152:155], a[68:71], v[76:79], v[152:155]
    v_mfma_f32_16x16x32_bf16 v[148:151], a[68:71], v[72:75], v[148:151]
    v_mfma_f32_16x16x32_bf16 v[144:147], a[68:71], v[68:71], v[144:147]
    v_mfma_f32_16x16x32_bf16 v[156:159], a[72:75], v[68:71], v[156:159]
    buffer_load_dwordx4 a[200:203], v231, s[4:7], s75 offen offset:3072 sc1
    v_mfma_f32_16x16x32_bf16 v[160:163], a[72:75], v[72:75], v[160:163]
    v_mfma_f32_16x16x32_bf16 v[164:167], a[72:75], v[76:79], v[164:167]
    v_mfma_f32_16x16x32_bf16 v[208:211], a[72:75], v[80:83], v[208:211]
    v_mfma_f32_16x16x32_bf16 v[212:215], a[76:79], v[80:83], v[212:215]
    buffer_load_dwordx4 a[204:207], v231, s[4:7], s76 offen offset:3072 sc1
    s_add_u32 s69, s69, 4096
    s_add_u32 s70, s70, 4096
    s_add_u32 s75, s75, 4096
    s_add_u32 s76, s76, 4096
    v_mfma_f32_16x16x32_bf16 v[176:179], a[76:79], v[76:79], v[176:179]
    v_mfma_f32_16x16x32_bf16 v[172:175], a[76:79], v[72:75], v[172:175]
    v_mfma_f32_16x16x32_bf16 v[168:171], a[76:79], v[68:71], v[168:171]
    s_waitcnt vmcnt(8)
    v_mfma_f32_16x16x32_bf16 v[132:135], a[80:83], v[84:87], v[132:135]
    buffer_load_dwordx4 a[208:211], v231, s[4:7], s69 offen offset:0 sc1
    v_mfma_f32_16x16x32_bf16 v[136:139], a[80:83], v[88:91], v[136:139]
    v_mfma_f32_16x16x32_bf16 v[140:143], a[80:83], v[92:95], v[140:143]
    v_mfma_f32_16x16x32_bf16 v[200:203], a[80:83], v[96:99], v[200:203]
    v_mfma_f32_16x16x32_bf16 v[204:207], a[84:87], v[96:99], v[204:207]
    buffer_load_dwordx4 a[212:215], v231, s[4:7], s70 offen offset:0 sc1
    v_mfma_f32_16x16x32_bf16 v[152:155], a[84:87], v[92:95], v[152:155]
    v_mfma_f32_16x16x32_bf16 v[148:151], a[84:87], v[88:91], v[148:151]
    v_mfma_f32_16x16x32_bf16 v[144:147], a[84:87], v[84:87], v[144:147]
    v_mfma_f32_16x16x32_bf16 v[156:159], a[88:91], v[84:87], v[156:159]
    buffer_load_dwordx4 a[216:219], v231, s[4:7], s75 offen offset:0 sc1
    v_mfma_f32_16x16x32_bf16 v[160:163], a[88:91], v[88:91], v[160:163]
    v_mfma_f32_16x16x32_bf16 v[164:167], a[88:91], v[92:95], v[164:167]
    v_mfma_f32_16x16x32_bf16 v[208:211], a[88:91], v[96:99], v[208:211]
    v_mfma_f32_16x16x32_bf16 v[212:215], a[92:95], v[96:99], v[212:215]
    buffer_load_dwordx4 a[220:223], v231, s[4:7], s76 offen offset:0 sc1
    v_mfma_f32_16x16x32_bf16 v[176:179], a[92:95], v[92:95], v[176:179]
    v_mfma_f32_16x16x32_bf16 v[172:175], a[92:95], v[88:91], v[172:175]
    v_mfma_f32_16x16x32_bf16 v[168:171], a[92:95], v[84:87], v[168:171]
    s_waitcnt vmcnt(8)
    v_mfma_f32_16x16x32_bf16 v[132:135], a[96:99], a[176:179], v[132:135]
    buffer_load_dwordx4 a[224:227], v231, s[4:7], s69 offen offset:1024 sc1
    v_mfma_f32_16x16x32_bf16 v[136:139], a[96:99], a[180:183], v[136:139]
    v_mfma_f32_16x16x32_bf16 v[140:143], a[96:99], a[184:187], v[140:143]
    v_mfma_f32_16x16x32_bf16 v[200:203], a[96:99], a[188:191], v[200:203]
    v_mfma_f32_16x16x32_bf16 v[204:207], a[100:103], a[188:191], v[204:207]
    buffer_load_dwordx4 a[228:231], v231, s[4:7], s70 offen offset:1024 sc1
    v_mfma_f32_16x16x32_bf16 v[152:155], a[100:103], a[184:187], v[152:155]
    v_mfma_f32_16x16x32_bf16 v[148:151], a[100:103], a[180:183], v[148:151]
    v_mfma_f32_16x16x32_bf16 v[144:147], a[100:103], a[176:179], v[144:147]
    v_mfma_f32_16x16x32_bf16 v[156:159], a[104:107], a[176:179], v[156:159]
    buffer_load_dwordx4 a[232:235], v231, s[4:7], s75 offen offset:1024 sc1
    v_mfma_f32_16x16x32_bf16 v[160:163], a[104:107], a[180:183], v[160:163]
    v_mfma_f32_16x16x32_bf16 v[164:167], a[104:107], a[184:187], v[164:167]
    v_mfma_f32_16x16x32_bf16 v[208:211], a[104:107], a[188:191], v[208:211]
    v_mfma_f32_16x16x32_bf16 v[212:215], a[108:111], a[188:191], v[212:215]
    buffer_load_dwordx4 a[236:239], v231, s[4:7], s76 offen offset:1024 sc1
    v_mfma_f32_16x16x32_bf16 v[176:179], a[108:111], a[184:187], v[176:179]
    v_mfma_f32_16x16x32_bf16 v[172:175], a[108:111], a[180:183], v[172:175]
    v_mfma_f32_16x16x32_bf16 v[168:171], a[108:111], a[176:179], v[168:171]
    s_waitcnt vmcnt(8)
    v_mfma_f32_16x16x32_bf16 v[132:135], a[112:115], a[192:195], v[132:135]
    buffer_load_dwordx4 a[240:243], v231, s[4:7], s69 offen offset:2048 sc1
    v_mfma_f32_16x16x32_bf16 v[136:139], a[112:115], a[196:199], v[136:139]
    v_mfma_f32_16x16x32_bf16 v[140:143], a[112:115], a[200:203], v[140:143]
    v_mfma_f32_16x16x32_bf16 v[200:203], a[112:115], a[204:207], v[200:203]
    v_mfma_f32_16x16x32_bf16 v[204:207], a[116:119], a[204:207], v[204:207]
    buffer_load_dwordx4 a[244:247], v231, s[4:7], s70 offen offset:2048 sc1
    v_mfma_f32_16x16x32_bf16 v[152:155], a[116:119], a[200:203], v[152:155]
    v_mfma_f32_16x16x32_bf16 v[148:151], a[116:119], a[196:199], v[148:151]
    v_mfma_f32_16x16x32_bf16 v[144:147], a[116:119], a[192:195], v[144:147]
    v_mfma_f32_16x16x32_bf16 v[156:159], a[120:123], a[192:195], v[156:159]
    buffer_load_dwordx4 a[248:251], v231, s[4:7], s75 offen offset:2048 sc1
    v_mfma_f32_16x16x32_bf16 v[160:163], a[120:123], a[196:199], v[160:163]
    v_mfma_f32_16x16x32_bf16 v[164:167], a[120:123], a[200:203], v[164:167]
    v_mfma_f32_16x16x32_bf16 v[208:211], a[120:123], a[204:207], v[208:211]
    v_mfma_f32_16x16x32_bf16 v[212:215], a[124:127], a[204:207], v[212:215]
    buffer_load_dwordx4 a[252:255], v231, s[4:7], s76 offen offset:2048 sc1
    v_mfma_f32_16x16x32_bf16 v[176:179], a[124:127], a[200:203], v[176:179]
    v_mfma_f32_16x16x32_bf16 v[172:175], a[124:127], a[196:199], v[172:175]
    v_mfma_f32_16x16x32_bf16 v[168:171], a[124:127], a[192:195], v[168:171]
    s_waitcnt vmcnt(8)
    v_mfma_f32_16x16x32_bf16 v[132:135], a[128:131], a[208:211], v[132:135]
    v_mfma_f32_16x16x32_bf16 v[136:139], a[128:131], a[212:215], v[136:139]
    v_mfma_f32_16x16x32_bf16 v[140:143], a[128:131], a[216:219], v[140:143]
    v_mfma_f32_16x16x32_bf16 v[200:203], a[128:131], a[220:223], v[200:203]
    v_mfma_f32_16x16x32_bf16 v[204:207], a[132:135], a[220:223], v[204:207]
    v_mfma_f32_16x16x32_bf16 v[152:155], a[132:135], a[216:219], v[152:155]
    v_mfma_f32_16x16x32_bf16 v[148:151], a[132:135], a[212:215], v[148:151]
    v_mfma_f32_16x16x32_bf16 v[144:147], a[132:135], a[208:211], v[144:147]
    v_mfma_f32_16x16x32_bf16 v[156:159], a[136:139], a[208:211], v[156:159]
    v_mfma_f32_16x16x32_bf16 v[160:163], a[136:139], a[212:215], v[160:163]
    v_mfma_f32_16x16x32_bf16 v[164:167], a[136:139], a[216:219], v[164:167]
    v_mfma_f32_16x16x32_bf16 v[208:211], a[136:139], a[220:223], v[208:211]
    v_mfma_f32_16x16x32_bf16 v[212:215], a[140:143], a[220:223], v[212:215]
    v_mfma_f32_16x16x32_bf16 v[176:179], a[140:143], a[216:219], v[176:179]
    v_mfma_f32_16x16x32_bf16 v[172:175], a[140:143], a[212:215], v[172:175]
    v_mfma_f32_16x16x32_bf16 v[168:171], a[140:143], a[208:211], v[168:171]
    s_waitcnt vmcnt(0)
    v_mfma_f32_16x16x32_bf16 v[132:135], a[144:147], a[224:227], v[132:135]
    v_mfma_f32_16x16x32_bf16 v[144:147], a[148:151], a[224:227], v[144:147]
    v_mfma_f32_16x16x32_bf16 v[156:159], a[152:155], a[224:227], v[156:159]
    v_mfma_f32_16x16x32_bf16 v[168:171], a[156:159], a[224:227], v[168:171]
    v_mfma_f32_16x16x32_bf16 v[132:135], a[160:163], a[240:243], v[132:135]
    v_mfma_f32_16x16x32_bf16 v[144:147], a[164:167], a[240:243], v[144:147]
    v_mfma_f32_16x16x32_bf16 v[156:159], a[168:171], a[240:243], v[156:159]
    v_mfma_f32_16x16x32_bf16 v[168:171], a[172:175], a[240:243], v[168:171]
    v_mfma_f32_16x16x32_bf16 v[136:139], a[144:147], a[228:231], v[136:139]
    v_mfma_f32_16x16x32_bf16 v[148:151], a[148:151], a[228:231], v[148:151]
    v_mfma_f32_16x16x32_bf16 v[160:163], a[152:155], a[228:231], v[160:163]
    v_mfma_f32_16x16x32_bf16 v[172:175], a[156:159], a[228:231], v[172:175]
    v_mfma_f32_16x16x32_bf16 v[136:139], a[160:163], a[244:247], v[136:139]
    ds_write_b128 v226, v[132:135] offset:0
    v_mfma_f32_16x16x32_bf16 v[148:151], a[164:167], a[244:247], v[148:151]
    ds_write_b128 v226, v[144:147] offset:1024
    v_mfma_f32_16x16x32_bf16 v[160:163], a[168:171], a[244:247], v[160:163]
    ds_write_b128 v226, v[156:159] offset:2048
    v_mfma_f32_16x16x32_bf16 v[172:175], a[172:175], a[244:247], v[172:175]
    ds_write_b128 v226, v[168:171] offset:3072
    v_mfma_f32_16x16x32_bf16 v[140:143], a[144:147], a[232:235], v[140:143]
    v_mfma_f32_16x16x32_bf16 v[152:155], a[148:151], a[232:235], v[152:155]
    v_mfma_f32_16x16x32_bf16 v[164:167], a[152:155], a[232:235], v[164:167]
    v_mfma_f32_16x16x32_bf16 v[176:179], a[156:159], a[232:235], v[176:179]
    v_mfma_f32_16x16x32_bf16 v[140:143], a[160:163], a[248:251], v[140:143]
    ds_write_b128 v227, v[136:139] offset:0
    v_mfma_f32_16x16x32_bf16 v[152:155], a[164:167], a[248:251], v[152:155]
    ds_write_b128 v227, v[148:151] offset:1024
    v_mfma_f32_16x16x32_bf16 v[164:167], a[168:171], a[248:251], v[164:167]
    ds_write_b128 v227, v[160:163] offset:2048
    v_mfma_f32_16x16x32_bf16 v[176:179], a[172:175], a[248:251], v[176:179]
    ds_write_b128 v227, v[172:175] offset:3072
    v_mfma_f32_16x16x32_bf16 v[200:203], a[144:147], a[236:239], v[200:203]
    v_mfma_f32_16x16x32_bf16 v[204:207], a[148:151], a[236:239], v[204:207]
    v_mfma_f32_16x16x32_bf16 v[208:211], a[152:155], a[236:239], v[208:211]
    v_mfma_f32_16x16x32_bf16 v[212:215], a[156:159], a[236:239], v[212:215]
    v_mfma_f32_16x16x32_bf16 v[200:203], a[160:163], a[252:255], v[200:203]
    ds_write_b128 v228, v[140:143] offset:0
    v_mfma_f32_16x16x32_bf16 v[204:207], a[164:167], a[252:255], v[204:207]
    ds_write_b128 v228, v[152:155] offset:1024
    v_mfma_f32_16x16x32_bf16 v[208:211], a[168:171], a[252:255], v[208:211]
    ds_write_b128 v228, v[164:167] offset:2048
    v_mfma_f32_16x16x32_bf16 v[212:215], a[172:175], a[252:255], v[212:215]
    ds_write_b128 v228, v[176:179] offset:3072
    s_waitcnt lgkmcnt(0)
    s_barrier
    ds_read_b128 v[100:103], v229 offset:0
    ds_read_b128 v[104:107], v229 offset:1024
    ds_read_b128 v[108:111], v229 offset:2048
    ds_read_b128 v[112:115], v229 offset:3072
    ds_read_b128 v[116:119], v229 offset:4096
    ds_read_b128 v[120:123], v229 offset:5120
    ds_read_b128 v[124:127], v229 offset:6144
    ds_read_b128 v[128:131], v229 offset:7168
    ds_read_b128 v[36:39], v229 offset:8192
    ds_read_b128 v[40:43], v229 offset:9216
    ds_read_b128 v[44:47], v229 offset:10240
    ds_read_b128 v[48:51], v229 offset:11264
    s_waitcnt lgkmcnt(8)
    v_pk_add_f32 v[200:201], v[200:201], v[100:101]
    v_pk_add_f32 v[202:203], v[202:203], v[102:103]
    v_pk_add_f32 v[204:205], v[204:205], v[104:105]
    v_pk_add_f32 v[206:207], v[206:207], v[106:107]
    v_pk_add_f32 v[208:209], v[208:209], v[108:109]
    v_pk_add_f32 v[210:211], v[210:211], v[110:111]
    v_pk_add_f32 v[212:213], v[212:213], v[112:113]
    v_pk_add_f32 v[214:215], v[214:215], v[114:115]
    s_waitcnt lgkmcnt(4)
    v_pk_add_f32 v[200:201], v[200:201], v[116:117]
    v_pk_add_f32 v[202:203], v[202:203], v[118:119]
    v_pk_add_f32 v[204:205], v[204:205], v[120:121]
    v_pk_add_f32 v[206:207], v[206:207], v[122:123]
    v_pk_add_f32 v[208:209], v[208:209], v[124:125]
    v_pk_add_f32 v[210:211], v[210:211], v[126:127]
    v_pk_add_f32 v[212:213], v[212:213], v[128:129]
    v_pk_add_f32 v[214:215], v[214:215], v[130:131]
    s_waitcnt lgkmcnt(0)
    v_pk_add_f32 v[200:201], v[200:201], v[36:37]
    v_pk_add_f32 v[202:203], v[202:203], v[38:39]
    v_pk_add_f32 v[204:205], v[204:205], v[40:41]
    v_pk_add_f32 v[206:207], v[206:207], v[42:43]
    v_pk_add_f32 v[208:209], v[208:209], v[44:45]
    v_pk_add_f32 v[210:211], v[210:211], v[46:47]
    v_pk_add_f32 v[212:213], v[212:213], v[48:49]
    v_pk_add_f32 v[214:215], v[214:215], v[50:51]
    v_pk_fma_f32 v[180:181], v[232:233], v[200:201], v[180:181]
    v_pk_fma_f32 v[182:183], v[234:235], v[202:203], v[182:183]
    v_pk_fma_f32 v[184:185], v[236:237], v[204:205], v[184:185]
    v_pk_fma_f32 v[186:187], v[238:239], v[206:207], v[186:187]
    v_pk_fma_f32 v[188:189], v[240:241], v[208:209], v[188:189]
    v_pk_fma_f32 v[190:191], v[242:243], v[210:211], v[190:191]
    v_pk_fma_f32 v[192:193], v[244:245], v[212:213], v[192:193]
    v_pk_fma_f32 v[194:195], v[246:247], v[214:215], v[194:195]
    v_cvt_pk_bf16_f32 v20, v180, v181
    v_cvt_pk_bf16_f32 v21, v182, v183
    v_cvt_pk_bf16_f32 v22, v184, v185
    v_cvt_pk_bf16_f32 v23, v186, v187
    v_cvt_pk_bf16_f32 v24, v188, v189
    v_cvt_pk_bf16_f32 v25, v190, v191
    v_cvt_pk_bf16_f32 v26, v192, v193
    v_cvt_pk_bf16_f32 v27, v194, v195
    v_permlane16_swap_b32 v20, v22
    v_permlane16_swap_b32 v21, v23
    v_permlane16_swap_b32 v24, v26
    v_permlane16_swap_b32 v25, v27
    buffer_store_dwordx4 v[20:23], v225, s[28:31], 0 offen offset:0
    buffer_store_dwordx4 v[24:27], v225, s[28:31], 0 offen offset:64
L_done:
    s_endpgm
L_retry:
    s_mov_b32 s73, 1
    s_waitcnt vmcnt(0) lgkmcnt(0)
    s_barrier
    s_branch L_top
L_maxpass:
    s_mov_b32 s69, 507904
L_fbloop:
    s_waitcnt lgkmcnt(0)
    s_barrier
    s_add_u32 m0, s71, 0
    s_nop 0
    buffer_load_dwordx4 v212, s[4:7], s69 offen offset:0 lds
    buffer_load_dwordx4 v213, s[4:7], s69 offen offset:1024 lds
    buffer_load_dwordx4 v214, s[4:7], s69 offen offset:2048 lds
    buffer_load_dwordx4 v215, s[4:7], s69 offen offset:3072 lds
    s_waitcnt vmcnt(0)
    s_barrier
    ds_read_b128 a[128:131], v200 offset:8192
    ds_read_b128 a[132:135], v201 offset:8192
    ds_read_b128 a[136:139], v202 offset:8192
    ds_read_b128 a[140:143], v203 offset:8192
    ds_read_b128 a[144:147], v200 offset:12288
    ds_read_b128 a[148:151], v201 offset:12288
    ds_read_b128 a[152:155], v202 offset:12288
    ds_read_b128 a[156:159], v203 offset:12288
    s_waitcnt lgkmcnt(0)
    v_mfma_f32_16x16x32_bf16 v[4:7], a[128:131], v[132:135], 0
    v_mfma_f32_16x16x32_bf16 v[4:7], a[132:135], v[136:139], v[4:7]
    v_mfma_f32_16x16x32_bf16 v[4:7], a[136:139], v[140:143], v[4:7]
    v_mfma_f32_16x16x32_bf16 v[4:7], a[140:143], v[144:147], v[4:7]
    v_mfma_f32_16x16x32_bf16 v[8:11], a[140:143], v[160:163], 0
    v_mfma_f32_16x16x32_bf16 v[8:11], a[136:139], v[156:159], v[8:11]
    v_mfma_f32_16x16x32_bf16 v[8:11], a[132:135], v[152:155], v[8:11]
    v_mfma_f32_16x16x32_bf16 v[8:11], a[128:131], v[148:151], v[8:11]
    v_mfma_f32_16x16x32_bf16 v[12:15], a[128:131], v[164:167], 0
    v_mfma_f32_16x16x32_bf16 v[12:15], a[132:135], v[168:171], v[12:15]
    v_mfma_f32_16x16x32_bf16 v[12:15], a[136:139], v[172:175], v[12:15]
    v_mfma_f32_16x16x32_bf16 v[12:15], a[140:143], v[176:179], v[12:15]
    v_mfma_f32_16x16x32_bf16 v[16:19], a[140:143], v[192:195], 0
    v_mfma_f32_16x16x32_bf16 v[16:19], a[136:139], v[188:191], v[16:19]
    v_mfma_f32_16x16x32_bf16 v[16:19], a[132:135], v[184:187], v[16:19]
    v_mfma_f32_16x16x32_bf16 v[16:19], a[128:131], v[180:183], v[16:19]
    v_mfma_f32_16x16x32_bf16 v[32:35], a[144:147], v[180:183], 0
    v_mfma_f32_16x16x32_bf16 v[32:35], a[148:151], v[184:187], v[32:35]
    v_mfma_f32_16x16x32_bf16 v[32:35], a[152:155], v[188:191], v[32:35]
    v_mfma_f32_16x16x32_bf16 v[32:35], a[156:159], v[192:195], v[32:35]
    v_mfma_f32_16x16x32_bf16 v[28:31], a[156:159], v[176:179], 0
    v_mfma_f32_16x16x32_bf16 v[28:31], a[152:155], v[172:175], v[28:31]
    v_mfma_f32_16x16x32_bf16 v[28:31], a[148:151], v[168:171], v[28:31]
    v_mfma_f32_16x16x32_bf16 v[28:31], a[144:147], v[164:167], v[28:31]
    v_mfma_f32_16x16x32_bf16 v[24:27], a[144:147], v[148:151], 0
    v_mfma_f32_16x16x32_bf16 v[24:27], a[148:151], v[152:155], v[24:27]
    v_mfma_f32_16x16x32_bf16 v[24:27], a[152:155], v[156:159], v[24:27]
    v_mfma_f32_16x16x32_bf16 v[24:27], a[156:159], v[160:163], v[24:27]
    v_mfma_f32_16x16x32_bf16 v[20:23], a[156:159], v[144:147], 0
    v_mfma_f32_16x16x32_bf16 v[20:23], a[152:155], v[140:143], v[20:23]
    v_mfma_f32_16x16x32_bf16 v[20:23], a[148:151], v[136:139], v[20:23]
    v_mfma_f32_16x16x32_bf16 v[20:23], a[144:147], v[132:135], v[20:23]
    s_nop 7
    v_max3_f32 v223, v4, v5, v223
    v_max3_f32 v224, v8, v9, v224
    v_max3_f32 v225, v12, v13, v225
    v_max3_f32 v226, v16, v17, v226
    v_max3_f32 v223, v6, v7, v223
    v_max3_f32 v224, v10, v11, v224
    v_max3_f32 v225, v14, v15, v225
    v_max3_f32 v226, v18, v19, v226
    v_max3_f32 v223, v20, v21, v223
    v_max3_f32 v224, v24, v25, v224
    v_max3_f32 v225, v28, v29, v225
    v_max3_f32 v226, v32, v33, v226
    v_max3_f32 v223, v22, v23, v223
    v_max3_f32 v224, v26, v27, v224
    v_max3_f32 v225, v30, v31, v225
    v_max3_f32 v226, v34, v35, v226
    ds_read_b128 a[128:131], v200 offset:0
    ds_read_b128 a[132:135], v201 offset:0
    ds_read_b128 a[136:139], v202 offset:0
    ds_read_b128 a[140:143], v203 offset:0
    ds_read_b128 a[144:147], v200 offset:4096
    ds_read_b128 a[148:151], v201 offset:4096
    ds_read_b128 a[152:155], v202 offset:4096
    ds_read_b128 a[156:159], v203 offset:4096
    s_waitcnt lgkmcnt(0)
    v_mfma_f32_16x16x32_bf16 v[4:7], a[128:131], v[132:135], 0
    v_mfma_f32_16x16x32_bf16 v[4:7], a[132:135], v[136:139], v[4:7]
    v_mfma_f32_16x16x32_bf16 v[4:7], a[136:139], v[140:143], v[4:7]
    v_mfma_f32_16x16x32_bf16 v[4:7], a[140:143], v[144:147], v[4:7]
    v_mfma_f32_16x16x32_bf16 v[8:11], a[140:143], v[160:163], 0
    v_mfma_f32_16x16x32_bf16 v[8:11], a[136:139], v[156:159], v[8:11]
    v_mfma_f32_16x16x32_bf16 v[8:11], a[132:135], v[152:155], v[8:11]
    v_mfma_f32_16x16x32_bf16 v[8:11], a[128:131], v[148:151], v[8:11]
    v_mfma_f32_16x16x32_bf16 v[12:15], a[128:131], v[164:167], 0
    v_mfma_f32_16x16x32_bf16 v[12:15], a[132:135], v[168:171], v[12:15]
    v_mfma_f32_16x16x32_bf16 v[12:15], a[136:139], v[172:175], v[12:15]
    v_mfma_f32_16x16x32_bf16 v[12:15], a[140:143], v[176:179], v[12:15]
    v_mfma_f32_16x16x32_bf16 v[16:19], a[140:143], v[192:195], 0
    v_mfma_f32_16x16x32_bf16 v[16:19], a[136:139], v[188:191], v[16:19]
    v_mfma_f32_16x16x32_bf16 v[16:19], a[132:135], v[184:187], v[16:19]
    v_mfma_f32_16x16x32_bf16 v[16:19], a[128:131], v[180:183], v[16:19]
    v_mfma_f32_16x16x32_bf16 v[32:35], a[144:147], v[180:183], 0
    v_mfma_f32_16x16x32_bf16 v[32:35], a[148:151], v[184:187], v[32:35]
    v_mfma_f32_16x16x32_bf16 v[32:35], a[152:155], v[188:191], v[32:35]
    v_mfma_f32_16x16x32_bf16 v[32:35], a[156:159], v[192:195], v[32:35]
    v_mfma_f32_16x16x32_bf16 v[28:31], a[156:159], v[176:179], 0
    v_mfma_f32_16x16x32_bf16 v[28:31], a[152:155], v[172:175], v[28:31]
    v_mfma_f32_16x16x32_bf16 v[28:31], a[148:151], v[168:171], v[28:31]
    v_mfma_f32_16x16x32_bf16 v[28:31], a[144:147], v[164:167], v[28:31]
    v_mfma_f32_16x16x32_bf16 v[24:27], a[144:147], v[148:151], 0
    v_mfma_f32_16x16x32_bf16 v[24:27], a[148:151], v[152:155], v[24:27]
    v_mfma_f32_16x16x32_bf16 v[24:27], a[152:155], v[156:159], v[24:27]
    v_mfma_f32_16x16x32_bf16 v[24:27], a[156:159], v[160:163], v[24:27]
    v_mfma_f32_16x16x32_bf16 v[20:23], a[156:159], v[144:147], 0
    v_mfma_f32_16x16x32_bf16 v[20:23], a[152:155], v[140:143], v[20:23]
    v_mfma_f32_16x16x32_bf16 v[20:23], a[148:151], v[136:139], v[20:23]
    v_mfma_f32_16x16x32_bf16 v[20:23], a[144:147], v[132:135], v[20:23]
    s_nop 7
    v_max3_f32 v223, v4, v5, v223
    v_max3_f32 v224, v8, v9, v224
    v_max3_f32 v225, v12, v13, v225
    v_max3_f32 v226, v16, v17, v226
    v_max3_f32 v223, v6, v7, v223
    v_max3_f32 v224, v10, v11, v224
    v_max3_f32 v225, v14, v15, v225
    v_max3_f32 v226, v18, v19, v226
    v_max3_f32 v223, v20, v21, v223
    v_max3_f32 v224, v24, v25, v224
    v_max3_f32 v225, v28, v29, v225
    v_max3_f32 v226, v32, v33, v226
    v_max3_f32 v223, v22, v23, v223
    v_max3_f32 v224, v26, v27, v224
    v_max3_f32 v225, v30, v31, v225
    v_max3_f32 v226, v34, v35, v226
    s_sub_u32 s69, s69, 16384
    s_cbranch_scc0 L_fbloop
    ds_read_b128 a[128:131], v200 offset:8192
    ds_read_b128 a[132:135], v201 offset:8192
    ds_read_b128 a[136:139], v202 offset:8192
    ds_read_b128 a[140:143], v203 offset:8192
    ds_read_b128 a[144:147], v200 offset:12288
    ds_read_b128 a[148:151], v201 offset:12288
    ds_read_b128 a[152:155], v202 offset:12288
    ds_read_b128 a[156:159], v203 offset:12288
    s_branch L_havemax
L_end:
.section .rodata,"a"
.p2align 6
.amdhsa_kernel adaLN_cond__gqa_block_cached__dense_activation_silu__prompt_kernel
  .amdhsa_next_free_vgpr 512
  .amdhsa_next_free_sgpr 83
  .amdhsa_accum_offset 256
  .amdhsa_group_segment_fixed_size 0
  .amdhsa_kernarg_size 104
  .amdhsa_user_sgpr_count 2
  .amdhsa_user_sgpr_kernarg_segment_ptr 1
  .amdhsa_system_sgpr_workgroup_id_x 1
  .amdhsa_float_denorm_mode_32 3
.end_amdhsa_kernel
```
